```python
import torch

def _softmax(x, axis=-1):
    return torch.softmax(x, dim=axis)
def _gelu(x):
    return torch.nn.functional.gelu(x, approximate="tanh")
def _silu(x):
    return torch.nn.functional.silu(x)
def _sigmoid(x):
    return torch.sigmoid(x)
def _layernorm(x, axis=-1, eps=1e-5):
    m = x.mean(dim=axis, keepdim=True)
    v = x.var(dim=axis, keepdim=True, unbiased=False)
    return (x - m) / torch.sqrt(v + eps)
def _scatter_add(tgt, idx, src, axis=0):
    return tgt.clone().index_add_(axis, idx, src)
def _segment_sum(src, seg, n):
    out = torch.zeros((n,) + src.shape[1:], dtype=src.dtype)
    return out.index_add_(0, seg, src)
def _pad(x, pw):
    flat = tuple(v for pair in reversed(pw) for v in pair)
    return torch.nn.functional.pad(x, flat)

kernel_name = 'parallel_sum__linear_kernel_hedgehog__glu_gated_geglu__prompt'

def setup_inputs():

    _w = (lambda a: (lambda t: t.to(torch.bfloat16) if t.is_floating_point() else t)(torch.as_tensor(a)))
    def _A_setup():
        B, S, D, H = 1, 2048, 448, 16
        Dh = D // H
        return {
            "x": _w((lambda *s: torch.randn(*s, dtype=torch.bfloat16) * 0.05)(B, S, D)),
            "wqkv": _w((lambda *s: torch.randn(*s, dtype=torch.bfloat16) * 0.2)(D, 3 * D)),
            "w_phi": _w((lambda *s: torch.randn(*s, dtype=torch.bfloat16) * 0.2)(H, Dh, Dh) * (Dh ** -0.5)),
            "wo": _w((lambda *s: torch.randn(*s, dtype=torch.bfloat16) * 0.05)(D, D)),
        }
    _A_in = _A_setup()

    def _B_setup():
        B, S, Dm, Df = 1, 2048, 448, 1792
        return {
            "x": _w((lambda *s: torch.randn(*s, dtype=torch.bfloat16) * 0.05)(B, S, Dm)),
            "w_gate": _w((lambda *s: torch.randn(*s, dtype=torch.bfloat16) * 0.4)(Dm, Df) * (Dm ** -0.5)),
            "w_up": _w((lambda *s: torch.randn(*s, dtype=torch.bfloat16) * 0.4)(Dm, Df) * (Dm ** -0.5)),
            "w_down": _w((lambda *s: torch.randn(*s, dtype=torch.bfloat16) * 0.4)(Df, Dm) * (Df ** -0.5)),
        }
    _B_in = _B_setup()

    return {
        "A_x": _A_in["x"],
        "A_wqkv": _A_in["wqkv"],
        "A_w_phi": _A_in["w_phi"],
        "A_wo": _A_in["wo"],
        "B_x": _B_in["x"],
        "B_w_gate": _B_in["w_gate"],
        "B_w_up": _B_in["w_up"],
        "B_w_down": _B_in["w_down"],
    }

def reference(A_x, A_wqkv, A_w_phi, A_wo, B_x, B_w_gate, B_w_up, B_w_down):
    def _A_ref(x, wqkv, w_phi, wo):
        B, S, D = x.shape
        H = 16; Dh = D // H
        qkv = (lambda x, *d: x.permute(*d))((x @ wqkv).reshape(B, S, 3, H, Dh), 2, 0, 3, 1, 4)
        q, k, v = qkv[0], qkv[1], qkv[2]
        pq = torch.einsum("bhsd,hdf->bhsf", q, w_phi)
        pk = torch.einsum("bhsd,hdf->bhsf", k, w_phi)
        phi_q = torch.concatenate([_softmax(pq, axis=-1), _softmax(-pq, axis=-1)], axis=-1)
        phi_k = torch.concatenate([_softmax(pk, axis=-1), _softmax(-pk, axis=-1)], axis=-1)
        kv = torch.einsum("bhsf,bhsd->bhfd", phi_k, v)
        z  = torch.einsum("bhsf->bhf", phi_k)
        num = torch.einsum("bhqf,bhfd->bhqd", phi_q, kv)
        den = torch.einsum("bhqf,bhf->bhq", phi_q, z)[..., None] + 1e-6
        o = num / den
        return (lambda x, *d: x.permute(*d))(o, 0, 2, 1, 3).reshape(B, S, D) @ wo

    def _B_ref(x, w_gate, w_up, w_down):
        g = torch.einsum("bsd,df->bsf", x, w_gate)
        u = torch.einsum("bsd,df->bsf", x, w_up)
        h = _gelu(g) * u
        return torch.einsum("bsf,fd->bsd", h, w_down)

    x = A_x
    xn = _layernorm(x, axis=-1)
    return x + _A_ref(xn, A_wqkv, A_w_phi, A_wo) + _B_ref(xn, B_w_gate, B_w_up, B_w_down)
```

```asm
; @launch grid=(256,1,1) block=(512,1,1) lds=163840
.amdgcn_target "amdgcn-amd-amdhsa--gfx950"
.text
.globl parallel_sum__linear_kernel_hedgehog__glu_gated_geglu__prompt_kernel
.p2align 8
.type parallel_sum__linear_kernel_hedgehog__glu_gated_geglu__prompt_kernel,@function
parallel_sum__linear_kernel_hedgehog__glu_gated_geglu__prompt_kernel:
  s_load_dwordx16 s[4:19], s[0:1], 0
  s_cmp_ge_u32 s2, 256
  s_cbranch_scc1 L_end
  v_readfirstlane_b32 s36, v0
  v_bfe_u32 v248, v0, 3, 5
  s_lshr_b32 s41, s2, 5
  v_and_b32 v250, 7, v0
  s_bfe_u32 s48, s2, 0x20003
  v_mul_u32_u24 v254, 896, v248
  s_and_b32 s40, s2, 6
  v_lshl_add_u32 v254, v250, 4, v254
  s_lshl1_add_u32 s40, s40, s48
  s_lshr_b32 s55, s36, 8
  s_add_u32 s55, s55, s41
  s_and_b32 s55, s55, 3
  s_lshl2_add_u32 s47, s40, s55
  s_mul_i32 s54, s47, 28672
  s_xor_b32 s47, s47, 2
  s_mul_i32 s47, s47, 28672
  v_add_u32 v252, s54, v254
  v_add_u32 v254, s47, v254
  s_mov_b32 s58, 0x06543210
  s_mov_b32 s59, 0x654321
  s_lshl_b32 s47, s48, 3
  s_lshr_b64 s[58:59], s[58:59], s47
  s_bfe_u32 s60, s58, 0x40000
  s_lshl_b32 s88, s60, 7
  s_bfe_u32 s61, s58, 0x40004
  s_lshl_b32 s89, s61, 7
  s_bfe_u32 s63, s58, 0x4000c
  s_lshl_b32 s90, s63, 7
  s_bfe_u32 s65, s58, 0x40014
  s_lshl_b32 s91, s65, 7
  s_lshr_b32 s36, s36, 6
  s_cmp_lg_u32 s36, 7
  s_cbranch_scc1 L_nopf
  s_getpc_b64 s[80:81]
  v_and_b32 v12, 31, v0
  s_and_b32 s47, s2, 0xf8
  v_lshl_add_u32 v12, s47, 2, v12
  v_lshlrev_b32 v12, 7, v12
  v_min_u32 v12, L_code_end-parallel_sum__linear_kernel_hedgehog__glu_gated_geglu__prompt_kernel-1024, v12
  global_load_dword v10, v12, s[80:81]
L_nopf:
  s_waitcnt lgkmcnt(0)
  s_mov_b64 s[82:83], s[6:7]
  s_mov_b32 s6, 1835008
  s_mov_b32 s7, 0x20000
  buffer_load_dwordx4 v[128:131], v252, s[4:7], s88 offen offset:0
  s_load_dwordx2 s[28:29], s[0:1], 64
  s_load_dwordx2 s[32:33], s[0:1], 80
  s_cmp_eq_u32 s41, 7
  s_cbranch_scc1 L_Q
  s_cmp_ge_u32 s36, 4
  s_cbranch_scc1 L_F1
  buffer_load_dwordx4 v[132:135], v252, s[4:7], s89 offen offset:0
  buffer_load_dwordx4 v[136:139], v252, s[4:7], s89 offen offset:128
  buffer_load_dwordx4 v[140:143], v252, s[4:7], s90 offen offset:0
  buffer_load_dwordx4 v[144:147], v252, s[4:7], s90 offen offset:128
  buffer_load_dwordx4 v[148:151], v252, s[4:7], s91 offen offset:0
  buffer_load_dwordx4 v[152:155], v252, s[4:7], s91 offen offset:128
  s_and_b32 s37, s36, 3
  v_and_b32 v15, 63, v0
  s_lshl_b32 s38, s37, 10
  s_and_b32 s39, s2, 1
  s_lshl3_add_u32 s42, s39, s41
  s_mul_i32 s54, s42, 56
  s_and_b32 s57, s54, 15
  s_sub_u32 s54, s54, s57
  s_add_u32 s54, s54, 896
  s_add_u32 s62, s61, 1
  v_mov_b32 v208, 0x3f803f80
  v_mov_b32 v209, 0x3f803f80
  s_add_u32 s64, s63, 1
  v_mov_b32 v210, 0x3b124925
  v_bfe_u32 v240, v15, 4, 1
  s_add_u32 s66, s65, 1
  v_and_b32 v241, 3, v15
  v_bfe_u32 v242, v15, 2, 2
  s_mul_i32 s60, s60, 172032
  v_lshrrev_b32 v243, 5, v15
  v_mov_b32 v212, 0xffff
  s_mul_i32 s61, s61, 172032
  v_mov_b32 v213, 0
  v_lshlrev_b32 v11, 4, v241
  s_mul_i32 s62, s62, 172032
  v_lshlrev_b64 v[212:213], v11, v[212:213]
  v_lshlrev_b32 v1, 4, v15
  s_mul_i32 s63, s63, 172032
  v_xor_b32 v14, v248, v250
  v_lshlrev_b32 v224, 4, v14
  s_mul_i32 s64, s64, 172032
  v_lshrrev_b32 v14, 1, v250
  v_lshl_add_u32 v224, v14, 12, v224
  s_mul_i32 s65, s65, 172032
  v_and_b32 v14, 1, v250
  v_lshl_add_u32 v224, v14, 9, v224
  s_mul_i32 s66, s66, 172032
  v_lshl_add_u32 v224, s55, 10, v224
  v_add_u32 v225, 0x10000, v224
  s_mov_b64 s[84:85], s[14:15]
  v_xor_b32 v226, 2048, v224
  s_mov_b64 s[86:87], s[16:17]
  v_xor_b32 v227, 2048, v225
  v_xor_b32 v249, v242, v240
  s_mov_b64 s[24:25], s[18:19]
  v_and_b32 v249, 1, v249
  v_mul_u32_u24 v2, 2688, v248
  s_mov_b64 s[16:17], s[10:11]
  v_mul_u32_u24 v14, 896, v249
  v_add3_u32 v2, v2, v14, s54
  s_mov_b64 s[12:13], s[8:9]
  v_add_u32 v2, v11, v2
  v_xor_b32 v14, v243, v15
  s_mov_b64 s[8:9], s[82:83]
  v_lshl_add_u32 v244, v14, 4, s38
  v_xor_b32 v245, 32, v244
  s_mov_b32 s10, 1204224
  v_xor_b32 v246, 64, v244
  v_xor_b32 v247, 96, v244
  s_mov_b32 s11, 0x20000
  v_lshl_add_u32 v11, v240, 2, v241
  v_lshl_add_u32 v11, v11, 3, s57
  s_mov_b32 s34, 268435456
  v_and_b32 v11, 63, v11
  v_lshrrev_b32 v12, 1, v242
  s_mov_b32 s35, 0x20000
  v_xor_b32 v12, 0, v12
  v_lshl_add_u32 v11, v12, 6, v11
  s_mov_b32 s14, 25088
  v_lshl_add_u32 v11, v242, 7, v11
  v_lshl_add_u32 v220, v243, 10, v11
  s_mov_b32 s15, 0x20000
  v_add_u32 v220, 98304, v220
  s_mul_i32 s51, s42, 1568
  s_add_u32 s51, s51, s38
  s_cmp_ge_u32 s37, 2
  s_cselect_b32 s51, 0x1000000, s51
  s_bitcmp1_b32 s36, 0
  s_cselect_b32 s20, s86, s84
  s_cselect_b32 s21, s87, s85
  s_mov_b32 s22, 1605632
  s_mov_b32 s23, 0x20000
  v_lshrrev_b32 v11, 3, v15
  s_and_b32 s54, s37, 2
  v_lshl_add_u32 v11, s54, 2, v11
  v_mul_u32_u24 v3, 3584, v11
  v_bfe_u32 v11, v15, 1, 2
  s_and_b32 s54, s36, 1
  v_lshl_add_u32 v12, s54, 1, v240
  v_xor_b32 v11, v11, v12
  v_lshl_add_u32 v3, v11, 5, v3
  v_and_b32 v11, 16, v1
  s_mul_i32 s55, s39, 7
  s_add_u32 s92, s55, s41
  s_lshl_b32 s54, s92, 8
  v_add3_u32 v3, v3, v11, s54
  s_mov_b32 s18, 401408
  s_mov_b32 s19, 0x20000
  s_mov_b32 s26, 1605632
  s_mov_b32 s27, 0x20000
  s_waitcnt lgkmcnt(0)
  s_load_dword s44, s[32:33], 0
  v_lshrrev_b32 v11, 1, v242
  v_lshl_add_u32 v11, v240, 1, v11
  v_xor_b32 v11, 0, v11
  v_lshlrev_b32 v11, 5, v11
  v_lshl_add_u32 v11, v241, 3, v11
  v_lshl_add_u32 v11, v242, 7, v11
  v_lshl_add_u32 v11, v240, 10, v11
  v_lshl_add_u32 v6, v243, 11, v11
  v_xor_b32 v7, 32, v6
  s_lshl2_add_u32 s50, s40, s37
  v_mov_b32 v8, 0xc0135761
  v_lshlrev_b32 v12, 4, v241
  s_mul_i32 s50, s50, 147456
  v_lshl_add_u32 v12, v249, 6, v12
  s_add_u32 s50, s50, 8388608
  v_lshl_add_u32 v12, s41, 7, v12
  s_mul_i32 s55, s39, 7
  v_mul_u32_u24 v4, 896, v248
  s_add_u32 s56, s55, 7
  v_add_u32 v4, v4, v12
  s_lshr_b32 s54, s37, 1
  s_and_b32 s52, s40, 3
  s_mul_i32 s54, s54, 14
  s_lshl_b32 s52, s52, 1
  v_add_u32 v14, s54, v243
  s_max_u32 s52, s52, 1
  v_mul_u32_u24 v14, 1792, v14
  s_add_u32 s93, s92, s52
  s_cmp_ge_u32 s93, s56
  s_cselect_b32 s46, 7, 0
  s_sub_u32 s93, s93, s46
  v_add_u32 v5, v14, v12
  v_and_b32 v11, 1, v241
  s_add_u32 s94, s93, s52
  s_cmp_ge_u32 s94, s56
  s_cselect_b32 s46, 7, 0
  s_sub_u32 s94, s94, s46
  v_lshlrev_b32 v11, 2, v11
  s_add_u32 s95, s94, s52
  s_cmp_ge_u32 s95, s56
  s_cselect_b32 s46, 7, 0
  s_sub_u32 s95, s95, s46
  v_lshl_add_u32 v11, v240, 1, v11
  s_add_u32 s96, s95, s52
  s_cmp_ge_u32 s96, s56
  s_cselect_b32 s46, 7, 0
  s_sub_u32 s96, s96, s46
  v_lshrrev_b32 v12, 1, v241
  s_add_u32 s97, s96, s52
  s_cmp_ge_u32 s97, s56
  s_cselect_b32 s46, 7, 0
  s_sub_u32 s97, s97, s46
  v_add_lshl_u32 v11, v11, v12, 3
  v_lshl_add_u32 v11, v242, 7, v11
  s_add_u32 s98, s97, s52
  s_cmp_ge_u32 s98, s56
  s_cselect_b32 s46, 7, 0
  s_sub_u32 s98, s98, s46
  v_lshl_add_u32 v11, v243, 9, v11
  s_mov_b32 s30, 1835008
  v_lshrrev_b32 v12, 1, v242
  s_mov_b32 s31, 0x20000
  v_lshl_add_u32 v251, v12, 6, v11
  v_lshl_add_u32 v11, v243, 2, v242
  v_mul_u32_u24 v11, 56, v11
  v_lshl_add_u32 v12, v240, 2, v241
  v_lshl_add_u32 v221, v12, 3, v11
  v_lshl_add_u32 v9, v243, 18, v221
  v_and_b32 v11, 1, v15
  v_bfe_u32 v12, v15, 1, 1
  v_lshl_add_u32 v11, v12, 2, v11
  v_bfe_u32 v12, v15, 2, 1
  v_xor_b32 v12, v12, v243
  v_lshl_add_u32 v11, v12, 1, v11
  v_and_b32 v12, 31, v15
  v_lshl_add_u32 v12, s37, 5, v12
  v_lshlrev_b32 v12, 7, v12
  v_lshl_add_u32 v223, v11, 4, v12
  s_setprio 1
  s_waitcnt vmcnt(6)
  v_mfma_f32_4x4x4_16b_bf16 v[192:195], v[208:209], v[128:129], 0
  v_mfma_f32_4x4x4_16b_bf16 v[196:199], v[128:129], v[128:129], 0
  v_mfma_f32_4x4x4_16b_bf16 v[200:203], v[208:209], v[130:131], 0
  v_mfma_f32_4x4x4_16b_bf16 v[204:207], v[130:131], v[130:131], 0
  s_waitcnt vmcnt(5)
  v_mfma_f32_4x4x4_16b_bf16 v[192:195], v[208:209], v[132:133], v[192:195]
  v_mfma_f32_4x4x4_16b_bf16 v[196:199], v[132:133], v[132:133], v[196:199]
  v_mfma_f32_4x4x4_16b_bf16 v[200:203], v[208:209], v[134:135], v[200:203]
  v_mfma_f32_4x4x4_16b_bf16 v[204:207], v[134:135], v[134:135], v[204:207]
  s_waitcnt vmcnt(4)
  v_mfma_f32_4x4x4_16b_bf16 v[192:195], v[208:209], v[136:137], v[192:195]
  v_mfma_f32_4x4x4_16b_bf16 v[196:199], v[136:137], v[136:137], v[196:199]
  v_mfma_f32_4x4x4_16b_bf16 v[200:203], v[208:209], v[138:139], v[200:203]
  v_mfma_f32_4x4x4_16b_bf16 v[204:207], v[138:139], v[138:139], v[204:207]
  s_waitcnt vmcnt(3)
  v_mfma_f32_4x4x4_16b_bf16 v[192:195], v[208:209], v[140:141], v[192:195]
  v_mfma_f32_4x4x4_16b_bf16 v[196:199], v[140:141], v[140:141], v[196:199]
  v_mfma_f32_4x4x4_16b_bf16 v[200:203], v[208:209], v[142:143], v[200:203]
  v_mfma_f32_4x4x4_16b_bf16 v[204:207], v[142:143], v[142:143], v[204:207]
  s_waitcnt vmcnt(2)
  v_mfma_f32_4x4x4_16b_bf16 v[192:195], v[208:209], v[144:145], v[192:195]
  buffer_load_dwordx4 v[156:159], v254, s[4:7], s88 offen offset:0
  v_mfma_f32_4x4x4_16b_bf16 v[196:199], v[144:145], v[144:145], v[196:199]
  v_mfma_f32_4x4x4_16b_bf16 v[200:203], v[208:209], v[146:147], v[200:203]
  v_mfma_f32_4x4x4_16b_bf16 v[204:207], v[146:147], v[146:147], v[204:207]
  s_waitcnt vmcnt(2)
  v_mfma_f32_4x4x4_16b_bf16 v[192:195], v[208:209], v[148:149], v[192:195]
  buffer_load_dwordx4 v[160:163], v254, s[4:7], s89 offen offset:0
  v_mfma_f32_4x4x4_16b_bf16 v[196:199], v[148:149], v[148:149], v[196:199]
  v_mfma_f32_4x4x4_16b_bf16 v[200:203], v[208:209], v[150:151], v[200:203]
  v_mfma_f32_4x4x4_16b_bf16 v[204:207], v[150:151], v[150:151], v[204:207]
  s_waitcnt vmcnt(2)
  v_mfma_f32_4x4x4_16b_bf16 v[192:195], v[208:209], v[152:153], v[192:195]
  buffer_load_dwordx4 v[164:167], v254, s[4:7], s89 offen offset:128
  v_mfma_f32_4x4x4_16b_bf16 v[196:199], v[152:153], v[152:153], v[196:199]
  v_mfma_f32_4x4x4_16b_bf16 v[200:203], v[208:209], v[154:155], v[200:203]
  v_mfma_f32_4x4x4_16b_bf16 v[204:207], v[154:155], v[154:155], v[204:207]
  buffer_load_dwordx4 v[168:171], v254, s[4:7], s90 offen offset:0
  s_nop 3
  v_add_f32 v192, v192, v200
  v_add_f32 v196, v196, v204
  v_add_f32 v197, v197, v205
  v_add_f32 v198, v198, v206
  v_add_f32 v199, v199, v207
  v_add_f32_dpp v216, v192, v192 quad_perm:[1,0,3,2] row_mask:0xf bank_mask:0xf
  v_mov_b32_dpp v217, v196 quad_perm:[0,0,0,0] row_mask:0xf bank_mask:0xf
  v_mov_b32_dpp v218, v197 quad_perm:[1,1,1,1] row_mask:0xf bank_mask:0xf
  v_add_f32_dpp v216, v216, v216 quad_perm:[2,3,0,1] row_mask:0xf bank_mask:0xf
  v_add_f32_dpp v217, v198, v217 quad_perm:[2,2,2,2] row_mask:0xf bank_mask:0xf
  v_add_f32_dpp v218, v199, v218 quad_perm:[3,3,3,3] row_mask:0xf bank_mask:0xf
  v_add_f32_dpp v216, v216, v216 row_half_mirror row_mask:0xf bank_mask:0xf
  v_add_f32 v217, v217, v218
  v_mul_f32 v216, 0xbb124925, v216
  v_mul_f32 v218, v216, v216
  v_add_f32_dpp v217, v217, v217 row_half_mirror row_mask:0xf bank_mask:0xf
  buffer_load_dwordx4 v[172:175], v254, s[4:7], s90 offen offset:128
  v_fma_f32 v217, v217, v210, -v218
  v_max_f32 v217, 0, v217
  v_add_f32 v217, 0x3727c5ac, v217
  v_rsq_f32 v217, v217
  s_nop 0
  v_cvt_pk_bf16_f32 v218, v217, v217
  v_and_b32 v184, v212, v218
  v_and_b32 v185, v213, v218
  v_and_b32 v218, 0xffff0000, v218
  v_sub_f32 v218, v217, v218
  v_cvt_pk_bf16_f32 v218, v218, v218
  v_and_b32 v186, v212, v218
  v_and_b32 v187, v213, v218
  v_mul_f32 v188, v216, v217
  v_mul_f32 v189, v216, v217
  v_mul_f32 v190, v216, v217
  v_mul_f32 v191, v216, v217
  s_nop 1
  v_mfma_f32_4x4x4_16b_bf16 v[16:19], v[184:185], v[128:129], v[188:191]
  v_mfma_f32_4x4x4_16b_bf16 v[20:23], v[184:185], v[130:131], v[188:191]
  v_mfma_f32_4x4x4_16b_bf16 v[24:27], v[184:185], v[132:133], v[188:191]
  v_mfma_f32_4x4x4_16b_bf16 v[16:19], v[186:187], v[128:129], v[16:19]
  v_mfma_f32_4x4x4_16b_bf16 v[20:23], v[186:187], v[130:131], v[20:23]
  v_mfma_f32_4x4x4_16b_bf16 v[28:31], v[184:185], v[134:135], v[188:191]
  s_nop 3
  v_cvt_pk_bf16_f32 v128, v16, v17
  v_mfma_f32_4x4x4_16b_bf16 v[24:27], v[186:187], v[132:133], v[24:27]
  v_cvt_pk_bf16_f32 v129, v18, v19
  v_mfma_f32_4x4x4_16b_bf16 v[32:35], v[184:185], v[136:137], v[188:191]
  v_cvt_pk_bf16_f32 v130, v20, v21
  v_mfma_f32_4x4x4_16b_bf16 v[28:31], v[186:187], v[134:135], v[28:31]
  v_cvt_pk_bf16_f32 v131, v22, v23
  ds_write_b128 v224, v[128:131] offset:0
  buffer_load_dwordx4 v[176:179], v254, s[4:7], s91 offen offset:0
  v_mfma_f32_4x4x4_16b_bf16 v[36:39], v[184:185], v[138:139], v[188:191]
  v_cvt_pk_bf16_f32 v132, v24, v25
  v_mfma_f32_4x4x4_16b_bf16 v[32:35], v[186:187], v[136:137], v[32:35]
  v_cvt_pk_bf16_f32 v133, v26, v27
  v_mfma_f32_4x4x4_16b_bf16 v[40:43], v[184:185], v[140:141], v[188:191]
  v_cvt_pk_bf16_f32 v134, v28, v29
  v_mfma_f32_4x4x4_16b_bf16 v[36:39], v[186:187], v[138:139], v[36:39]
  v_cvt_pk_bf16_f32 v135, v30, v31
  ds_write_b128 v224, v[132:135] offset:16384
  buffer_load_dwordx4 v[180:183], v254, s[4:7], s91 offen offset:128
  v_mfma_f32_4x4x4_16b_bf16 v[44:47], v[184:185], v[142:143], v[188:191]
  v_cvt_pk_bf16_f32 v136, v32, v33
  v_mfma_f32_4x4x4_16b_bf16 v[40:43], v[186:187], v[140:141], v[40:43]
  v_cvt_pk_bf16_f32 v137, v34, v35
  v_mfma_f32_4x4x4_16b_bf16 v[48:51], v[184:185], v[144:145], v[188:191]
  v_cvt_pk_bf16_f32 v138, v36, v37
  v_mfma_f32_4x4x4_16b_bf16 v[44:47], v[186:187], v[142:143], v[44:47]
  v_cvt_pk_bf16_f32 v139, v38, v39
  ds_write_b128 v224, v[136:139] offset:32768
  v_mfma_f32_4x4x4_16b_bf16 v[52:55], v[184:185], v[146:147], v[188:191]
  v_cvt_pk_bf16_f32 v140, v40, v41
  v_mfma_f32_4x4x4_16b_bf16 v[48:51], v[186:187], v[144:145], v[48:51]
  v_cvt_pk_bf16_f32 v141, v42, v43
  v_mfma_f32_4x4x4_16b_bf16 v[56:59], v[184:185], v[148:149], v[188:191]
  v_cvt_pk_bf16_f32 v142, v44, v45
  v_mfma_f32_4x4x4_16b_bf16 v[52:55], v[186:187], v[146:147], v[52:55]
  v_cvt_pk_bf16_f32 v143, v46, v47
  ds_write_b128 v224, v[140:143] offset:49152
  v_mfma_f32_4x4x4_16b_bf16 v[60:63], v[184:185], v[150:151], v[188:191]
  v_cvt_pk_bf16_f32 v144, v48, v49
  v_mfma_f32_4x4x4_16b_bf16 v[56:59], v[186:187], v[148:149], v[56:59]
  v_cvt_pk_bf16_f32 v145, v50, v51
  v_mfma_f32_4x4x4_16b_bf16 v[64:67], v[184:185], v[152:153], v[188:191]
  v_cvt_pk_bf16_f32 v146, v52, v53
  v_mfma_f32_4x4x4_16b_bf16 v[60:63], v[186:187], v[150:151], v[60:63]
  v_cvt_pk_bf16_f32 v147, v54, v55
  ds_write_b128 v225, v[144:147] offset:0
  v_mfma_f32_4x4x4_16b_bf16 v[68:71], v[184:185], v[154:155], v[188:191]
  v_cvt_pk_bf16_f32 v148, v56, v57
  v_mfma_f32_4x4x4_16b_bf16 v[64:67], v[186:187], v[152:153], v[64:67]
  v_cvt_pk_bf16_f32 v149, v58, v59
  v_cvt_pk_bf16_f32 v150, v60, v61
  v_mfma_f32_4x4x4_16b_bf16 v[68:71], v[186:187], v[154:155], v[68:71]
  v_cvt_pk_bf16_f32 v151, v62, v63
  ds_write_b128 v225, v[148:151] offset:16384
  s_nop 0
  v_cvt_pk_bf16_f32 v152, v64, v65
  v_cvt_pk_bf16_f32 v153, v66, v67
  s_nop 0
  v_cvt_pk_bf16_f32 v154, v68, v69
  v_cvt_pk_bf16_f32 v155, v70, v71
  ds_write_b128 v225, v[152:155] offset:32768
  s_setprio 0
  s_waitcnt vmcnt(6)
  v_mfma_f32_4x4x4_16b_bf16 v[192:195], v[208:209], v[156:157], 0
  v_mfma_f32_4x4x4_16b_bf16 v[196:199], v[156:157], v[156:157], 0
  v_mfma_f32_4x4x4_16b_bf16 v[200:203], v[208:209], v[158:159], 0
  v_mfma_f32_4x4x4_16b_bf16 v[204:207], v[158:159], v[158:159], 0
  s_waitcnt vmcnt(5)
  v_mfma_f32_4x4x4_16b_bf16 v[192:195], v[208:209], v[160:161], v[192:195]
  s_add_u32 m0, s38, 114688
  s_add_u32 s46, s60, 0
  buffer_load_dwordx4 v2, s[8:11], s46 offen lds
  v_mfma_f32_4x4x4_16b_bf16 v[196:199], v[160:161], v[160:161], v[196:199]
  v_mfma_f32_4x4x4_16b_bf16 v[200:203], v[208:209], v[162:163], v[200:203]
  v_mfma_f32_4x4x4_16b_bf16 v[204:207], v[162:163], v[162:163], v[204:207]
  s_waitcnt vmcnt(5)
  v_mfma_f32_4x4x4_16b_bf16 v[192:195], v[208:209], v[164:165], v[192:195]
  v_mfma_f32_4x4x4_16b_bf16 v[196:199], v[164:165], v[164:165], v[196:199]
  v_mfma_f32_4x4x4_16b_bf16 v[200:203], v[208:209], v[166:167], v[200:203]
  v_mfma_f32_4x4x4_16b_bf16 v[204:207], v[166:167], v[166:167], v[204:207]
  s_waitcnt vmcnt(4)
  v_mfma_f32_4x4x4_16b_bf16 v[192:195], v[208:209], v[168:169], v[192:195]
  v_mfma_f32_4x4x4_16b_bf16 v[196:199], v[168:169], v[168:169], v[196:199]
  v_mfma_f32_4x4x4_16b_bf16 v[200:203], v[208:209], v[170:171], v[200:203]
  v_mfma_f32_4x4x4_16b_bf16 v[204:207], v[170:171], v[170:171], v[204:207]
  s_waitcnt vmcnt(3)
  v_mfma_f32_4x4x4_16b_bf16 v[192:195], v[208:209], v[172:173], v[192:195]
  v_mfma_f32_4x4x4_16b_bf16 v[196:199], v[172:173], v[172:173], v[196:199]
  v_mfma_f32_4x4x4_16b_bf16 v[200:203], v[208:209], v[174:175], v[200:203]
  v_mfma_f32_4x4x4_16b_bf16 v[204:207], v[174:175], v[174:175], v[204:207]
  s_waitcnt vmcnt(2)
  v_mfma_f32_4x4x4_16b_bf16 v[192:195], v[208:209], v[176:177], v[192:195]
  s_add_u32 m0, s38, 122880
  s_add_u32 s46, s61, 0
  buffer_load_dwordx4 v2, s[8:11], s46 offen lds
  v_mfma_f32_4x4x4_16b_bf16 v[196:199], v[176:177], v[176:177], v[196:199]
  v_mfma_f32_4x4x4_16b_bf16 v[200:203], v[208:209], v[178:179], v[200:203]
  v_mfma_f32_4x4x4_16b_bf16 v[204:207], v[178:179], v[178:179], v[204:207]
  s_waitcnt vmcnt(2)
  v_mfma_f32_4x4x4_16b_bf16 v[192:195], v[208:209], v[180:181], v[192:195]
  v_mfma_f32_4x4x4_16b_bf16 v[196:199], v[180:181], v[180:181], v[196:199]
  v_mfma_f32_4x4x4_16b_bf16 v[200:203], v[208:209], v[182:183], v[200:203]
  v_mfma_f32_4x4x4_16b_bf16 v[204:207], v[182:183], v[182:183], v[204:207]
  s_nop 4
  v_add_f32 v192, v192, v200
  v_add_f32 v196, v196, v204
  v_add_f32 v197, v197, v205
  v_add_f32 v198, v198, v206
  v_add_f32 v199, v199, v207
  v_add_f32_dpp v216, v192, v192 quad_perm:[1,0,3,2] row_mask:0xf bank_mask:0xf
  v_mov_b32_dpp v217, v196 quad_perm:[0,0,0,0] row_mask:0xf bank_mask:0xf
  v_mov_b32_dpp v218, v197 quad_perm:[1,1,1,1] row_mask:0xf bank_mask:0xf
  v_add_f32_dpp v216, v216, v216 quad_perm:[2,3,0,1] row_mask:0xf bank_mask:0xf
  v_add_f32_dpp v217, v198, v217 quad_perm:[2,2,2,2] row_mask:0xf bank_mask:0xf
  v_add_f32_dpp v218, v199, v218 quad_perm:[3,3,3,3] row_mask:0xf bank_mask:0xf
  v_add_f32_dpp v216, v216, v216 row_half_mirror row_mask:0xf bank_mask:0xf
  v_add_f32 v217, v217, v218
  v_mul_f32 v216, 0xbb124925, v216
  v_mul_f32 v218, v216, v216
  v_add_f32_dpp v217, v217, v217 row_half_mirror row_mask:0xf bank_mask:0xf
  v_fma_f32 v217, v217, v210, -v218
  v_max_f32 v217, 0, v217
  v_add_f32 v217, 0x3727c5ac, v217
  v_rsq_f32 v217, v217
  s_nop 0
  v_cvt_pk_bf16_f32 v218, v217, v217
  v_and_b32 v184, v212, v218
  v_and_b32 v185, v213, v218
  v_and_b32 v218, 0xffff0000, v218
  v_sub_f32 v218, v217, v218
  v_cvt_pk_bf16_f32 v218, v218, v218
  v_and_b32 v186, v212, v218
  v_and_b32 v187, v213, v218
  v_mul_f32 v188, v216, v217
  v_mul_f32 v189, v216, v217
  v_mul_f32 v190, v216, v217
  v_mul_f32 v191, v216, v217
  s_nop 1
  v_mfma_f32_4x4x4_16b_bf16 v[72:75], v[184:185], v[156:157], v[188:191]
  v_mfma_f32_4x4x4_16b_bf16 v[76:79], v[184:185], v[158:159], v[188:191]
  v_mfma_f32_4x4x4_16b_bf16 v[80:83], v[184:185], v[160:161], v[188:191]
  v_mfma_f32_4x4x4_16b_bf16 v[72:75], v[186:187], v[156:157], v[72:75]
  v_mfma_f32_4x4x4_16b_bf16 v[76:79], v[186:187], v[158:159], v[76:79]
  v_mfma_f32_4x4x4_16b_bf16 v[84:87], v[184:185], v[162:163], v[188:191]
  s_nop 3
  v_cvt_pk_bf16_f32 v156, v72, v73
  v_mfma_f32_4x4x4_16b_bf16 v[80:83], v[186:187], v[160:161], v[80:83]
  v_cvt_pk_bf16_f32 v157, v74, v75
  v_mfma_f32_4x4x4_16b_bf16 v[88:91], v[184:185], v[164:165], v[188:191]
  v_cvt_pk_bf16_f32 v158, v76, v77
  v_mfma_f32_4x4x4_16b_bf16 v[84:87], v[186:187], v[162:163], v[84:87]
  v_cvt_pk_bf16_f32 v159, v78, v79
  ds_write_b128 v226, v[156:159] offset:0
  v_mfma_f32_4x4x4_16b_bf16 v[92:95], v[184:185], v[166:167], v[188:191]
  v_cvt_pk_bf16_f32 v160, v80, v81
  v_mfma_f32_4x4x4_16b_bf16 v[88:91], v[186:187], v[164:165], v[88:91]
  v_cvt_pk_bf16_f32 v161, v82, v83
  v_mfma_f32_4x4x4_16b_bf16 v[96:99], v[184:185], v[168:169], v[188:191]
  v_cvt_pk_bf16_f32 v162, v84, v85
  v_mfma_f32_4x4x4_16b_bf16 v[92:95], v[186:187], v[166:167], v[92:95]
  v_cvt_pk_bf16_f32 v163, v86, v87
  ds_write_b128 v226, v[160:163] offset:16384
  s_add_u32 m0, s38, 131072
  s_add_u32 s46, s62, 0
  buffer_load_dwordx4 v2, s[8:11], s46 offen lds
  v_mfma_f32_4x4x4_16b_bf16 v[100:103], v[184:185], v[170:171], v[188:191]
  v_cvt_pk_bf16_f32 v164, v88, v89
  v_mfma_f32_4x4x4_16b_bf16 v[96:99], v[186:187], v[168:169], v[96:99]
  v_cvt_pk_bf16_f32 v165, v90, v91
  v_mfma_f32_4x4x4_16b_bf16 v[104:107], v[184:185], v[172:173], v[188:191]
  v_cvt_pk_bf16_f32 v166, v92, v93
  v_mfma_f32_4x4x4_16b_bf16 v[100:103], v[186:187], v[170:171], v[100:103]
  v_cvt_pk_bf16_f32 v167, v94, v95
  ds_write_b128 v226, v[164:167] offset:32768
  v_mfma_f32_4x4x4_16b_bf16 v[108:111], v[184:185], v[174:175], v[188:191]
  v_cvt_pk_bf16_f32 v168, v96, v97
  v_mfma_f32_4x4x4_16b_bf16 v[104:107], v[186:187], v[172:173], v[104:107]
  v_cvt_pk_bf16_f32 v169, v98, v99
  v_mfma_f32_4x4x4_16b_bf16 v[112:115], v[184:185], v[176:177], v[188:191]
  v_cvt_pk_bf16_f32 v170, v100, v101
  v_mfma_f32_4x4x4_16b_bf16 v[108:111], v[186:187], v[174:175], v[108:111]
  v_cvt_pk_bf16_f32 v171, v102, v103
  ds_write_b128 v226, v[168:171] offset:49152
  v_mfma_f32_4x4x4_16b_bf16 v[116:119], v[184:185], v[178:179], v[188:191]
  v_cvt_pk_bf16_f32 v172, v104, v105
  v_mfma_f32_4x4x4_16b_bf16 v[112:115], v[186:187], v[176:177], v[112:115]
  v_cvt_pk_bf16_f32 v173, v106, v107
  v_mfma_f32_4x4x4_16b_bf16 v[120:123], v[184:185], v[180:181], v[188:191]
  v_cvt_pk_bf16_f32 v174, v108, v109
  v_mfma_f32_4x4x4_16b_bf16 v[116:119], v[186:187], v[178:179], v[116:119]
  v_cvt_pk_bf16_f32 v175, v110, v111
  ds_write_b128 v227, v[172:175] offset:0
  s_add_u32 m0, s38, 135168
  s_add_u32 s46, s62, 86016
  buffer_load_dwordx4 v2, s[8:11], s46 offen lds
  v_mfma_f32_4x4x4_16b_bf16 v[124:127], v[184:185], v[182:183], v[188:191]
  v_cvt_pk_bf16_f32 v176, v112, v113
  v_mfma_f32_4x4x4_16b_bf16 v[120:123], v[186:187], v[180:181], v[120:123]
  v_cvt_pk_bf16_f32 v177, v114, v115
  v_cvt_pk_bf16_f32 v178, v116, v117
  v_mfma_f32_4x4x4_16b_bf16 v[124:127], v[186:187], v[182:183], v[124:127]
  v_cvt_pk_bf16_f32 v179, v118, v119
  ds_write_b128 v227, v[176:179] offset:16384
  s_nop 0
  v_cvt_pk_bf16_f32 v180, v120, v121
  v_cvt_pk_bf16_f32 v181, v122, v123
  s_nop 0
  v_cvt_pk_bf16_f32 v182, v124, v125
  v_cvt_pk_bf16_f32 v183, v126, v127
  ds_write_b128 v227, v[180:183] offset:32768
  s_add_u32 m0, s38, 139264
  s_add_u32 s46, s63, 0
  buffer_load_dwordx4 v2, s[8:11], s46 offen lds
  s_add_u32 m0, s38, 143360
  s_add_u32 s46, s63, 86016
  buffer_load_dwordx4 v2, s[8:11], s46 offen lds
  s_add_u32 m0, s38, 147456
  s_add_u32 s46, s64, 0
  buffer_load_dwordx4 v2, s[8:11], s46 offen lds
  s_add_u32 m0, s38, 151552
  s_add_u32 s46, s64, 86016
  buffer_load_dwordx4 v2, s[8:11], s46 offen lds
  s_add_u32 m0, s38, 155648
  s_add_u32 s46, s65, 0
  buffer_load_dwordx4 v2, s[8:11], s46 offen lds
  s_add_u32 m0, s38, 159744
  s_add_u32 s46, s65, 86016
  buffer_load_dwordx4 v2, s[8:11], s46 offen lds
  s_waitcnt vmcnt(8) lgkmcnt(0)
  s_barrier
  ds_read_b128 v[16:19], v244 offset:0
  ds_read_b64_tr_b16 v[192:193], v220 offset:16384
  ds_read_b64_tr_b16 v[194:195], v220 offset:16896
  ds_read_b128 v[20:23], v245 offset:4096
  ds_read_b64_tr_b16 v[196:197], v220 offset:18432
  ds_read_b64_tr_b16 v[198:199], v220 offset:18944
  ds_read_b128 v[24:27], v246 offset:8192
  ds_read_b64_tr_b16 v[200:201], v220 offset:20480
  ds_read_b64_tr_b16 v[202:203], v220 offset:20992
  ds_read_b128 v[28:31], v247 offset:12288
  ds_read_b64_tr_b16 v[204:205], v220 offset:22528
  ds_read_b64_tr_b16 v[206:207], v220 offset:23040
  ds_read_b64_tr_b16 v[208:209], v220 offset:24576
  ds_read_b64_tr_b16 v[210:211], v220 offset:25088
  s_waitcnt lgkmcnt(8)
  v_mfma_f32_32x32x16_bf16 v[160:175], v[192:195], v[16:19], 0
  ds_read_b128 v[32:35], v244 offset:16384
  s_mul_i32 s43, s44, 0x9E3779B1
  s_add_u32 s43, s43, 0x7F4A7C15
  ds_read_b64_tr_b16 v[212:213], v220 offset:26624
  ds_read_b64_tr_b16 v[214:215], v220 offset:27136
  v_mfma_f32_32x32x16_bf16 v[160:175], v[196:199], v[20:23], v[160:175]
  ds_read_b128 v[36:39], v245 offset:20480
  s_and_b32 s45, s44, 0xfff
  s_add_u32 s45, s45, 1
  ds_read_b64_tr_b16 v[192:193], v220 offset:28672
  ds_read_b64_tr_b16 v[194:195], v220 offset:29184
  s_waitcnt lgkmcnt(8)
  v_mfma_f32_32x32x16_bf16 v[160:175], v[200:203], v[24:27], v[160:175]
  ds_read_b128 v[40:43], v246 offset:24576
  s_lshl_b32 s45, s45, 16
  s_add_u32 s45, s45, s44
  ds_read_b64_tr_b16 v[196:197], v220 offset:30720
  ds_read_b64_tr_b16 v[198:199], v220 offset:31232
  s_waitcnt vmcnt(4)
  s_waitcnt lgkmcnt(8)
  v_mfma_f32_32x32x16_bf16 v[160:175], v[204:207], v[28:31], v[160:175]
  s_barrier
  v_mfma_f32_32x32x16_bf16 v[160:175], v[208:211], v[32:35], v[160:175]
  ds_read_b64_tr_b16 v[200:201], v220 offset:32768
  ds_read_b64_tr_b16 v[202:203], v220 offset:33280
  ds_read_b128 v[44:47], v247 offset:28672
  s_and_b32 s45, s45, 0x1fff0000
  s_or_b32 s45, s45, 0x40000000
  ds_read_b128 v[48:51], v244 offset:32768
  s_add_u32 m0, s38, 114688
  s_add_u32 s46, s66, 0
  buffer_load_dwordx4 v2, s[8:11], s46 offen lds
  ds_read_b64_tr_b16 v[204:205], v220 offset:34816
  ds_read_b64_tr_b16 v[206:207], v220 offset:35328
  s_waitcnt lgkmcnt(9)
  v_mfma_f32_32x32x16_bf16 v[160:175], v[212:215], v[36:39], v[160:175]
  ds_read_b128 v[52:55], v245 offset:36864
  s_add_u32 m0, s38, 118784
  s_add_u32 s46, s66, 86016
  buffer_load_dwordx4 v2, s[8:11], s46 offen lds
  ds_read_b64_tr_b16 v[208:209], v220 offset:36864
  ds_read_b64_tr_b16 v[210:211], v220 offset:37376
  s_waitcnt lgkmcnt(11)
  v_mfma_f32_32x32x16_bf16 v[160:175], v[192:195], v[40:43], v[160:175]
  ds_read_b128 v[56:59], v246 offset:40960
  s_bfe_u32 s60, s58, 0x40000
  s_mul_i32 s60, s60, 229376
  s_bfe_u32 s61, s58, 0x40004
  s_mul_i32 s61, s61, 229376
  s_bfe_u32 s62, s58, 0x40008
  s_mul_i32 s62, s62, 229376
  ds_read_b64_tr_b16 v[212:213], v220 offset:38912
  ds_read_b64_tr_b16 v[214:215], v220 offset:39424
  s_waitcnt lgkmcnt(10)
  s_waitcnt lgkmcnt(9)
  v_mfma_f32_32x32x16_bf16 v[160:175], v[196:199], v[44:47], v[160:175]
  ds_read_b128 v[60:63], v247 offset:45056
  s_bfe_u32 s63, s58, 0x4000c
  s_mul_i32 s63, s63, 229376
  s_bfe_u32 s64, s58, 0x40010
  s_mul_i32 s64, s64, 229376
  s_add_u32 m0, s38, 0
  s_add_u32 s46, s51, 0
  buffer_load_dwordx4 v1, s[12:15], s46 offen lds
  ds_read_b64_tr_b16 v[192:193], v220 offset:40960
  ds_read_b64_tr_b16 v[194:195], v220 offset:41472
  s_waitcnt lgkmcnt(11)
  v_mfma_f32_32x32x16_bf16 v[160:175], v[200:203], v[48:51], v[160:175]
  ds_read_b128 v[64:67], v244 offset:49152
  s_bfe_u32 s65, s58, 0x40014
  s_mul_i32 s65, s65, 229376
  s_bfe_u32 s66, s58, 0x40018
  s_mul_i32 s66, s66, 229376
  ds_read_b64_tr_b16 v[196:197], v220 offset:43008
  ds_read_b64_tr_b16 v[198:199], v220 offset:43520
  s_waitcnt vmcnt(5)
  s_waitcnt lgkmcnt(8)
  v_mfma_f32_32x32x16_bf16 v[160:175], v[204:207], v[52:55], v[160:175]
  s_barrier
  v_mfma_f32_32x32x16_bf16 v[160:175], v[208:211], v[56:59], v[160:175]
  ds_read_b64_tr_b16 v[200:201], v220 offset:45056
  ds_read_b64_tr_b16 v[202:203], v220 offset:45568
  ds_read_b128 v[68:71], v245 offset:53248
  s_add_u32 m0, s38, 8192
  s_add_u32 s46, s60, 0
  buffer_load_dwordx4 v3, s[20:23], s46 offen lds
  ds_read_b128 v[72:75], v246 offset:57344
  s_add_u32 m0, s38, 12288
  s_add_u32 s46, s60, 57344
  buffer_load_dwordx4 v3, s[20:23], s46 offen lds
  ds_read_b64_tr_b16 v[204:205], v220 offset:47104
  ds_read_b64_tr_b16 v[206:207], v220 offset:47616
  s_waitcnt lgkmcnt(9)
  v_mfma_f32_32x32x16_bf16 v[160:175], v[212:215], v[60:63], v[160:175]
  ds_read_b128 v[76:79], v247 offset:61440
  s_add_u32 m0, s38, 16384
  s_add_u32 s46, s60, 114688
  buffer_load_dwordx4 v3, s[20:23], s46 offen lds
  ds_read_b64_tr_b16 v[208:209], v220 offset:49152
  ds_read_b64_tr_b16 v[210:211], v220 offset:49664
  s_waitcnt lgkmcnt(11)
  v_mfma_f32_32x32x16_bf16 v[160:175], v[192:195], v[64:67], v[160:175]
  v_add_u32 v244, 65536, v244
  ds_read_b128 v[80:83], v244 offset:0
  s_add_u32 m0, s38, 20480
  s_add_u32 s46, s60, 172032
  buffer_load_dwordx4 v3, s[20:23], s46 offen lds
  ds_read_b64_tr_b16 v[212:213], v220 offset:51200
  ds_read_b64_tr_b16 v[214:215], v220 offset:51712
  s_waitcnt lgkmcnt(10)
  s_waitcnt lgkmcnt(9)
  v_mfma_f32_32x32x16_bf16 v[160:175], v[196:199], v[68:71], v[160:175]
  v_add_u32 v245, 65536, v245
  ds_read_b128 v[84:87], v245 offset:4096
  s_add_u32 m0, s38, 24576
  s_add_u32 s46, s61, 0
  buffer_load_dwordx4 v3, s[20:23], s46 offen lds
  ds_read_b64_tr_b16 v[192:193], v220 offset:53248
  ds_read_b64_tr_b16 v[194:195], v220 offset:53760
  s_waitcnt lgkmcnt(11)
  v_mfma_f32_32x32x16_bf16 v[160:175], v[200:203], v[72:75], v[160:175]
  v_add_u32 v246, 65536, v246
  ds_read_b128 v[88:91], v246 offset:8192
  s_add_u32 m0, s38, 28672
  s_add_u32 s46, s61, 57344
  buffer_load_dwordx4 v3, s[20:23], s46 offen lds
  ds_read_b64_tr_b16 v[196:197], v220 offset:55296
  ds_read_b64_tr_b16 v[198:199], v220 offset:55808
  s_waitcnt vmcnt(7)
  s_waitcnt lgkmcnt(8)
  v_mfma_f32_32x32x16_bf16 v[160:175], v[204:207], v[76:79], v[160:175]
  s_barrier
  v_mfma_f32_32x32x16_bf16 v[160:175], v[208:211], v[80:83], v[160:175]
  ds_read_b64_tr_b16 v[200:201], v220 offset:57344
  ds_read_b64_tr_b16 v[202:203], v220 offset:57856
  v_add_u32 v247, 65536, v247
  ds_read_b128 v[92:95], v247 offset:12288
  s_add_u32 m0, s38, 122880
  s_add_u32 s46, s61, 114688
  buffer_load_dwordx4 v3, s[20:23], s46 offen lds
  ds_read_b128 v[96:99], v244 offset:16384
  s_add_u32 m0, s38, 126976
  s_add_u32 s46, s61, 172032
  buffer_load_dwordx4 v3, s[20:23], s46 offen lds
  ds_read_b64_tr_b16 v[204:205], v220 offset:59392
  ds_read_b64_tr_b16 v[206:207], v220 offset:59904
  s_waitcnt lgkmcnt(9)
  v_mfma_f32_32x32x16_bf16 v[160:175], v[212:215], v[84:87], v[160:175]
  ds_read_b128 v[100:103], v245 offset:20480
  s_add_u32 m0, s38, 57344
  s_add_u32 s46, s62, 0
  buffer_load_dwordx4 v3, s[20:23], s46 offen lds
  ds_read_b64_tr_b16 v[208:209], v220 offset:61440
  ds_read_b64_tr_b16 v[210:211], v220 offset:61952
  s_waitcnt lgkmcnt(11)
  v_mfma_f32_32x32x16_bf16 v[160:175], v[192:195], v[88:91], v[160:175]
  ds_read_b128 v[104:107], v246 offset:24576
  s_add_u32 m0, s38, 61440
  s_add_u32 s46, s62, 57344
  buffer_load_dwordx4 v3, s[20:23], s46 offen lds
  ds_read_b64_tr_b16 v[212:213], v220 offset:63488
  ds_read_b64_tr_b16 v[214:215], v220 offset:64000
  s_waitcnt lgkmcnt(10)
  s_waitcnt lgkmcnt(9)
  v_mfma_f32_32x32x16_bf16 v[160:175], v[196:199], v[92:95], v[160:175]
  ds_read_b128 v[108:111], v247 offset:28672
  s_add_u32 m0, s38, 131072
  s_add_u32 s46, s62, 114688
  buffer_load_dwordx4 v3, s[20:23], s46 offen lds
  ds_read_b64_tr_b16 v[192:193], v220 offset:16384
  ds_read_b64_tr_b16 v[194:195], v220 offset:16896
  s_waitcnt lgkmcnt(11)
  v_mfma_f32_32x32x16_bf16 v[160:175], v[200:203], v[96:99], v[160:175]
  ds_read_b128 v[112:115], v244 offset:32768
  s_add_u32 m0, s38, 135168
  s_add_u32 s46, s62, 172032
  buffer_load_dwordx4 v3, s[20:23], s46 offen lds
  ds_read_b64_tr_b16 v[196:197], v220 offset:18432
  ds_read_b64_tr_b16 v[198:199], v220 offset:18944
  s_waitcnt vmcnt(8)
  s_waitcnt lgkmcnt(8)
  v_mfma_f32_32x32x16_bf16 v[160:175], v[204:207], v[100:103], v[160:175]
  s_barrier
  v_mfma_f32_32x32x16_bf16 v[160:175], v[208:211], v[104:107], v[160:175]
  ds_read_b64_tr_b16 v[200:201], v220 offset:20480
  ds_read_b64_tr_b16 v[202:203], v220 offset:20992
  ds_read_b128 v[116:119], v245 offset:36864
  s_add_u32 m0, s38, 139264
  s_add_u32 s46, s63, 0
  buffer_load_dwordx4 v3, s[20:23], s46 offen lds
  ds_read_b128 v[120:123], v246 offset:40960
  s_add_u32 m0, s38, 143360
  s_add_u32 s46, s63, 57344
  buffer_load_dwordx4 v3, s[20:23], s46 offen lds
  ds_read_b64_tr_b16 v[224:225], v221 offset:0
  ds_read_b64_tr_b16 v[226:227], v221 offset:448
  ds_read_b64_tr_b16 v[228:229], v221 offset:896
  ds_read_b64_tr_b16 v[230:231], v9 offset:1344
  v_lshl_add_u32 v14, s37, 11, v1
  ds_read_b64_tr_b16 v[204:205], v220 offset:22528
  ds_read_b64_tr_b16 v[206:207], v220 offset:23040
  s_waitcnt lgkmcnt(13)
  v_mfma_f32_32x32x16_bf16 v[160:175], v[212:215], v[108:111], v[160:175]
  ds_read_b128 v[124:127], v247 offset:45056
  s_add_u32 m0, s38, 65536
  s_add_u32 s46, s63, 114688
  buffer_load_dwordx4 v3, s[20:23], s46 offen lds
  ds_read_b64_tr_b16 v[208:209], v6 offset:8192
  ds_read_b64_tr_b16 v[210:211], v6 offset:8704
  s_waitcnt lgkmcnt(15)
  v_mfma_f32_32x32x16_bf16 v[160:175], v[192:195], v[112:115], v[160:175]
  v_mov_b32 v2, v251
  s_add_u32 m0, s38, 69632
  s_add_u32 s46, s63, 172032
  buffer_load_dwordx4 v3, s[20:23], s46 offen lds
  s_waitcnt lgkmcnt(8)
  v_mov_b32_dpp v224, v224 row_shr:2 row_mask:0xa bank_mask:0x8
  v_mov_b32_dpp v225, v225 row_shr:2 row_mask:0xa bank_mask:0x8
  ds_read_b64_tr_b16 v[212:213], v6 offset:12288
  ds_read_b64_tr_b16 v[214:215], v6 offset:12800
  v_mfma_f32_32x32x16_bf16 v[160:175], v[196:199], v[116:119], v[160:175]
  s_add_u32 m0, s38, 73728
  s_add_u32 s46, s64, 0
  buffer_load_dwordx4 v3, s[20:23], s46 offen lds
  s_waitcnt lgkmcnt(9)
  v_mov_b32_dpp v226, v226 row_shr:2 row_mask:0xa bank_mask:0x8
  v_mov_b32_dpp v227, v227 row_shr:2 row_mask:0xa bank_mask:0x8
  ds_read_b64_tr_b16 v[192:193], v6 offset:16384
  ds_read_b64_tr_b16 v[194:195], v6 offset:16896
  v_mfma_f32_32x32x16_bf16 v[160:175], v[200:203], v[120:123], v[160:175]
  s_add_u32 m0, s38, 77824
  s_add_u32 s46, s64, 57344
  buffer_load_dwordx4 v3, s[20:23], s46 offen lds
  s_waitcnt lgkmcnt(10)
  v_mov_b32_dpp v228, v228 row_shr:2 row_mask:0xa bank_mask:0x8
  v_mov_b32_dpp v229, v229 row_shr:2 row_mask:0xa bank_mask:0x8
  ds_read_b64_tr_b16 v[196:197], v6 offset:20480
  ds_read_b64_tr_b16 v[198:199], v6 offset:20992
  s_waitcnt vmcnt(8)
  s_waitcnt lgkmcnt(6)
  v_mfma_f32_32x32x16_bf16 v[160:175], v[204:207], v[124:127], v[160:175]
  s_barrier
  v_mfma_f32_32x32x16_bf16 v[128:143], v[208:211], v[16:19], 0
  ds_read_b64_tr_b16 v[200:201], v6 offset:24576
  ds_read_b64_tr_b16 v[202:203], v6 offset:25088
  s_add_u32 m0, s38, 81920
  s_add_u32 s46, s64, 114688
  buffer_load_dwordx4 v3, s[20:23], s46 offen lds
  v_mov_b32_dpp v230, v230 row_shr:2 row_mask:0xa bank_mask:0x8
  v_mov_b32_dpp v231, v231 row_shr:2 row_mask:0xa bank_mask:0x8
  s_add_u32 m0, s38, 86016
  s_add_u32 s46, s64, 172032
  buffer_load_dwordx4 v3, s[20:23], s46 offen lds
  ds_read_b64_tr_b16 v[204:205], v6 offset:28672
  ds_read_b64_tr_b16 v[206:207], v6 offset:29184
  s_waitcnt lgkmcnt(6)
  v_mfma_f32_32x32x16_bf16 v[128:143], v[212:215], v[20:23], v[128:143]
  v_cvt_pk_bf16_f32 v232, v160, v161
  v_cvt_pk_bf16_f32 v233, v162, v163
  v_cvt_pk_bf16_f32 v234, v164, v165
  v_cvt_pk_bf16_f32 v235, v166, v167
  v_cvt_pk_bf16_f32 v236, v168, v169
  v_cvt_pk_bf16_f32 v237, v170, v171
  v_cvt_pk_bf16_f32 v238, v172, v173
  v_cvt_pk_bf16_f32 v239, v174, v175
  v_mfma_f32_32x32x16_bf16 v[176:191], v[224:227], v[232:235], 0
  s_nop 0
  v_mfma_f32_32x32x16_bf16 v[176:191], v[228:231], v[236:239], v[176:191]
  v_add_u32 v6, 98304, v6
  ds_read_b64_tr_b16 v[208:209], v6 offset:24576
  ds_read_b64_tr_b16 v[210:211], v6 offset:25088
  v_mfma_f32_32x32x16_bf16 v[128:143], v[192:195], v[24:27], v[128:143]
  s_nop 7
  v_max3_f32 v216, v176, v177, v178
  v_min3_f32 v217, v176, v177, v178
  v_max3_f32 v216, v216, v179, v180
  v_min3_f32 v217, v217, v179, v180
  v_max3_f32 v216, v216, v181, v182
  v_min3_f32 v217, v217, v181, v182
  v_max3_f32 v216, v216, v183, v184
  v_min3_f32 v217, v217, v183, v184
  v_max3_f32 v216, v216, v185, v186
  v_min3_f32 v217, v217, v185, v186
  ds_read_b64_tr_b16 v[212:213], v6 offset:28672
  ds_read_b64_tr_b16 v[214:215], v6 offset:29184
  s_waitcnt lgkmcnt(6)
  v_mfma_f32_32x32x16_bf16 v[128:143], v[196:199], v[28:31], v[128:143]
  v_max3_f32 v216, v216, v187, v188
  v_min3_f32 v217, v217, v187, v188
  v_max_f32 v216, v216, v189
  v_min_f32 v217, v217, v189
  v_mov_b32 v218, v216
  v_mov_b32 v219, v217
  s_nop 0
  v_permlane32_swap_b32 v216, v218
  v_permlane32_swap_b32 v217, v219
  v_max_f32 v216, v216, v218
  v_min_f32 v217, v217, v219
  v_mul_f32 v216, 0xbfb8aa3b, v216
  v_add_u32 v6, 4294901760, v6
  ds_read_b64_tr_b16 v[192:193], v6 offset:24576
  ds_read_b64_tr_b16 v[194:195], v6 offset:25088
  v_mfma_f32_32x32x16_bf16 v[128:143], v[200:203], v[32:35], v[128:143]
  v_mul_f32 v217, 0x3fb8aa3b, v217
  v_fmamk_f32 v160, v176, 0x3fb8aa3b, v216
  v_fmamk_f32 v176, v176, 0xbfb8aa3b, v217
  v_exp_f32 v160, v160
  v_exp_f32 v176, v176
  v_fmamk_f32 v161, v177, 0x3fb8aa3b, v216
  v_fmamk_f32 v177, v177, 0xbfb8aa3b, v217
  v_exp_f32 v161, v161
  v_exp_f32 v177, v177
  ds_read_b64_tr_b16 v[196:197], v6 offset:28672
  ds_read_b64_tr_b16 v[198:199], v6 offset:29184
  s_waitcnt vmcnt(4)
  s_waitcnt lgkmcnt(6)
  v_mfma_f32_32x32x16_bf16 v[128:143], v[204:207], v[36:39], v[128:143]
  s_barrier
  v_mfma_f32_32x32x16_bf16 v[128:143], v[208:211], v[40:43], v[128:143]
  v_add_u32 v6, 65536, v6
  ds_read_b64_tr_b16 v[200:201], v6 offset:32768
  ds_read_b64_tr_b16 v[202:203], v6 offset:33280
  v_fmamk_f32 v162, v178, 0x3fb8aa3b, v216
  v_fmamk_f32 v178, v178, 0xbfb8aa3b, v217
  v_exp_f32 v162, v162
  v_exp_f32 v178, v178
  v_fmamk_f32 v163, v179, 0x3fb8aa3b, v216
  v_fmamk_f32 v179, v179, 0xbfb8aa3b, v217
  v_exp_f32 v163, v163
  v_exp_f32 v179, v179
  v_fmamk_f32 v164, v180, 0x3fb8aa3b, v216
  v_fmamk_f32 v180, v180, 0xbfb8aa3b, v217
  v_exp_f32 v164, v164
  v_exp_f32 v180, v180
  v_fmamk_f32 v165, v181, 0x3fb8aa3b, v216
  v_fmamk_f32 v181, v181, 0xbfb8aa3b, v217
  v_exp_f32 v165, v165
  ds_read_b64_tr_b16 v[204:205], v6 offset:36864
  ds_read_b64_tr_b16 v[206:207], v6 offset:37376
  s_waitcnt lgkmcnt(6)
  v_mfma_f32_32x32x16_bf16 v[128:143], v[212:215], v[44:47], v[128:143]
  v_exp_f32 v181, v181
  v_fmamk_f32 v166, v182, 0x3fb8aa3b, v216
  v_fmamk_f32 v182, v182, 0xbfb8aa3b, v217
  v_exp_f32 v166, v166
  v_exp_f32 v182, v182
  v_fmamk_f32 v167, v183, 0x3fb8aa3b, v216
  v_fmamk_f32 v183, v183, 0xbfb8aa3b, v217
  v_exp_f32 v167, v167
  ds_read_b64_tr_b16 v[208:209], v6 offset:40960
  ds_read_b64_tr_b16 v[210:211], v6 offset:41472
  v_mfma_f32_32x32x16_bf16 v[128:143], v[192:195], v[48:51], v[128:143]
  v_exp_f32 v183, v183
  v_fmamk_f32 v168, v184, 0x3fb8aa3b, v216
  v_fmamk_f32 v184, v184, 0xbfb8aa3b, v217
  v_exp_f32 v168, v168
  v_exp_f32 v184, v184
  v_fmamk_f32 v169, v185, 0x3fb8aa3b, v216
  v_fmamk_f32 v185, v185, 0xbfb8aa3b, v217
  v_exp_f32 v169, v169
  ds_read_b64_tr_b16 v[212:213], v6 offset:45056
  ds_read_b64_tr_b16 v[214:215], v6 offset:45568
  s_waitcnt lgkmcnt(6)
  v_mfma_f32_32x32x16_bf16 v[128:143], v[196:199], v[52:55], v[128:143]
  v_exp_f32 v185, v185
  v_fmamk_f32 v170, v186, 0x3fb8aa3b, v216
  v_fmamk_f32 v186, v186, 0xbfb8aa3b, v217
  v_exp_f32 v170, v170
  v_exp_f32 v186, v186
  v_fmamk_f32 v171, v187, 0x3fb8aa3b, v216
  v_fmamk_f32 v187, v187, 0xbfb8aa3b, v217
  v_add_u32 v6, 4294934528, v6
  ds_read_b64_tr_b16 v[192:193], v6 offset:0
  ds_read_b64_tr_b16 v[194:195], v6 offset:512
  v_mfma_f32_32x32x16_bf16 v[128:143], v[200:203], v[56:59], v[128:143]
  v_exp_f32 v171, v171
  v_exp_f32 v187, v187
  v_fmamk_f32 v172, v188, 0x3fb8aa3b, v216
  v_fmamk_f32 v188, v188, 0xbfb8aa3b, v217
  v_exp_f32 v172, v172
  v_exp_f32 v188, v188
  v_fmamk_f32 v173, v189, 0x3fb8aa3b, v216
  v_fmamk_f32 v189, v189, 0xbfb8aa3b, v217
  ds_read_b64_tr_b16 v[196:197], v7 offset:8192
  ds_read_b64_tr_b16 v[198:199], v7 offset:8704
  s_waitcnt vmcnt(0)
  s_waitcnt lgkmcnt(6)
  v_mfma_f32_32x32x16_bf16 v[128:143], v[204:207], v[60:63], v[128:143]
  s_barrier
  v_mfma_f32_32x32x16_bf16 v[128:143], v[208:211], v[64:67], v[128:143]
  ds_read_b64_tr_b16 v[200:201], v6 offset:4096
  ds_read_b64_tr_b16 v[202:203], v6 offset:4608
  v_exp_f32 v173, v173
  v_exp_f32 v189, v189
  v_add_f32 v216, v160, v161
  v_add_f32 v217, v176, v177
  v_add_f32 v216, v216, v162
  v_add_f32 v217, v217, v178
  v_add_f32 v216, v216, v163
  v_add_f32 v217, v217, v179
  v_add_f32 v216, v216, v164
  v_add_f32 v217, v217, v180
  v_add_f32 v216, v216, v165
  v_add_f32 v217, v217, v181
  v_add_f32 v216, v216, v166
  v_add_f32 v217, v217, v182
  v_add_f32 v216, v216, v167
  v_add_f32 v217, v217, v183
  v_add_f32 v216, v216, v168
  v_add_f32 v217, v217, v184
  v_add_f32 v216, v216, v169
  v_add_f32 v217, v217, v185
  v_add_f32 v216, v216, v170
  v_add_f32 v217, v217, v186
  v_add_f32 v216, v216, v171
  v_add_f32 v217, v217, v187
  v_add_f32 v216, v216, v172
  ds_read_b64_tr_b16 v[204:205], v7 offset:12288
  ds_read_b64_tr_b16 v[206:207], v7 offset:12800
  s_waitcnt lgkmcnt(6)
  v_mfma_f32_32x32x16_bf16 v[128:143], v[212:215], v[68:71], v[128:143]
  v_add_f32 v217, v217, v188
  v_add_f32 v216, v216, v173
  v_add_f32 v217, v217, v189
  v_mov_b32 v218, v216
  v_mov_b32 v219, v217
  s_nop 0
  v_permlane32_swap_b32 v216, v218
  v_permlane32_swap_b32 v217, v219
  v_add_f32 v216, v216, v218
  v_add_f32 v217, v217, v219
  v_rcp_f32 v216, v216
  ds_read_b64_tr_b16 v[208:209], v6 offset:8192
  ds_read_b64_tr_b16 v[210:211], v6 offset:8704
  v_mfma_f32_32x32x16_bf16 v[128:143], v[192:195], v[72:75], v[128:143]
  v_rcp_f32 v217, v217
  v_xor_b32 v11, 16, v223
  v_xor_b32 v12, 64, v223
  v_xor_b32 v13, 80, v223
  v_mov_b32 v239, 0
  v_mov_b32 v231, 0
  v_mul_f32 v160, v160, v216
  v_mul_f32 v161, v161, v216
  v_mul_f32 v162, v162, v216
  v_mul_f32 v163, v163, v216
  v_mul_f32 v164, v164, v216
  v_mul_f32 v165, v165, v216
  v_mul_f32 v166, v166, v216
  ds_read_b64_tr_b16 v[212:213], v7 offset:16384
  ds_read_b64_tr_b16 v[214:215], v7 offset:16896
  s_waitcnt lgkmcnt(6)
  v_mfma_f32_32x32x16_bf16 v[144:159], v[196:199], v[16:19], 0
  v_mul_f32 v167, v167, v216
  v_cvt_pk_bf16_f32 v232, v160, v161
  v_cvt_pk_bf16_f32 v233, v162, v163
  v_cvt_pk_bf16_f32 v234, v164, v165
  v_cvt_pk_bf16_f32 v235, v166, v167
  ds_write_b128 v223, v[232:235] offset:32768
  v_mul_f32 v168, v168, v216
  v_mul_f32 v169, v169, v216
  v_mul_f32 v170, v170, v216
  v_mul_f32 v171, v171, v216
  v_mul_f32 v172, v172, v216
  v_mul_f32 v173, v173, v216
  v_cvt_pk_bf16_f32 v236, v168, v169
  ds_read_b64_tr_b16 v[192:193], v6 offset:12288
  ds_read_b64_tr_b16 v[194:195], v6 offset:12800
  v_mfma_f32_32x32x16_bf16 v[128:143], v[200:203], v[76:79], v[128:143]
  v_cvt_pk_bf16_f32 v237, v170, v171
  v_cvt_pk_bf16_f32 v238, v172, v173
  ds_write_b128 v11, v[236:239] offset:32768
  v_mul_f32 v176, v176, v217
  v_mul_f32 v177, v177, v217
  v_mul_f32 v178, v178, v217
  v_mul_f32 v179, v179, v217
  v_mul_f32 v180, v180, v217
  v_mul_f32 v181, v181, v217
  v_mul_f32 v182, v182, v217
  v_mul_f32 v183, v183, v217
  v_cvt_pk_bf16_f32 v224, v176, v177
  v_cvt_pk_bf16_f32 v225, v178, v179
  ds_read_b64_tr_b16 v[196:197], v7 offset:20480
  ds_read_b64_tr_b16 v[198:199], v7 offset:20992
  s_waitcnt lgkmcnt(8)
  v_mfma_f32_32x32x16_bf16 v[144:159], v[204:207], v[20:23], v[144:159]
  v_cvt_pk_bf16_f32 v226, v180, v181
  v_cvt_pk_bf16_f32 v227, v182, v183
  ds_write_b128 v12, v[224:227] offset:32768
  v_mul_f32 v184, v184, v217
  v_mul_f32 v185, v185, v217
  v_mul_f32 v186, v186, v217
  v_mul_f32 v187, v187, v217
  v_mul_f32 v188, v188, v217
  v_mul_f32 v189, v189, v217
  v_cvt_pk_bf16_f32 v228, v184, v185
  v_cvt_pk_bf16_f32 v229, v186, v187
  v_cvt_pk_bf16_f32 v230, v188, v189
  ds_write_b128 v13, v[228:231] offset:32768
  ds_read_b64_tr_b16 v[200:201], v6 offset:16384
  ds_read_b64_tr_b16 v[202:203], v6 offset:16896
  v_mfma_f32_32x32x16_bf16 v[128:143], v[208:211], v[80:83], v[128:143]
  ds_read_b64_tr_b16 v[204:205], v7 offset:24576
  ds_read_b64_tr_b16 v[206:207], v7 offset:25088
  s_waitcnt lgkmcnt(4)
  v_mfma_f32_32x32x16_bf16 v[144:159], v[212:215], v[24:27], v[144:159]
  s_barrier
  v_mfma_f32_32x32x16_bf16 v[128:143], v[192:195], v[84:87], v[128:143]
  ds_read_b64_tr_b16 v[208:209], v6 offset:20480
  ds_read_b64_tr_b16 v[210:211], v6 offset:20992
  ds_read_b64_tr_b16 v[212:213], v7 offset:28672
  ds_read_b64_tr_b16 v[214:215], v7 offset:29184
  v_mfma_f32_32x32x16_bf16 v[144:159], v[196:199], v[28:31], v[144:159]
  s_add_u32 m0, s38, 8192
  s_add_u32 s46, s61, 114816
  buffer_load_dwordx4 v3, s[20:23], s46 offen lds
  v_add_u32 v6, 32768, v6
  ds_read_b64_tr_b16 v[192:193], v6 offset:49152
  ds_read_b64_tr_b16 v[194:195], v6 offset:49664
  s_waitcnt lgkmcnt(6)
  v_mfma_f32_32x32x16_bf16 v[128:143], v[200:203], v[88:91], v[128:143]
  s_add_u32 m0, s38, 12288
  s_add_u32 s46, s61, 172160
  buffer_load_dwordx4 v3, s[20:23], s46 offen lds
  v_add_u32 v7, 98304, v7
  ds_read_b64_tr_b16 v[196:197], v7 offset:24576
  ds_read_b64_tr_b16 v[198:199], v7 offset:25088
  v_mfma_f32_32x32x16_bf16 v[144:159], v[204:207], v[32:35], v[144:159]
  ds_read_b64_tr_b16 v[200:201], v6 offset:53248
  ds_read_b64_tr_b16 v[202:203], v6 offset:53760
  s_waitcnt lgkmcnt(6)
  v_mfma_f32_32x32x16_bf16 v[128:143], v[208:211], v[92:95], v[128:143]
  ds_read_b64_tr_b16 v[204:205], v7 offset:28672
  ds_read_b64_tr_b16 v[206:207], v7 offset:29184
  v_mfma_f32_32x32x16_bf16 v[144:159], v[212:215], v[36:39], v[144:159]
  v_add_u32 v6, 4294934528, v6
  ds_read_b64_tr_b16 v[208:209], v6 offset:24576
  ds_read_b64_tr_b16 v[210:211], v6 offset:25088
  s_waitcnt lgkmcnt(6)
  v_mfma_f32_32x32x16_bf16 v[128:143], v[192:195], v[96:99], v[128:143]
  v_add_u32 v7, 4294901760, v7
  ds_read_b64_tr_b16 v[212:213], v7 offset:24576
  ds_read_b64_tr_b16 v[214:215], v7 offset:25088
  v_mfma_f32_32x32x16_bf16 v[144:159], v[196:199], v[40:43], v[144:159]
  ds_read_b64_tr_b16 v[192:193], v6 offset:28672
  ds_read_b64_tr_b16 v[194:195], v6 offset:29184
  s_waitcnt lgkmcnt(6)
  v_mfma_f32_32x32x16_bf16 v[128:143], v[200:203], v[100:103], v[128:143]
  s_barrier
  v_mfma_f32_32x32x16_bf16 v[144:159], v[204:207], v[44:47], v[144:159]
  ds_read_b64_tr_b16 v[196:197], v7 offset:28672
  ds_read_b64_tr_b16 v[198:199], v7 offset:29184
  s_lshl1_add_u32 s99, s40, s39
  s_lshl3_add_u32 s99, s99, s36
  s_lshl_b32 s99, s99, 12
  s_add_u32 s99, s99, 2097152
  s_lshl_b32 s100, s41, 7
  s_add_u32 m0, s38, 16384
  s_add_u32 s46, s62, 128
  buffer_load_dwordx4 v3, s[20:23], s46 offen lds
  s_add_u32 s100, s100, s99
  v_min_u32 v9, 6, v15
  v_lshlrev_b32 v9, 7, v9
  s_lshl_b32 s83, s92, 13
  ds_read_b64_tr_b16 v[200:201], v6 offset:32768
  ds_read_b64_tr_b16 v[202:203], v6 offset:33280
  s_waitcnt lgkmcnt(6)
  v_mfma_f32_32x32x16_bf16 v[128:143], v[208:211], v[104:107], v[128:143]
  s_add_u32 m0, s38, 20480
  s_add_u32 s46, s62, 57472
  buffer_load_dwordx4 v3, s[20:23], s46 offen lds
  s_add_u32 s83, s83, s50
  v_xor_b32 v220, 64, v2
  v_lshrrev_b32 v11, 3, v15
  v_mul_u32_u24 v11, 768, v11
  v_add_u32 v7, 65536, v7
  ds_read_b64_tr_b16 v[204:205], v7 offset:32768
  ds_read_b64_tr_b16 v[206:207], v7 offset:33280
  v_mfma_f32_32x32x16_bf16 v[144:159], v[212:215], v[48:51], v[144:159]
  s_add_u32 m0, s38, 24576
  s_add_u32 s46, s62, 114816
  buffer_load_dwordx4 v3, s[20:23], s46 offen lds
  v_add_u32 v221, v11, v1
  s_and_b32 s54, s37, 1
  s_lshl1_add_u32 s54, s39, s54
  s_lshl2_add_u32 s55, s40, s54
  ds_read_b64_tr_b16 v[208:209], v6 offset:36864
  ds_read_b64_tr_b16 v[210:211], v6 offset:37376
  s_waitcnt lgkmcnt(6)
  v_mfma_f32_32x32x16_bf16 v[128:143], v[192:195], v[108:111], v[128:143]
  s_add_u32 m0, s38, 28672
  s_add_u32 s46, s62, 172160
  buffer_load_dwordx4 v3, s[20:23], s46 offen lds
  s_mul_i32 s101, s55, 28672
  s_lshl_b32 s56, s41, 7
  s_add_u32 s101, s101, s56
  s_cmp_lg_u32 s54, s37
  s_cselect_b32 s67, 1, 0
  s_add_u32 s56, s67, 0
  ds_read_b64_tr_b16 v[212:213], v7 offset:36864
  ds_read_b64_tr_b16 v[214:215], v7 offset:37376
  v_mfma_f32_32x32x16_bf16 v[144:159], v[196:199], v[52:55], v[144:159]
  s_mul_i32 s56, s56, 7168
  s_add_u32 s101, s101, s56
  s_mul_i32 s51, s55, 147456
  s_add_u32 s51, s51, 8503296
  ds_read_b64_tr_b16 v[192:193], v6 offset:40960
  ds_read_b64_tr_b16 v[194:195], v6 offset:41472
  s_waitcnt lgkmcnt(6)
  v_mfma_f32_32x32x16_bf16 v[128:143], v[200:203], v[112:115], v[128:143]
  s_add_u32 m0, s38, 32768
  s_add_u32 s46, s63, 128
  buffer_load_dwordx4 v3, s[20:23], s46 offen lds
  s_mul_i32 s56, s40, 7
  s_add_u32 s56, s56, s41
  s_lshl2_add_u32 s82, s56, s54
  s_lshl2_add_u32 s81, s56, s37
  ds_read_b64_tr_b16 v[196:197], v7 offset:40960
  ds_read_b64_tr_b16 v[198:199], v7 offset:41472
  v_mfma_f32_32x32x16_bf16 v[144:159], v[204:207], v[56:59], v[144:159]
  s_add_u32 m0, s38, 36864
  s_add_u32 s46, s63, 57472
  buffer_load_dwordx4 v3, s[20:23], s46 offen lds
  s_add_u32 s58, s54, 0
  s_and_b32 s54, s37, 1
  v_bfe_u32 v228, v15, 3, 2
  v_lshl_add_u32 v228, s54, 2, v228
  ds_read_b64_tr_b16 v[200:201], v6 offset:45056
  ds_read_b64_tr_b16 v[202:203], v6 offset:45568
  s_waitcnt lgkmcnt(6)
  v_mfma_f32_32x32x16_bf16 v[128:143], v[208:211], v[116:119], v[128:143]
  s_add_u32 m0, s38, 40960
  s_add_u32 s46, s63, 114816
  buffer_load_dwordx4 v3, s[20:23], s46 offen lds
  v_lshrrev_b32 v229, 4, v15
  v_and_b32 v229, 2, v229
  s_lshl_b32 s86, s93, 13
  s_add_u32 s86, s86, s50
  s_lshl_b32 s87, s94, 13
  ds_read_b64_tr_b16 v[204:205], v7 offset:45056
  ds_read_b64_tr_b16 v[206:207], v7 offset:45568
  v_mfma_f32_32x32x16_bf16 v[144:159], v[212:215], v[60:63], v[144:159]
  s_add_u32 m0, s38, 45056
  s_add_u32 s46, s63, 172160
  buffer_load_dwordx4 v3, s[20:23], s46 offen lds
  s_add_u32 s87, s87, s50
  s_lshl_b32 s88, s95, 13
  s_add_u32 s88, s88, s50
  s_lshl_b32 s89, s96, 13
  v_add_u32 v7, 4294934528, v7
  ds_read_b64_tr_b16 v[208:209], v7 offset:0
  ds_read_b64_tr_b16 v[210:211], v7 offset:512
  s_waitcnt lgkmcnt(6)
  v_mfma_f32_32x32x16_bf16 v[128:143], v[192:195], v[120:123], v[128:143]
  s_add_u32 s89, s89, s50
  s_lshl_b32 s90, s97, 13
  s_add_u32 s90, s90, s50
  s_lshl_b32 s91, s98, 13
  ds_read_b64_tr_b16 v[212:213], v7 offset:4096
  ds_read_b64_tr_b16 v[214:215], v7 offset:4608
  v_mfma_f32_32x32x16_bf16 v[144:159], v[196:199], v[64:67], v[144:159]
  s_add_u32 m0, s38, 49152
  s_add_u32 s46, s64, 128
  buffer_load_dwordx4 v3, s[20:23], s46 offen lds
  s_add_u32 s91, s91, s50
  s_mul_i32 s92, s92, 114688
  s_mul_i32 s93, s93, 114688
  s_mul_i32 s94, s94, 114688
  ds_read_b64_tr_b16 v[192:193], v7 offset:8192
  ds_read_b64_tr_b16 v[194:195], v7 offset:8704
  s_waitcnt lgkmcnt(6)
  v_mfma_f32_32x32x16_bf16 v[128:143], v[200:203], v[124:127], v[128:143]
  s_barrier
  v_mfma_f32_32x32x16_bf16 v[144:159], v[204:207], v[68:71], v[144:159]
  ds_read_b64_tr_b16 v[196:197], v7 offset:12288
  ds_read_b64_tr_b16 v[198:199], v7 offset:12800
  s_add_u32 m0, s38, 53248
  s_add_u32 s46, s64, 57472
  buffer_load_dwordx4 v3, s[20:23], s46 offen lds
  s_mul_i32 s95, s95, 114688
  s_mul_i32 s96, s96, 114688
  s_mul_i32 s97, s97, 114688
  s_mul_i32 s98, s98, 114688
  s_add_u32 m0, s38, 57344
  s_add_u32 s46, s64, 114816
  buffer_load_dwordx4 v3, s[20:23], s46 offen lds
  buffer_load_dwordx4 v[224:227], v221, s[4:7], s101 offen
  ds_read_b64_tr_b16 v[200:201], v7 offset:16384
  ds_read_b64_tr_b16 v[202:203], v7 offset:16896
  s_waitcnt lgkmcnt(6)
  v_mfma_f32_32x32x16_bf16 v[144:159], v[208:211], v[72:75], v[144:159]
  s_add_u32 m0, s38, 61440
  s_add_u32 s46, s64, 172160
  buffer_load_dwordx4 v3, s[20:23], s46 offen lds
  v_mul_f32 v216, v128, v128
  v_mul_f32 v217, v129, v129
  v_mul_f32 v218, v130, v130
  v_mul_f32 v219, v131, v131
  v_fmamk_f32 v216, v216, 0xbdd2d3e8, v8
  v_fmamk_f32 v217, v217, 0xbdd2d3e8, v8
  v_fmamk_f32 v218, v218, 0xbdd2d3e8, v8
  ds_read_b64_tr_b16 v[204:205], v7 offset:20480
  ds_read_b64_tr_b16 v[206:207], v7 offset:20992
  v_mfma_f32_32x32x16_bf16 v[144:159], v[212:215], v[76:79], v[144:159]
  s_add_u32 m0, s38, 122880
  s_add_u32 s46, s65, 128
  buffer_load_dwordx4 v3, s[20:23], s46 offen lds
  v_fmamk_f32 v219, v219, 0xbdd2d3e8, v8
  v_mul_f32 v216, v216, v128
  v_mul_f32 v217, v217, v129
  v_mul_f32 v218, v218, v130
  v_mul_f32 v219, v219, v131
  v_exp_f32 v216, v216
  v_add_u32 v7, 32768, v7
  ds_read_b64_tr_b16 v[208:209], v7 offset:49152
  ds_read_b64_tr_b16 v[210:211], v7 offset:49664
  s_waitcnt lgkmcnt(6)
  v_mfma_f32_32x32x16_bf16 v[144:159], v[192:195], v[80:83], v[144:159]
  s_add_u32 m0, s38, 126976
  s_add_u32 s46, s65, 57472
  buffer_load_dwordx4 v3, s[20:23], s46 offen lds
  v_mul_f32 v136, v128, v136
  v_exp_f32 v217, v217
  v_mul_f32 v137, v129, v137
  v_exp_f32 v218, v218
  ds_read_b64_tr_b16 v[212:213], v7 offset:53248
  ds_read_b64_tr_b16 v[214:215], v7 offset:53760
  v_mfma_f32_32x32x16_bf16 v[144:159], v[196:199], v[84:87], v[144:159]
  s_add_u32 m0, s38, 131072
  s_add_u32 s46, s65, 114816
  buffer_load_dwordx4 v3, s[20:23], s46 offen lds
  v_mul_f32 v138, v130, v138
  v_exp_f32 v219, v219
  v_mul_f32 v139, v131, v139
  v_add_f32 v216, 1.0, v216
  v_add_u32 v7, 4294934528, v7
  ds_read_b64_tr_b16 v[192:193], v7 offset:24576
  ds_read_b64_tr_b16 v[194:195], v7 offset:25088
  s_waitcnt lgkmcnt(6)
  v_mfma_f32_32x32x16_bf16 v[144:159], v[200:203], v[88:91], v[144:159]
  s_add_u32 m0, s38, 135168
  s_add_u32 s46, s65, 172160
  buffer_load_dwordx4 v3, s[20:23], s46 offen lds
  v_add_f32 v217, 1.0, v217
  v_add_f32 v218, 1.0, v218
  v_add_f32 v219, 1.0, v219
  v_rcp_f32 v216, v216
  v_rcp_f32 v217, v217
  ds_read_b64_tr_b16 v[196:197], v7 offset:28672
  ds_read_b64_tr_b16 v[198:199], v7 offset:29184
  v_mfma_f32_32x32x16_bf16 v[144:159], v[204:207], v[92:95], v[144:159]
  v_rcp_f32 v218, v218
  v_rcp_f32 v219, v219
  v_mul_f32 v136, v136, v216
  ds_read_b64_tr_b16 v[200:201], v7 offset:32768
  ds_read_b64_tr_b16 v[202:203], v7 offset:33280
  s_waitcnt lgkmcnt(6)
  v_mfma_f32_32x32x16_bf16 v[144:159], v[208:211], v[96:99], v[144:159]
  v_mul_f32 v137, v137, v217
  v_mul_f32 v138, v138, v218
  v_mul_f32 v139, v139, v219
  v_mul_f32 v216, v132, v132
  v_mul_f32 v217, v133, v133
  v_mul_f32 v218, v134, v134
  ds_read_b64_tr_b16 v[204:205], v7 offset:36864
  ds_read_b64_tr_b16 v[206:207], v7 offset:37376
  v_mfma_f32_32x32x16_bf16 v[144:159], v[212:215], v[100:103], v[144:159]
  v_mul_f32 v219, v135, v135
  v_fmamk_f32 v216, v216, 0xbdd2d3e8, v8
  v_fmamk_f32 v217, v217, 0xbdd2d3e8, v8
  v_fmamk_f32 v218, v218, 0xbdd2d3e8, v8
  v_fmamk_f32 v219, v219, 0xbdd2d3e8, v8
  v_mul_f32 v216, v216, v132
  ds_read_b64_tr_b16 v[208:209], v7 offset:40960
  ds_read_b64_tr_b16 v[210:211], v7 offset:41472
  s_waitcnt lgkmcnt(6)
  v_mfma_f32_32x32x16_bf16 v[144:159], v[192:195], v[104:107], v[144:159]
  v_mul_f32 v217, v217, v133
  v_mul_f32 v218, v218, v134
  v_mul_f32 v219, v219, v135
  v_exp_f32 v216, v216
  v_mul_f32 v140, v132, v140
  v_exp_f32 v217, v217
  ds_read_b64_tr_b16 v[212:213], v7 offset:45056
  ds_read_b64_tr_b16 v[214:215], v7 offset:45568
  s_waitcnt vmcnt(15)
  s_waitcnt lgkmcnt(6)
  v_mfma_f32_32x32x16_bf16 v[144:159], v[196:199], v[108:111], v[144:159]
  s_barrier
  v_mfma_f32_32x32x16_bf16 v[144:159], v[200:203], v[112:115], v[144:159]
  ds_read_b64_tr_b16 v[192:193], v6 offset:49152
  ds_read_b64_tr_b16 v[194:195], v6 offset:49664
  v_mul_f32 v141, v133, v141
  v_exp_f32 v218, v218
  v_mul_f32 v142, v134, v142
  v_exp_f32 v219, v219
  s_add_u32 m0, s38, 65536
  s_add_u32 s46, s66, 128
  buffer_load_dwordx4 v3, s[20:23], s46 offen lds
  v_mul_f32 v143, v135, v143
  v_add_f32 v216, 1.0, v216
  v_add_f32 v217, 1.0, v217
  v_add_f32 v218, 1.0, v218
  v_add_f32 v219, 1.0, v219
  ds_read_b64_tr_b16 v[196:197], v6 offset:53248
  ds_read_b64_tr_b16 v[198:199], v6 offset:53760
  s_waitcnt lgkmcnt(6)
  v_mfma_f32_32x32x16_bf16 v[144:159], v[204:207], v[116:119], v[144:159]
  s_add_u32 m0, s38, 69632
  s_add_u32 s46, s66, 57472
  buffer_load_dwordx4 v3, s[20:23], s46 offen lds
  v_rcp_f32 v216, v216
  v_rcp_f32 v217, v217
  v_rcp_f32 v218, v218
  v_add_u32 v6, 32768, v6
  ds_read_b64_tr_b16 v[200:201], v6 offset:57344
  ds_read_b64_tr_b16 v[202:203], v6 offset:57856
  v_mfma_f32_32x32x16_bf16 v[144:159], v[208:211], v[120:123], v[144:159]
  s_add_u32 m0, s38, 73728
  s_add_u32 s46, s66, 114816
  buffer_load_dwordx4 v3, s[20:23], s46 offen lds
  v_rcp_f32 v219, v219
  v_mul_f32 v140, v140, v216
  v_mul_f32 v141, v141, v217
  v_mul_f32 v142, v142, v218
  v_mul_f32 v143, v143, v219
  ds_read_b64_tr_b16 v[204:205], v6 offset:61440
  ds_read_b64_tr_b16 v[206:207], v6 offset:61952
  s_waitcnt lgkmcnt(6)
  v_mfma_f32_32x32x16_bf16 v[144:159], v[212:215], v[124:127], v[144:159]
  s_add_u32 m0, s38, 77824
  s_add_u32 s46, s66, 172160
  buffer_load_dwordx4 v3, s[20:23], s46 offen lds
  v_cvt_pk_bf16_f32 v240, v136, v137
  v_cvt_pk_bf16_f32 v241, v138, v139
  v_cvt_pk_bf16_f32 v242, v140, v141
  v_cvt_pk_bf16_f32 v243, v142, v143
  s_add_u32 s47, s83, 0
  buffer_store_dwordx4 v[240:243], v1, s[32:35], s47 offen offset:0 sc1
  v_add_u32 v6, 4294868992, v6
  ds_read_b64_tr_b16 v[208:209], v6 offset:0
  ds_read_b64_tr_b16 v[210:211], v6 offset:512
  v_mfma_f32_32x32x16_bf16 v[160:175], v[192:195], v[16:19], 0
  ds_read_b64_tr_b16 v[212:213], v6 offset:4096
  ds_read_b64_tr_b16 v[214:215], v6 offset:4608
  s_waitcnt lgkmcnt(6)
  v_mfma_f32_32x32x16_bf16 v[160:175], v[196:199], v[20:23], v[160:175]
  v_mul_f32 v216, v144, v144
  v_mul_f32 v217, v145, v145
  v_mul_f32 v218, v146, v146
  v_mul_f32 v219, v147, v147
  v_fmamk_f32 v216, v216, 0xbdd2d3e8, v8
  v_fmamk_f32 v217, v217, 0xbdd2d3e8, v8
  ds_read_b64_tr_b16 v[192:193], v6 offset:8192
  ds_read_b64_tr_b16 v[194:195], v6 offset:8704
  v_mfma_f32_32x32x16_bf16 v[160:175], v[200:203], v[24:27], v[160:175]
  v_fmamk_f32 v218, v218, 0xbdd2d3e8, v8
  v_fmamk_f32 v219, v219, 0xbdd2d3e8, v8
  v_mul_f32 v216, v216, v144
  v_mul_f32 v217, v217, v145
  ds_read_b64_tr_b16 v[196:197], v6 offset:12288
  ds_read_b64_tr_b16 v[198:199], v6 offset:12800
  s_waitcnt lgkmcnt(6)
  v_mfma_f32_32x32x16_bf16 v[160:175], v[204:207], v[28:31], v[160:175]
  v_mul_f32 v218, v218, v146
  v_mul_f32 v219, v219, v147
  v_exp_f32 v216, v216
  v_mul_f32 v152, v144, v152
  ds_read_b64_tr_b16 v[200:201], v6 offset:16384
  ds_read_b64_tr_b16 v[202:203], v6 offset:16896
  v_mfma_f32_32x32x16_bf16 v[160:175], v[208:211], v[32:35], v[160:175]
  v_exp_f32 v217, v217
  v_mul_f32 v153, v145, v153
  v_exp_f32 v218, v218
  v_lshrrev_b32 v11, 3, v15
  v_mul_u32_u24 v11, 896, v11
  v_add_u32 v11, v11, v1
  s_add_u32 s49, s100, 1024
  v_not_b32 v12, s43
  s_bfm_b64 exec, 24, 0
  buffer_store_dwordx4 v[12:15], v11, s[32:35], s49 offen sc1
  s_mov_b64 exec, -1
  ds_read_b64_tr_b16 v[204:205], v6 offset:20480
  ds_read_b64_tr_b16 v[206:207], v6 offset:20992
  s_waitcnt vmcnt(13)
  s_waitcnt lgkmcnt(6)
  v_mfma_f32_32x32x16_bf16 v[160:175], v[212:215], v[36:39], v[160:175]
  s_barrier
  v_mfma_f32_32x32x16_bf16 v[160:175], v[192:195], v[40:43], v[160:175]
  ds_read_b64_tr_b16 v[208:209], v6 offset:24576
  ds_read_b64_tr_b16 v[210:211], v6 offset:25088
  v_mul_f32 v154, v146, v154
  v_exp_f32 v219, v219
  v_mul_f32 v155, v147, v155
  v_mov_b32 v252, -1
  v_mov_b32 v253, -1
  v_mov_b32 v254, -1
  v_mov_b32 v255, -1
  v_add_f32 v216, 1.0, v216
  v_add_f32 v217, 1.0, v217
  v_add_f32 v218, 1.0, v218
  v_add_f32 v219, 1.0, v219
  v_rcp_f32 v216, v216
  s_lshl_b32 s49, s81, 13
  s_add_u32 s49, s49, 4194304
  s_cmp_lg_u32 s67, 0
  s_cselect_b32 s49, s49, 0x20000000
  buffer_store_dwordx4 v[252:255], v1, s[32:35], s49 offen offset:0 sc1
  buffer_store_dwordx4 v[252:255], v1, s[32:35], s49 offen offset:1024 sc1
  ds_read_b64_tr_b16 v[212:213], v6 offset:28672
  ds_read_b64_tr_b16 v[214:215], v6 offset:29184
  s_waitcnt lgkmcnt(6)
  v_mfma_f32_32x32x16_bf16 v[160:175], v[196:199], v[44:47], v[160:175]
  v_rcp_f32 v217, v217
  v_rcp_f32 v218, v218
  ds_read_b64_tr_b16 v[192:193], v6 offset:32768
  ds_read_b64_tr_b16 v[194:195], v6 offset:33280
  v_mfma_f32_32x32x16_bf16 v[160:175], v[200:203], v[48:51], v[160:175]
  s_add_u32 m0, s38, 81920
  s_add_u32 s46, s92, 0
  buffer_load_dwordx4 v4, s[24:27], s46 offen lds
  v_rcp_f32 v219, v219
  v_mul_f32 v152, v152, v216
  v_mul_f32 v153, v153, v217
  ds_read_b64_tr_b16 v[196:197], v6 offset:36864
  ds_read_b64_tr_b16 v[198:199], v6 offset:37376
  s_waitcnt lgkmcnt(6)
  v_mfma_f32_32x32x16_bf16 v[160:175], v[204:207], v[52:55], v[160:175]
  s_add_u32 m0, s38, 86016
  s_add_u32 s46, s92, 28672
  buffer_load_dwordx4 v4, s[24:27], s46 offen lds
  v_mul_f32 v154, v154, v218
  v_mul_f32 v155, v155, v219
  v_mul_f32 v216, v148, v148
  v_mul_f32 v217, v149, v149
  v_mul_f32 v218, v150, v150
  ds_read_b64_tr_b16 v[200:201], v6 offset:40960
  ds_read_b64_tr_b16 v[202:203], v6 offset:41472
  v_mfma_f32_32x32x16_bf16 v[160:175], v[208:211], v[56:59], v[160:175]
  s_add_u32 m0, s38, 90112
  s_add_u32 s46, s93, 0
  buffer_load_dwordx4 v4, s[24:27], s46 offen lds
  v_mul_f32 v219, v151, v151
  v_fmamk_f32 v216, v216, 0xbdd2d3e8, v8
  v_fmamk_f32 v217, v217, 0xbdd2d3e8, v8
  v_fmamk_f32 v218, v218, 0xbdd2d3e8, v8
  v_fmamk_f32 v219, v219, 0xbdd2d3e8, v8
  ds_read_b64_tr_b16 v[204:205], v7 offset:49152
  ds_read_b64_tr_b16 v[206:207], v7 offset:49664
  s_waitcnt lgkmcnt(6)
  v_mfma_f32_32x32x16_bf16 v[160:175], v[212:215], v[60:63], v[160:175]
  s_add_u32 m0, s38, 94208
  s_add_u32 s46, s93, 28672
  buffer_load_dwordx4 v4, s[24:27], s46 offen lds
  v_mul_f32 v216, v216, v148
  v_mul_f32 v217, v217, v149
  v_mul_f32 v218, v218, v150
  v_mul_f32 v219, v219, v151
  v_exp_f32 v216, v216
  ds_read_b64_tr_b16 v[208:209], v6 offset:45056
  ds_read_b64_tr_b16 v[210:211], v6 offset:45568
  v_mfma_f32_32x32x16_bf16 v[160:175], v[192:195], v[64:67], v[160:175]
  s_add_u32 m0, s38, 139264
  s_add_u32 s46, s94, 0
  buffer_load_dwordx4 v4, s[24:27], s46 offen lds
  v_mul_f32 v156, v148, v156
  v_exp_f32 v217, v217
  ds_read_b64_tr_b16 v[212:213], v7 offset:53248
  ds_read_b64_tr_b16 v[214:215], v7 offset:53760
  s_waitcnt lgkmcnt(6)
  v_mfma_f32_32x32x16_bf16 v[160:175], v[196:199], v[68:71], v[160:175]
  s_add_u32 m0, s38, 143360
  s_add_u32 s46, s94, 28672
  buffer_load_dwordx4 v4, s[24:27], s46 offen lds
  v_mul_f32 v157, v149, v157
  v_exp_f32 v218, v218
  v_mul_f32 v158, v150, v158
  v_exp_f32 v219, v219
  ds_read_b64_tr_b16 v[192:193], v6 offset:49152
  ds_read_b64_tr_b16 v[194:195], v6 offset:49664
  v_mfma_f32_32x32x16_bf16 v[160:175], v[200:203], v[72:75], v[160:175]
  v_mul_f32 v159, v151, v159
  v_add_f32 v216, 1.0, v216
  v_add_f32 v217, 1.0, v217
  v_add_f32 v218, 1.0, v218
  v_add_u32 v7, 32768, v7
  ds_read_b64_tr_b16 v[196:197], v7 offset:57344
  ds_read_b64_tr_b16 v[198:199], v7 offset:57856
  s_waitcnt lgkmcnt(6)
  v_mfma_f32_32x32x16_bf16 v[176:191], v[204:207], v[16:19], 0
  s_add_u32 m0, s38, 147456
  s_add_u32 s46, s95, 0
  buffer_load_dwordx4 v4, s[24:27], s46 offen lds
  v_add_f32 v219, 1.0, v219
  v_rcp_f32 v216, v216
  v_rcp_f32 v217, v217
  ds_read_b64_tr_b16 v[200:201], v6 offset:53248
  ds_read_b64_tr_b16 v[202:203], v6 offset:53760
  v_mfma_f32_32x32x16_bf16 v[160:175], v[208:211], v[76:79], v[160:175]
  s_add_u32 m0, s38, 151552
  s_add_u32 s46, s95, 28672
  buffer_load_dwordx4 v4, s[24:27], s46 offen lds
  v_rcp_f32 v218, v218
  v_rcp_f32 v219, v219
  ds_read_b64_tr_b16 v[204:205], v7 offset:61440
  ds_read_b64_tr_b16 v[206:207], v7 offset:61952
  s_waitcnt vmcnt(18)
  s_waitcnt lgkmcnt(6)
  v_mfma_f32_32x32x16_bf16 v[176:191], v[212:215], v[20:23], v[176:191]
  s_barrier
  v_mfma_f32_32x32x16_bf16 v[160:175], v[192:195], v[80:83], v[160:175]
  ds_read_b64_tr_b16 v[208:209], v6 offset:57344
  ds_read_b64_tr_b16 v[210:211], v6 offset:57856
  s_add_u32 m0, s38, 98304
  s_add_u32 s46, s96, 0
  buffer_load_dwordx4 v4, s[24:27], s46 offen lds
  v_mul_f32 v156, v156, v216
  v_mul_f32 v157, v157, v217
  v_mul_f32 v158, v158, v218
  v_mul_f32 v159, v159, v219
  v_cvt_pk_bf16_f32 v244, v152, v153
  s_add_u32 m0, s38, 102400
  s_add_u32 s46, s96, 28672
  buffer_load_dwordx4 v4, s[24:27], s46 offen lds
  v_cvt_pk_bf16_f32 v245, v154, v155
  v_cvt_pk_bf16_f32 v246, v156, v157
  v_cvt_pk_bf16_f32 v247, v158, v159
  s_add_u32 s47, s83, 0
  buffer_store_dwordx4 v[244:247], v1, s[32:35], s47 offen offset:1024 sc1
  v_add_u32 v7, 4294868992, v7
  ds_read_b64_tr_b16 v[212:213], v7 offset:0
  ds_read_b64_tr_b16 v[214:215], v7 offset:512
  s_waitcnt lgkmcnt(6)
  v_mfma_f32_32x32x16_bf16 v[176:191], v[196:199], v[24:27], v[176:191]
  ds_read_b64_tr_b16 v[192:193], v6 offset:61440
  ds_read_b64_tr_b16 v[194:195], v6 offset:61952
  v_mfma_f32_32x32x16_bf16 v[160:175], v[200:203], v[84:87], v[160:175]
  s_add_u32 m0, s38, 106496
  s_add_u32 s46, s97, 0
  buffer_load_dwordx4 v4, s[24:27], s46 offen lds
  v_add_u32 v222, 0, v228
  v_add_u32 v232, 0, v222
  v_cmp_gt_u32 vcc, 12, v222
  v_and_b32 v222, 12, v222
  v_add_u32 v232, v232, v222
  v_cndmask_b32 v222, 0, v229, vcc
  ds_read_b64_tr_b16 v[196:197], v7 offset:4096
  ds_read_b64_tr_b16 v[198:199], v7 offset:4608
  s_waitcnt lgkmcnt(6)
  v_mfma_f32_32x32x16_bf16 v[176:191], v[204:207], v[28:31], v[176:191]
  s_add_u32 m0, s38, 110592
  s_add_u32 s46, s97, 28672
  buffer_load_dwordx4 v4, s[24:27], s46 offen lds
  v_add_u32 v232, v232, v222
  v_mul_u32_u24 v232, 896, v232
  v_add_u32 v232, v232, v5
  v_add_u32 v6, 98304, v6
  ds_read_b64_tr_b16 v[200:201], v6 offset:24576
  ds_read_b64_tr_b16 v[202:203], v6 offset:25088
  v_mfma_f32_32x32x16_bf16 v[160:175], v[208:211], v[88:91], v[160:175]
  s_add_u32 m0, s38, 114688
  s_add_u32 s46, s98, 0
  buffer_load_dwordx4 v4, s[24:27], s46 offen lds
  s_lshl_b32 s49, s81, 8
  s_add_u32 s49, s49, 262144
  s_cmp_lg_u32 s67, 0
  s_cselect_b32 s49, s49, 0x20000000
  s_waitcnt vmcnt(14)
  v_mov_b32 v12, s43
  s_mov_b64 exec, 0xff
  buffer_store_dwordx4 v[12:15], v1, s[32:35], s49 offen sc1
  s_mov_b64 exec, -1
  v_add_u32 v222, 8, v228
  v_mul_u32_u24 v233, 74, v222
  ds_read_b64_tr_b16 v[204:205], v7 offset:8192
  ds_read_b64_tr_b16 v[206:207], v7 offset:8704
  s_waitcnt lgkmcnt(6)
  v_mfma_f32_32x32x16_bf16 v[176:191], v[212:215], v[32:35], v[176:191]
  s_add_u32 m0, s38, 118784
  s_add_u32 s46, s98, 28672
  buffer_load_dwordx4 v4, s[24:27], s46 offen lds
  v_lshrrev_b32 v233, 10, v233
  v_mad_i32_i24 v222, v233, -14, v222
  v_mad_u32_u24 v233, v233, 56, v222
  ds_read_b64_tr_b16 v[208:209], v6 offset:28672
  ds_read_b64_tr_b16 v[210:211], v6 offset:29184
  v_mfma_f32_32x32x16_bf16 v[160:175], v[192:195], v[92:95], v[160:175]
  v_cmp_gt_u32 vcc, 12, v222
  v_and_b32 v222, 12, v222
  v_add_u32 v233, v233, v222
  v_cndmask_b32 v222, 0, v229, vcc
  v_add_u32 v233, v233, v222
  ds_read_b64_tr_b16 v[212:213], v7 offset:12288
  ds_read_b64_tr_b16 v[214:215], v7 offset:12800
  s_waitcnt lgkmcnt(6)
  v_mfma_f32_32x32x16_bf16 v[176:191], v[196:199], v[36:39], v[176:191]
  s_barrier
  v_mfma_f32_32x32x16_bf16 v[160:175], v[200:203], v[96:99], v[160:175]
  ds_read_b64_tr_b16 v[192:193], v6 offset:32768
  ds_read_b64_tr_b16 v[194:195], v6 offset:33280
  v_mul_u32_u24 v233, 896, v233
  v_add_u32 v233, v233, v5
  v_add_u32 v222, 16, v228
  s_add_u32 m0, s38, 0
  s_add_u32 s46, s92, 57344
  buffer_load_dwordx4 v4, s[24:27], s46 offen lds
  v_subrev_u32 v222, 14, v222
  v_add_u32 v234, 56, v222
  ds_read_b64_tr_b16 v[196:197], v7 offset:16384
  ds_read_b64_tr_b16 v[198:199], v7 offset:16896
  s_waitcnt lgkmcnt(6)
  v_mfma_f32_32x32x16_bf16 v[176:191], v[204:207], v[40:43], v[176:191]
  s_add_u32 m0, s38, 4096
  s_add_u32 s46, s92, 86016
  buffer_load_dwordx4 v4, s[24:27], s46 offen lds
  v_cmp_gt_u32 vcc, 12, v222
  v_and_b32 v222, 12, v222
  v_add_u32 v234, v234, v222
  v_cndmask_b32 v222, 0, v229, vcc
  v_add_u32 v234, v234, v222
  v_mul_u32_u24 v234, 896, v234
  ds_read_b64_tr_b16 v[200:201], v6 offset:36864
  ds_read_b64_tr_b16 v[202:203], v6 offset:37376
  v_mfma_f32_32x32x16_bf16 v[160:175], v[208:211], v[100:103], v[160:175]
  s_add_u32 m0, s38, 155648
  s_add_u32 s46, s93, 57344
  buffer_load_dwordx4 v4, s[24:27], s46 offen lds
  v_add_u32 v234, v234, v5
  v_add_u32 v222, 24, v228
  v_mul_u32_u24 v235, 74, v222
  ds_read_b64_tr_b16 v[204:205], v7 offset:20480
  ds_read_b64_tr_b16 v[206:207], v7 offset:20992
  s_waitcnt lgkmcnt(6)
  v_mfma_f32_32x32x16_bf16 v[176:191], v[212:215], v[44:47], v[176:191]
  s_add_u32 m0, s38, 159744
  s_add_u32 s46, s93, 86016
  buffer_load_dwordx4 v4, s[24:27], s46 offen lds
  v_lshrrev_b32 v235, 10, v235
  v_mad_i32_i24 v222, v235, -14, v222
  v_add_u32 v6, 4294934528, v6
  ds_read_b64_tr_b16 v[208:209], v6 offset:0
  ds_read_b64_tr_b16 v[210:211], v6 offset:512
  v_mfma_f32_32x32x16_bf16 v[160:175], v[192:195], v[104:107], v[160:175]
  v_mad_u32_u24 v235, v235, 56, v222
  v_cmp_gt_u32 vcc, 12, v222
  v_and_b32 v222, 12, v222
  v_add_u32 v235, v235, v222
  v_cndmask_b32 v222, 0, v229, vcc
  v_add_u32 v235, v235, v222
  ds_read_b64_tr_b16 v[212:213], v7 offset:24576
  ds_read_b64_tr_b16 v[214:215], v7 offset:25088
  s_waitcnt lgkmcnt(6)
  v_mfma_f32_32x32x16_bf16 v[176:191], v[196:199], v[48:51], v[176:191]
  v_mul_u32_u24 v235, 896, v235
  v_add_u32 v235, v235, v5
  ds_read_b64_tr_b16 v[192:193], v6 offset:4096
  ds_read_b64_tr_b16 v[194:195], v6 offset:4608
  v_mfma_f32_32x32x16_bf16 v[160:175], v[200:203], v[108:111], v[160:175]
  v_add_u32 v222, 32, v228
  v_subrev_u32 v222, 28, v222
  v_add_u32 v236, 112, v222
  ds_read_b64_tr_b16 v[196:197], v7 offset:28672
  ds_read_b64_tr_b16 v[198:199], v7 offset:29184
  s_waitcnt lgkmcnt(6)
  v_mfma_f32_32x32x16_bf16 v[176:191], v[204:207], v[52:55], v[176:191]
  s_barrier
  v_mfma_f32_32x32x16_bf16 v[160:175], v[208:211], v[112:115], v[160:175]
  ds_read_b64_tr_b16 v[200:201], v6 offset:8192
  ds_read_b64_tr_b16 v[202:203], v6 offset:8704
  v_cmp_gt_u32 vcc, 12, v222
  v_and_b32 v222, 12, v222
  v_add_u32 v236, v236, v222
  v_cndmask_b32 v222, 0, v229, vcc
  v_add_u32 v236, v236, v222
  s_add_u32 m0, s38, 8192
  s_add_u32 s46, s94, 57344
  buffer_load_dwordx4 v4, s[24:27], s46 offen lds
  v_mul_u32_u24 v236, 896, v236
  v_add_u32 v236, v236, v5
  v_add_u32 v222, 40, v228
  ds_read_b64_tr_b16 v[204:205], v7 offset:32768
  ds_read_b64_tr_b16 v[206:207], v7 offset:33280
  s_waitcnt lgkmcnt(6)
  v_mfma_f32_32x32x16_bf16 v[176:191], v[212:215], v[56:59], v[176:191]
  s_add_u32 m0, s38, 12288
  s_add_u32 s46, s94, 86016
  buffer_load_dwordx4 v4, s[24:27], s46 offen lds
  v_mul_u32_u24 v237, 74, v222
  v_lshrrev_b32 v237, 10, v237
  v_mad_i32_i24 v222, v237, -14, v222
  ds_read_b64_tr_b16 v[208:209], v6 offset:12288
  ds_read_b64_tr_b16 v[210:211], v6 offset:12800
  v_mfma_f32_32x32x16_bf16 v[160:175], v[192:195], v[116:119], v[160:175]
  s_add_u32 m0, s38, 16384
  s_add_u32 s46, s95, 57344
  buffer_load_dwordx4 v4, s[24:27], s46 offen lds
  v_mad_u32_u24 v237, v237, 56, v222
  v_cmp_gt_u32 vcc, 12, v222
  v_and_b32 v222, 12, v222
  v_add_u32 v237, v237, v222
  v_cndmask_b32 v222, 0, v229, vcc
  v_min_u32 v11, 15, v15
  v_lshlrev_b32 v11, 7, v11
  s_add_u32 s49, s83, 0
  s_waitcnt vmcnt(12)
  s_add_u32 s47, s100, 1024
  v_mov_b32 v12, s43
  s_mov_b64 exec, 0xff
  buffer_store_dwordx4 v[12:15], v1, s[32:35], s47 offen sc1
  s_mov_b64 exec, -1
  buffer_load_dword v231, v11, s[32:35], s49 offen sc1
  ds_read_b64_tr_b16 v[212:213], v7 offset:36864
  ds_read_b64_tr_b16 v[214:215], v7 offset:37376
  s_waitcnt lgkmcnt(6)
  v_mfma_f32_32x32x16_bf16 v[176:191], v[196:199], v[60:63], v[176:191]
  s_add_u32 m0, s38, 20480
  s_add_u32 s46, s95, 86016
  buffer_load_dwordx4 v4, s[24:27], s46 offen lds
  v_add_u32 v237, v237, v222
  v_mul_u32_u24 v237, 896, v237
  v_add_u32 v237, v237, v5
  ds_read_b64_tr_b16 v[192:193], v7 offset:40960
  ds_read_b64_tr_b16 v[194:195], v7 offset:41472
  v_mfma_f32_32x32x16_bf16 v[160:175], v[200:203], v[120:123], v[160:175]
  v_add_u32 v222, 48, v228
  v_subrev_u32 v222, 42, v222
  ds_read_b64_tr_b16 v[196:197], v7 offset:45056
  ds_read_b64_tr_b16 v[198:199], v7 offset:45568
  s_waitcnt lgkmcnt(6)
  v_mfma_f32_32x32x16_bf16 v[176:191], v[204:207], v[64:67], v[176:191]
  v_add_u32 v238, 168, v222
  v_cmp_gt_u32 vcc, 12, v222
  v_and_b32 v222, 12, v222
  v_add_u32 v238, v238, v222
  v_cndmask_b32 v222, 0, v229, vcc
  v_add_u32 v238, v238, v222
  ds_read_b64_tr_b16 v[200:201], v7 offset:49152
  ds_read_b64_tr_b16 v[202:203], v7 offset:49664
  v_mfma_f32_32x32x16_bf16 v[160:175], v[208:211], v[124:127], v[160:175]
  v_mul_u32_u24 v238, 896, v238
  v_add_u32 v238, v238, v5
  ds_read_b64_tr_b16 v[204:205], v7 offset:53248
  ds_read_b64_tr_b16 v[206:207], v7 offset:53760
  s_waitcnt lgkmcnt(6)
  v_mfma_f32_32x32x16_bf16 v[176:191], v[212:215], v[68:71], v[176:191]
  s_barrier
  v_mfma_f32_32x32x16_bf16 v[176:191], v[192:195], v[72:75], v[176:191]
  ds_read_b64_tr_b16 v[208:209], v7 offset:57344
  ds_read_b64_tr_b16 v[210:211], v7 offset:57856
  s_add_u32 m0, s38, 24576
  s_add_u32 s46, s96, 57344
  buffer_load_dwordx4 v4, s[24:27], s46 offen lds
  v_mul_f32 v216, v160, v160
  v_mul_f32 v217, v161, v161
  v_mul_f32 v218, v162, v162
  v_mul_f32 v219, v163, v163
  v_fmamk_f32 v216, v216, 0xbdd2d3e8, v8
  v_fmamk_f32 v217, v217, 0xbdd2d3e8, v8
  v_fmamk_f32 v218, v218, 0xbdd2d3e8, v8
  v_fmamk_f32 v219, v219, 0xbdd2d3e8, v8
  ds_read_b64_tr_b16 v[212:213], v7 offset:61440
  ds_read_b64_tr_b16 v[214:215], v7 offset:61952
  s_waitcnt lgkmcnt(6)
  v_mfma_f32_32x32x16_bf16 v[176:191], v[196:199], v[76:79], v[176:191]
  s_add_u32 m0, s38, 28672
  s_add_u32 s46, s96, 86016
  buffer_load_dwordx4 v4, s[24:27], s46 offen lds
  v_mul_f32 v216, v216, v160
  v_mul_f32 v217, v217, v161
  v_mul_f32 v218, v218, v162
  v_mul_f32 v219, v219, v163
  v_exp_f32 v216, v216
  v_mul_f32 v168, v160, v168
  v_add_u32 v7, 98304, v7
  ds_read_b64_tr_b16 v[192:193], v7 offset:24576
  ds_read_b64_tr_b16 v[194:195], v7 offset:25088
  v_mfma_f32_32x32x16_bf16 v[176:191], v[200:203], v[80:83], v[176:191]
  s_add_u32 m0, s38, 32768
  s_add_u32 s46, s97, 57344
  buffer_load_dwordx4 v4, s[24:27], s46 offen lds
  v_exp_f32 v217, v217
  v_mul_f32 v169, v161, v169
  v_exp_f32 v218, v218
  v_mul_f32 v170, v162, v170
  v_exp_f32 v219, v219
  ds_read_b64_tr_b16 v[196:197], v7 offset:28672
  ds_read_b64_tr_b16 v[198:199], v7 offset:29184
  s_waitcnt lgkmcnt(6)
  v_mfma_f32_32x32x16_bf16 v[176:191], v[204:207], v[84:87], v[176:191]
  s_add_u32 m0, s38, 36864
  s_add_u32 s46, s97, 86016
  buffer_load_dwordx4 v4, s[24:27], s46 offen lds
  v_mul_f32 v171, v163, v171
  v_add_f32 v216, 1.0, v216
  v_add_f32 v217, 1.0, v217
  v_add_f32 v218, 1.0, v218
  v_add_f32 v219, 1.0, v219
  v_rcp_f32 v216, v216
  ds_read_b64_tr_b16 v[200:201], v7 offset:32768
  ds_read_b64_tr_b16 v[202:203], v7 offset:33280
  v_mfma_f32_32x32x16_bf16 v[176:191], v[208:211], v[88:91], v[176:191]
  v_rcp_f32 v217, v217
  v_rcp_f32 v218, v218
  v_rcp_f32 v219, v219
  ds_read_b64_tr_b16 v[204:205], v7 offset:36864
  ds_read_b64_tr_b16 v[206:207], v7 offset:37376
  s_waitcnt lgkmcnt(6)
  v_mfma_f32_32x32x16_bf16 v[176:191], v[212:215], v[92:95], v[176:191]
  s_barrier
  v_mfma_f32_32x32x16_bf16 v[176:191], v[192:195], v[96:99], v[176:191]
  v_add_u32 v7, 4294934528, v7
  ds_read_b64_tr_b16 v[208:209], v7 offset:0
  ds_read_b64_tr_b16 v[210:211], v7 offset:512
  v_mul_f32 v168, v168, v216
  v_mul_f32 v169, v169, v217
  v_mul_f32 v170, v170, v218
  v_mul_f32 v171, v171, v219
  v_mul_f32 v216, v164, v164
  v_mul_f32 v217, v165, v165
  v_mul_f32 v218, v166, v166
  s_add_u32 m0, s38, 40960
  s_add_u32 s46, s98, 57344
  buffer_load_dwordx4 v4, s[24:27], s46 offen lds
  v_mul_f32 v219, v167, v167
  v_fmamk_f32 v216, v216, 0xbdd2d3e8, v8
  v_fmamk_f32 v217, v217, 0xbdd2d3e8, v8
  v_fmamk_f32 v218, v218, 0xbdd2d3e8, v8
  v_fmamk_f32 v219, v219, 0xbdd2d3e8, v8
  v_mul_f32 v216, v216, v164
  v_mul_f32 v217, v217, v165
  ds_read_b64_tr_b16 v[212:213], v7 offset:4096
  ds_read_b64_tr_b16 v[214:215], v7 offset:4608
  s_waitcnt lgkmcnt(6)
  v_mfma_f32_32x32x16_bf16 v[176:191], v[196:199], v[100:103], v[176:191]
  s_add_u32 m0, s38, 45056
  s_add_u32 s46, s98, 86016
  buffer_load_dwordx4 v4, s[24:27], s46 offen lds
  v_mul_f32 v218, v218, v166
  v_mul_f32 v219, v219, v167
  v_exp_f32 v216, v216
  v_mul_f32 v172, v164, v172
  v_exp_f32 v217, v217
  ds_read_b64_tr_b16 v[192:193], v7 offset:8192
  ds_read_b64_tr_b16 v[194:195], v7 offset:8704
  v_mfma_f32_32x32x16_bf16 v[176:191], v[200:203], v[104:107], v[176:191]
  s_add_u32 m0, s38, 49152
  s_mov_b32 s46, 0
  buffer_load_dwordx4 v232, s[16:19], s46 offen lds
  v_mul_f32 v173, v165, v173
  v_exp_f32 v218, v218
  v_mul_f32 v174, v166, v174
  v_exp_f32 v219, v219
  v_mul_f32 v175, v167, v175
  ds_read_b64_tr_b16 v[196:197], v7 offset:12288
  ds_read_b64_tr_b16 v[198:199], v7 offset:12800
  s_waitcnt lgkmcnt(6)
  v_mfma_f32_32x32x16_bf16 v[176:191], v[204:207], v[108:111], v[176:191]
  s_add_u32 m0, s38, 53248
  s_mov_b32 s46, 200704
  buffer_load_dwordx4 v232, s[16:19], s46 offen lds
  v_add_f32 v216, 1.0, v216
  v_add_f32 v217, 1.0, v217
  v_add_f32 v218, 1.0, v218
  v_add_f32 v219, 1.0, v219
  v_rcp_f32 v216, v216
  v_rcp_f32 v217, v217
  v_mfma_f32_32x32x16_bf16 v[176:191], v[208:211], v[112:115], v[176:191]
  s_add_u32 m0, s38, 57344
  s_mov_b32 s46, 0
  buffer_load_dwordx4 v233, s[16:19], s46 offen lds
  v_rcp_f32 v218, v218
  v_rcp_f32 v219, v219
  v_mul_f32 v172, v172, v216
  v_mul_f32 v173, v173, v217
  s_waitcnt lgkmcnt(2)
  v_mfma_f32_32x32x16_bf16 v[176:191], v[212:215], v[116:119], v[176:191]
  s_add_u32 m0, s38, 61440
  s_mov_b32 s46, 200704
  buffer_load_dwordx4 v233, s[16:19], s46 offen lds
  v_mul_f32 v174, v174, v218
  v_mul_f32 v175, v175, v219
  v_cvt_pk_bf16_f32 v248, v168, v169
  v_cvt_pk_bf16_f32 v249, v170, v171
  v_cvt_pk_bf16_f32 v250, v172, v173
  v_cvt_pk_bf16_f32 v251, v174, v175
  s_add_u32 s47, s83, 4096
  buffer_store_dwordx4 v[248:251], v1, s[32:35], s47 offen offset:0 sc1
  v_mfma_f32_32x32x16_bf16 v[176:191], v[192:195], v[120:123], v[176:191]
  s_waitcnt lgkmcnt(0)
  v_mfma_f32_32x32x16_bf16 v[176:191], v[196:199], v[124:127], v[176:191]
  s_add_u32 s80, s99, 1024
  buffer_load_dword v10, v9, s[32:35], s80 offen sc1
  s_waitcnt vmcnt(20)
  s_barrier
  s_nop 7
  v_mul_f32 v216, v176, v176
  v_mul_f32 v217, v177, v177
  v_mul_f32 v218, v178, v178
  v_mul_f32 v219, v179, v179
  v_fmamk_f32 v216, v216, 0xbdd2d3e8, v8
  s_add_u32 m0, s38, 122880
  s_mov_b32 s46, 0
  buffer_load_dwordx4 v234, s[16:19], s46 offen lds
  v_fmamk_f32 v217, v217, 0xbdd2d3e8, v8
  v_fmamk_f32 v218, v218, 0xbdd2d3e8, v8
  v_fmamk_f32 v219, v219, 0xbdd2d3e8, v8
  v_mul_f32 v216, v216, v176
  v_mul_f32 v217, v217, v177
  v_mul_f32 v218, v218, v178
  v_mul_f32 v219, v219, v179
  v_exp_f32 v216, v216
  v_mul_f32 v184, v176, v184
  v_exp_f32 v217, v217
  v_mul_f32 v185, v177, v185
  v_exp_f32 v218, v218
  v_mul_f32 v186, v178, v186
  s_add_u32 m0, s38, 131072
  s_mov_b32 s46, 0
  buffer_load_dwordx4 v235, s[16:19], s46 offen lds
  v_exp_f32 v219, v219
  v_mul_f32 v187, v179, v187
  v_add_f32 v216, 1.0, v216
  v_add_f32 v217, 1.0, v217
  v_add_f32 v218, 1.0, v218
  v_add_f32 v219, 1.0, v219
  v_rcp_f32 v216, v216
  v_rcp_f32 v217, v217
  v_rcp_f32 v218, v218
  v_rcp_f32 v219, v219
  v_mul_f32 v184, v184, v216
  v_mul_f32 v185, v185, v217
  v_mul_f32 v186, v186, v218
  s_add_u32 m0, s38, 65536
  s_mov_b32 s46, 0
  buffer_load_dwordx4 v236, s[16:19], s46 offen lds
  v_mul_f32 v187, v187, v219
  v_mul_f32 v216, v180, v180
  v_mul_f32 v217, v181, v181
  v_mul_f32 v218, v182, v182
  v_mul_f32 v219, v183, v183
  v_fmamk_f32 v216, v216, 0xbdd2d3e8, v8
  v_fmamk_f32 v217, v217, 0xbdd2d3e8, v8
  v_fmamk_f32 v218, v218, 0xbdd2d3e8, v8
  v_fmamk_f32 v219, v219, 0xbdd2d3e8, v8
  v_mul_f32 v216, v216, v180
  v_mul_f32 v217, v217, v181
  v_mul_f32 v218, v218, v182
  v_mul_f32 v219, v219, v183
  s_add_u32 m0, s38, 73728
  s_mov_b32 s46, 0
  buffer_load_dwordx4 v237, s[16:19], s46 offen lds
  v_exp_f32 v216, v216
  v_mul_f32 v188, v180, v188
  v_exp_f32 v217, v217
  v_mul_f32 v189, v181, v189
  v_exp_f32 v218, v218
  v_mul_f32 v190, v182, v190
  v_exp_f32 v219, v219
  v_mul_f32 v191, v183, v191
  v_add_f32 v216, 1.0, v216
  v_add_f32 v217, 1.0, v217
  v_add_f32 v218, 1.0, v218
  v_add_f32 v219, 1.0, v219
  v_rcp_f32 v216, v216
  v_rcp_f32 v217, v217
  v_rcp_f32 v218, v218
  v_rcp_f32 v219, v219
  s_waitcnt vmcnt(5)
  s_add_u32 s47, s100, 2048
  v_mov_b32 v12, s43
  s_mov_b64 exec, 0xff
  buffer_store_dwordx4 v[12:15], v1, s[32:35], s47 offen sc1
  s_mov_b64 exec, -1
  v_mul_f32 v188, v188, v216
  v_mul_f32 v189, v189, v217
  v_mul_f32 v190, v190, v218
  v_mul_f32 v191, v191, v219
  v_cvt_pk_bf16_f32 v252, v184, v185
  v_cvt_pk_bf16_f32 v253, v186, v187
  v_cvt_pk_bf16_f32 v254, v188, v189
  v_cvt_pk_bf16_f32 v255, v190, v191
  s_add_u32 s47, s83, 4096
  buffer_store_dwordx4 v[252:255], v1, s[32:35], s47 offen offset:1024 sc1
  s_waitcnt vmcnt(6)
  v_cmp_ne_u32 vcc, s43, v10
  s_nop 1
  s_cbranch_vccnz L_slow_2
L_ok_1:
  buffer_load_dwordx4 v[16:19], v1, s[32:35], s86 offen offset:0 sc1
  buffer_load_dwordx4 v[20:23], v1, s[32:35], s87 offen offset:0 sc1
  buffer_load_dwordx4 v[24:27], v1, s[32:35], s88 offen offset:0 sc1
  buffer_load_dwordx4 v[28:31], v1, s[32:35], s89 offen offset:0 sc1
  s_cmp_lg_u32 s67, 0
  s_cbranch_scc1 L_snd_4
  v_add_u32 v2, 65536, v2
  ds_read_b64_tr_b16 v[192:193], v2 offset:16384
  ds_read_b64_tr_b16 v[194:195], v2 offset:17408
  v_add_u32 v220, 65536, v220
  ds_read_b64_tr_b16 v[196:197], v220 offset:16384
  ds_read_b64_tr_b16 v[198:199], v220 offset:17408
  ds_read_b64_tr_b16 v[200:201], v2 offset:18432
  ds_read_b64_tr_b16 v[202:203], v2 offset:19456
  ds_read_b64_tr_b16 v[204:205], v220 offset:18432
  ds_read_b64_tr_b16 v[206:207], v220 offset:19456
  v_add_u32 v2, 4294901760, v2
  ds_read_b64_tr_b16 v[208:209], v2 offset:0
  ds_read_b64_tr_b16 v[210:211], v2 offset:1024
  s_waitcnt lgkmcnt(6)
  v_mfma_f32_32x32x16_bf16 v[128:143], v[192:195], v[240:243], 0
  v_add_u32 v220, 4294901760, v220
  ds_read_b64_tr_b16 v[212:213], v220 offset:0
  ds_read_b64_tr_b16 v[214:215], v220 offset:1024
  v_mfma_f32_32x32x16_bf16 v[144:159], v[196:199], v[240:243], 0
  ds_read_b64_tr_b16 v[192:193], v2 offset:2048
  ds_read_b64_tr_b16 v[194:195], v2 offset:3072
  s_waitcnt lgkmcnt(6)
  v_mfma_f32_32x32x16_bf16 v[128:143], v[200:203], v[244:247], v[128:143]
  ds_read_b64_tr_b16 v[196:197], v220 offset:2048
  ds_read_b64_tr_b16 v[198:199], v220 offset:3072
  v_mfma_f32_32x32x16_bf16 v[144:159], v[204:207], v[244:247], v[144:159]
  v_add_u32 v2, 65536, v2
  ds_read_b64_tr_b16 v[200:201], v2 offset:24576
  ds_read_b64_tr_b16 v[202:203], v2 offset:25600
  s_waitcnt lgkmcnt(6)
  v_mfma_f32_32x32x16_bf16 v[128:143], v[208:211], v[248:251], v[128:143]
  v_add_u32 v220, 65536, v220
  ds_read_b64_tr_b16 v[204:205], v220 offset:24576
  ds_read_b64_tr_b16 v[206:207], v220 offset:25600
  v_mfma_f32_32x32x16_bf16 v[144:159], v[212:215], v[248:251], v[144:159]
  v_add_u32 v2, 32768, v2
  ds_read_b64_tr_b16 v[208:209], v2 offset:40960
  ds_read_b64_tr_b16 v[210:211], v2 offset:41984
  s_waitcnt lgkmcnt(6)
  v_mfma_f32_32x32x16_bf16 v[128:143], v[192:195], v[252:255], v[128:143]
  v_min_u32 v222, 1, v15
  v_lshlrev_b32 v222, 7, v222
  s_lshl_b32 s56, s82, 8
  s_add_u32 s56, s56, 262144
  buffer_load_dword v223, v222, s[32:35], s56 offen sc1
  v_add_u32 v220, 32768, v220
  ds_read_b64_tr_b16 v[212:213], v220 offset:40960
  ds_read_b64_tr_b16 v[214:215], v220 offset:41984
  v_mfma_f32_32x32x16_bf16 v[144:159], v[196:199], v[252:255], v[144:159]
  s_waitcnt vmcnt(5)
  s_add_u32 s47, s100, 3072
  v_mov_b32 v12, s43
  s_mov_b64 exec, 0xff
  buffer_store_dwordx4 v[12:15], v1, s[32:35], s47 offen sc1
  s_mov_b64 exec, -1
  ds_read_b64_tr_b16 v[192:193], v2 offset:49152
  ds_read_b64_tr_b16 v[194:195], v2 offset:50176
  s_waitcnt lgkmcnt(6)
  s_waitcnt vmcnt(5)
  v_mfma_f32_32x32x16_bf16 v[128:143], v[200:203], v[16:19], v[128:143]
  buffer_load_dwordx4 v[32:35], v1, s[32:35], s90 offen offset:0 sc1
  ds_read_b64_tr_b16 v[196:197], v220 offset:49152
  ds_read_b64_tr_b16 v[198:199], v220 offset:50176
  v_mfma_f32_32x32x16_bf16 v[144:159], v[204:207], v[16:19], v[144:159]
  ds_read_b64_tr_b16 v[200:201], v2 offset:0
  ds_read_b64_tr_b16 v[202:203], v2 offset:1024
  s_waitcnt lgkmcnt(6)
  s_waitcnt vmcnt(5)
  v_mfma_f32_32x32x16_bf16 v[128:143], v[208:211], v[20:23], v[128:143]
  buffer_load_dwordx4 v[36:39], v1, s[32:35], s91 offen offset:0 sc1
  v_and_b32 v11, 7, v15
  v_lshrrev_b32 v12, 4, v15
  ds_read_b64_tr_b16 v[204:205], v220 offset:0
  ds_read_b64_tr_b16 v[206:207], v220 offset:1024
  v_mfma_f32_32x32x16_bf16 v[144:159], v[212:215], v[20:23], v[144:159]
  v_and_b32 v12, 2, v12
  ds_read_b64_tr_b16 v[208:209], v2 offset:8192
  ds_read_b64_tr_b16 v[210:211], v2 offset:9216
  s_waitcnt lgkmcnt(6)
  s_waitcnt vmcnt(5)
  v_mfma_f32_32x32x16_bf16 v[128:143], v[192:195], v[24:27], v[128:143]
  buffer_load_dwordx4 v[40:43], v1, s[32:35], s86 offen offset:1024 sc1
  v_xor_b32 v12, v12, v11
  ds_read_b64_tr_b16 v[212:213], v220 offset:8192
  ds_read_b64_tr_b16 v[214:215], v220 offset:9216
  v_mfma_f32_32x32x16_bf16 v[144:159], v[196:199], v[24:27], v[144:159]
  v_and_b32 v13, 31, v15
  v_lshlrev_b32 v13, 7, v13
  ds_read_b64_tr_b16 v[192:193], v2 offset:16384
  ds_read_b64_tr_b16 v[194:195], v2 offset:17408
  s_waitcnt lgkmcnt(6)
  s_waitcnt vmcnt(5)
  v_mfma_f32_32x32x16_bf16 v[128:143], v[200:203], v[28:31], v[128:143]
  buffer_load_dwordx4 v[44:47], v1, s[32:35], s87 offen offset:1024 sc1
  v_lshl_add_u32 v12, v12, 4, v13
  ds_read_b64_tr_b16 v[196:197], v220 offset:16384
  ds_read_b64_tr_b16 v[198:199], v220 offset:17408
  v_mfma_f32_32x32x16_bf16 v[144:159], v[204:207], v[28:31], v[144:159]
  s_bitcmp1_b32 s37, 0
  s_cselect_b32 s54, 17, 0
  s_cselect_b32 s49, 18, 11
  s_cselect_b32 s52, 13, 12
  v_add_u32 v2, 4294934528, v2
  ds_read_b64_tr_b16 v[200:201], v2 offset:26624
  ds_read_b64_tr_b16 v[202:203], v2 offset:27648
  s_waitcnt lgkmcnt(6)
  s_waitcnt vmcnt(3)
  v_mfma_f32_32x32x16_bf16 v[128:143], v[208:211], v[32:35], v[128:143]
  buffer_load_dwordx4 v[48:51], v1, s[32:35], s88 offen offset:1024 sc1
  v_cmp_ne_u32 vcc, s43, v223
  s_nop 1
  s_cbranch_vccnz L_slow_6
L_ok_5:
  v_lshl_add_u32 v240, s54, 13, v12
  v_add_u32 v220, 4294934528, v220
  ds_read_b64_tr_b16 v[204:205], v220 offset:26624
  ds_read_b64_tr_b16 v[206:207], v220 offset:27648
  v_mfma_f32_32x32x16_bf16 v[144:159], v[212:215], v[32:35], v[144:159]
  v_xor_b32 v241, 16, v240
  v_xor_b32 v242, 64, v240
  v_add_u32 v2, 32768, v2
  ds_read_b64_tr_b16 v[208:209], v2 offset:43008
  ds_read_b64_tr_b16 v[210:211], v2 offset:44032
  s_waitcnt lgkmcnt(6)
  s_waitcnt vmcnt(3)
  v_mfma_f32_32x32x16_bf16 v[128:143], v[192:195], v[36:39], v[128:143]
  s_add_u32 s80, s99, 2048
  buffer_load_dword v10, v9, s[32:35], s80 offen sc1
  buffer_load_dwordx4 v[52:55], v1, s[32:35], s89 offen offset:1024 sc1
  v_xor_b32 v243, 80, v240
  v_add_u32 v220, 32768, v220
  ds_read_b64_tr_b16 v[212:213], v220 offset:43008
  ds_read_b64_tr_b16 v[214:215], v220 offset:44032
  v_mfma_f32_32x32x16_bf16 v[144:159], v[196:199], v[36:39], v[144:159]
  v_lshrrev_b32 v12, 3, v15
  ds_read_b64_tr_b16 v[192:193], v2 offset:51200
  ds_read_b64_tr_b16 v[194:195], v2 offset:52224
  s_waitcnt lgkmcnt(6)
  s_waitcnt vmcnt(4)
  v_mfma_f32_32x32x16_bf16 v[128:143], v[200:203], v[40:43], v[128:143]
  buffer_load_dwordx4 v[56:59], v1, s[32:35], s90 offen offset:1024 sc1
  v_lshlrev_b32 v13, 4, v12
  ds_read_b64_tr_b16 v[196:197], v220 offset:51200
  ds_read_b64_tr_b16 v[198:199], v220 offset:52224
  s_waitcnt vmcnt(4) lgkmcnt(6)
  v_mfma_f32_32x32x16_bf16 v[144:159], v[204:207], v[40:43], v[144:159]
  s_barrier
  v_mfma_f32_32x32x16_bf16 v[128:143], v[208:211], v[44:47], v[128:143]
  ds_read_b64_tr_b16 v[200:201], v2 offset:2048
  ds_read_b64_tr_b16 v[202:203], v2 offset:3072
  v_xor_b32 v13, v13, v1
  v_lshl_add_u32 v244, s54, 13, v13
  buffer_load_dwordx4 v[60:63], v1, s[32:35], s91 offen offset:1024 sc1
  v_lshl_add_u32 v245, s49, 13, v13
  ds_read_b64_tr_b16 v[204:205], v220 offset:2048
  ds_read_b64_tr_b16 v[206:207], v220 offset:3072
  s_waitcnt lgkmcnt(6)
  v_mfma_f32_32x32x16_bf16 v[144:159], v[212:215], v[44:47], v[144:159]
  s_add_u32 m0, s38, 81920
  s_mov_b32 s46, 0
  buffer_load_dwordx4 v238, s[16:19], s46 offen lds
  v_and_b32 v13, 2, v15
  ds_read_b64_tr_b16 v[208:209], v2 offset:10240
  ds_read_b64_tr_b16 v[210:211], v2 offset:11264
  s_waitcnt vmcnt(5)
  v_mfma_f32_32x32x16_bf16 v[128:143], v[192:195], v[48:51], v[128:143]
  s_waitcnt vmcnt(4)
  v_cmp_ne_u32 vcc, s43, v10
  s_nop 1
  s_cbranch_vccnz L_slow_9
L_ok_8:
  v_add_u32 v3, 4096, v1
  buffer_load_dwordx4 v[64:67], v3, s[32:35], s86 offen offset:0 sc1
  v_lshlrev_b32 v13, 1, v13
  ds_read_b64_tr_b16 v[212:213], v220 offset:10240
  ds_read_b64_tr_b16 v[214:215], v220 offset:11264
  s_waitcnt lgkmcnt(6)
  v_mfma_f32_32x32x16_bf16 v[144:159], v[196:199], v[48:51], v[144:159]
  v_xor_b32 v13, v13, v12
  v_lshlrev_b32 v13, 4, v13
  ds_read_b64_tr_b16 v[192:193], v2 offset:18432
  ds_read_b64_tr_b16 v[194:195], v2 offset:19456
  s_waitcnt vmcnt(4)
  v_mfma_f32_32x32x16_bf16 v[128:143], v[200:203], v[52:55], v[128:143]
  buffer_load_dwordx4 v[68:71], v3, s[32:35], s87 offen offset:0 sc1
  v_lshl_add_u32 v13, v11, 7, v13
  ds_read_b64_tr_b16 v[196:197], v220 offset:18432
  ds_read_b64_tr_b16 v[198:199], v220 offset:19456
  s_waitcnt lgkmcnt(6)
  v_mfma_f32_32x32x16_bf16 v[144:159], v[204:207], v[52:55], v[144:159]
  s_lshl_b32 s52, s52, 13
  ds_read_b64_tr_b16 v[200:201], v2 offset:57344
  ds_read_b64_tr_b16 v[202:203], v2 offset:58368
  s_waitcnt vmcnt(4)
  v_mfma_f32_32x32x16_bf16 v[128:143], v[208:211], v[56:59], v[128:143]
  buffer_load_dwordx4 v[72:75], v3, s[32:35], s88 offen offset:0 sc1
  s_lshl1_add_u32 s57, s40, 0
  s_lshl3_add_u32 s57, s57, s58
  s_lshl_b32 s57, s57, 12
  s_add_u32 s57, s57, 2097152
  v_mov_b32 v222, 896
  buffer_load_dword v223, v222, s[32:35], s57 offen sc1
  s_add_u32 s3, s51, 4096
  s_add_u32 s52, s52, 0
  v_add_u32 v247, s52, v13
  ds_read_b64_tr_b16 v[204:205], v220 offset:57344
  ds_read_b64_tr_b16 v[206:207], v220 offset:58368
  s_waitcnt lgkmcnt(6)
  v_mfma_f32_32x32x16_bf16 v[144:159], v[212:215], v[56:59], v[144:159]
  v_bfe_u32 v13, v15, 4, 1
  v_add_u32 v2, 4294868992, v2
  ds_read_b64_tr_b16 v[208:209], v2 offset:8192
  ds_read_b64_tr_b16 v[210:211], v2 offset:9216
  s_waitcnt vmcnt(5)
  v_mfma_f32_32x32x16_bf16 v[128:143], v[192:195], v[60:63], v[128:143]
  s_add_u32 s80, s99, 3072
  buffer_load_dword v10, v9, s[32:35], s80 offen sc1
  buffer_load_dwordx4 v[76:79], v3, s[32:35], s89 offen offset:0 sc1
  v_lshlrev_b32 v246, 2, v13
  v_add_u32 v220, 4294868992, v220
  ds_read_b64_tr_b16 v[212:213], v220 offset:8192
  ds_read_b64_tr_b16 v[214:215], v220 offset:9216
  s_waitcnt lgkmcnt(6)
  v_mfma_f32_32x32x16_bf16 v[144:159], v[196:199], v[60:63], v[144:159]
  v_xor_b32 v246, v246, v11
  ds_read_b64_tr_b16 v[192:193], v2 offset:16384
  ds_read_b64_tr_b16 v[194:195], v2 offset:17408
  s_waitcnt vmcnt(5)
  v_mfma_f32_32x32x16_bf16 v[128:143], v[200:203], v[64:67], v[128:143]
  buffer_load_dwordx4 v[80:83], v3, s[32:35], s90 offen offset:0 sc1
  v_lshlrev_b32 v246, 4, v246
  v_lshl_add_u32 v246, v13, 9, v246
  ds_read_b64_tr_b16 v[196:197], v220 offset:16384
  ds_read_b64_tr_b16 v[198:199], v220 offset:17408
  s_waitcnt lgkmcnt(6)
  v_mfma_f32_32x32x16_bf16 v[144:159], v[204:207], v[64:67], v[144:159]
  v_and_b32 v13, 1, v12
  ds_read_b64_tr_b16 v[200:201], v2 offset:24576
  ds_read_b64_tr_b16 v[202:203], v2 offset:25600
  s_waitcnt vmcnt(5)
  v_mfma_f32_32x32x16_bf16 v[128:143], v[208:211], v[68:71], v[128:143]
  buffer_load_dwordx4 v[84:87], v3, s[32:35], s91 offen offset:0 sc1
  v_lshl_add_u32 v246, v13, 10, v246
  ds_read_b64_tr_b16 v[204:205], v220 offset:24576
  ds_read_b64_tr_b16 v[206:207], v220 offset:25600
  s_waitcnt lgkmcnt(6)
  v_mfma_f32_32x32x16_bf16 v[144:159], v[212:215], v[68:71], v[144:159]
  v_lshrrev_b32 v13, 5, v15
  ds_read_b64_tr_b16 v[208:209], v2 offset:32768
  ds_read_b64_tr_b16 v[210:211], v2 offset:33792
  s_waitcnt vmcnt(5)
  v_mfma_f32_32x32x16_bf16 v[128:143], v[192:195], v[72:75], v[128:143]
  s_waitcnt vmcnt(3)
  v_cmp_ne_u32 vcc, s43, v10
  s_nop 1
  s_cbranch_vccnz L_slow_12
L_ok_11:
  buffer_load_dwordx4 v[88:91], v3, s[32:35], s86 offen offset:1024 sc1
  v_lshl_add_u32 v246, v13, 11, v246
  v_mov_b32 v248, 0x3f80
  ds_read_b64_tr_b16 v[212:213], v220 offset:32768
  ds_read_b64_tr_b16 v[214:215], v220 offset:33792
  s_waitcnt lgkmcnt(6)
  v_mfma_f32_32x32x16_bf16 v[144:159], v[196:199], v[72:75], v[144:159]
  v_mov_b32 v249, 0
  ds_read_b64_tr_b16 v[192:193], v2 offset:40960
  ds_read_b64_tr_b16 v[194:195], v2 offset:41984
  s_waitcnt vmcnt(3)
  v_mfma_f32_32x32x16_bf16 v[128:143], v[200:203], v[76:79], v[128:143]
  buffer_load_dwordx4 v[92:95], v3, s[32:35], s87 offen offset:1024 sc1
  v_cmp_ne_u32 vcc, s43, v223
  s_nop 1
  s_cbranch_vccnz L_slow_15
L_ok_14:
  v_and_b32 v13, 0x30, v1
  ds_read_b64_tr_b16 v[196:197], v220 offset:40960
  ds_read_b64_tr_b16 v[198:199], v220 offset:41984
  s_waitcnt lgkmcnt(6)
  v_mfma_f32_32x32x16_bf16 v[144:159], v[204:207], v[76:79], v[144:159]
  v_lshlrev_b64 v[248:249], v13, v[248:249]
  v_add_u32 v2, 98304, v2
  ds_read_b64_tr_b16 v[200:201], v2 offset:59392
  ds_read_b64_tr_b16 v[202:203], v2 offset:60416
  s_waitcnt vmcnt(3)
  v_mfma_f32_32x32x16_bf16 v[128:143], v[208:211], v[80:83], v[128:143]
  buffer_load_dwordx4 v[96:99], v3, s[32:35], s88 offen offset:1024 sc1
  v_add_u32 v220, 98304, v220
  ds_read_b64_tr_b16 v[204:205], v220 offset:59392
  ds_read_b64_tr_b16 v[206:207], v220 offset:60416
  s_waitcnt vmcnt(3) lgkmcnt(6)
  v_mfma_f32_32x32x16_bf16 v[144:159], v[212:215], v[80:83], v[144:159]
  s_barrier
  v_mfma_f32_32x32x16_bf16 v[128:143], v[192:195], v[84:87], v[128:143]
  v_add_u32 v2, 4294868992, v2
  ds_read_b64_tr_b16 v[208:209], v2 offset:10240
  ds_read_b64_tr_b16 v[210:211], v2 offset:11264
  buffer_load_dwordx4 v[100:103], v3, s[32:35], s89 offen offset:1024 sc1
  v_add_u32 v220, 4294868992, v220
  ds_read_b64_tr_b16 v[212:213], v220 offset:10240
  ds_read_b64_tr_b16 v[214:215], v220 offset:11264
  s_waitcnt lgkmcnt(6)
  v_mfma_f32_32x32x16_bf16 v[144:159], v[196:199], v[84:87], v[144:159]
  ds_read_b64_tr_b16 v[192:193], v2 offset:18432
  ds_read_b64_tr_b16 v[194:195], v2 offset:19456
  s_waitcnt vmcnt(3)
  v_mfma_f32_32x32x16_bf16 v[128:143], v[200:203], v[88:91], v[128:143]
  buffer_load_dwordx4 v[104:107], v3, s[32:35], s90 offen offset:1024 sc1
  ds_read_b64_tr_b16 v[196:197], v220 offset:18432
  ds_read_b64_tr_b16 v[198:199], v220 offset:19456
  s_waitcnt lgkmcnt(6)
  v_mfma_f32_32x32x16_bf16 v[144:159], v[204:207], v[88:91], v[144:159]
  ds_read_b64_tr_b16 v[200:201], v2 offset:26624
  ds_read_b64_tr_b16 v[202:203], v2 offset:27648
  s_waitcnt vmcnt(3)
  v_mfma_f32_32x32x16_bf16 v[128:143], v[208:211], v[92:95], v[128:143]
  buffer_load_dwordx4 v[108:111], v3, s[32:35], s91 offen offset:1024 sc1
  ds_read_b64_tr_b16 v[204:205], v220 offset:26624
  ds_read_b64_tr_b16 v[206:207], v220 offset:27648
  s_waitcnt lgkmcnt(6)
  v_mfma_f32_32x32x16_bf16 v[144:159], v[212:215], v[92:95], v[144:159]
  ds_read_b64_tr_b16 v[208:209], v2 offset:34816
  ds_read_b64_tr_b16 v[210:211], v2 offset:35840
  s_waitcnt vmcnt(3)
  v_mfma_f32_32x32x16_bf16 v[128:143], v[192:195], v[96:99], v[128:143]
  buffer_load_dwordx4 v[16:19], v1, s[32:35], s51 offen offset:0 sc1
  ds_read_b64_tr_b16 v[212:213], v220 offset:34816
  ds_read_b64_tr_b16 v[214:215], v220 offset:35840
  s_waitcnt lgkmcnt(6)
  v_mfma_f32_32x32x16_bf16 v[144:159], v[196:199], v[96:99], v[144:159]
  ds_read_b64_tr_b16 v[192:193], v2 offset:43008
  ds_read_b64_tr_b16 v[194:195], v2 offset:44032
  s_waitcnt vmcnt(3)
  v_mfma_f32_32x32x16_bf16 v[128:143], v[200:203], v[100:103], v[128:143]
  buffer_load_dwordx4 v[20:23], v1, s[32:35], s51 offen offset:1024 sc1
  ds_read_b64_tr_b16 v[196:197], v220 offset:43008
  ds_read_b64_tr_b16 v[198:199], v220 offset:44032
  s_waitcnt lgkmcnt(6)
  v_mfma_f32_32x32x16_bf16 v[144:159], v[204:207], v[100:103], v[144:159]
  ds_read_b64_tr_b16 v[200:201], v2 offset:49152
  ds_read_b64_tr_b16 v[202:203], v2 offset:50176
  s_waitcnt vmcnt(3)
  v_mfma_f32_32x32x16_bf16 v[128:143], v[208:211], v[104:107], v[128:143]
  buffer_load_dwordx4 v[24:27], v1, s[32:35], s51 offen offset:2048 sc1
  ds_read_b64_tr_b16 v[204:205], v220 offset:49152
  ds_read_b64_tr_b16 v[206:207], v220 offset:50176
  s_waitcnt lgkmcnt(6)
  v_mfma_f32_32x32x16_bf16 v[144:159], v[212:215], v[104:107], v[144:159]
  ds_read_b64_tr_b16 v[208:209], v2 offset:57344
  ds_read_b64_tr_b16 v[210:211], v2 offset:58368
  s_waitcnt vmcnt(3) lgkmcnt(6)
  v_mfma_f32_32x32x16_bf16 v[128:143], v[192:195], v[108:111], v[128:143]
  s_barrier
  v_mfma_f32_32x32x16_bf16 v[144:159], v[196:199], v[108:111], v[144:159]
  ds_read_b64_tr_b16 v[212:213], v220 offset:57344
  ds_read_b64_tr_b16 v[214:215], v220 offset:58368
  buffer_load_dwordx4 v[28:31], v1, s[32:35], s51 offen offset:3072 sc1
  s_waitcnt vmcnt(3)
  v_max3_u32 v14, v16, v17, v18
  v_max_u32 v14, v14, v19
  v_cmp_eq_u32 vcc, -1, v14
  s_cbranch_vccnz L_vslow_18
L_vok_17:
  v_add_u32 v2, 98304, v2
  ds_read_b64_tr_b16 v[192:193], v2 offset:24576
  ds_read_b64_tr_b16 v[194:195], v2 offset:25600
  s_waitcnt lgkmcnt(6)
  v_mfma_f32_32x32x16_bf16 v[128:143], v[200:203], v[16:19], v[128:143]
  buffer_load_dwordx4 v[32:35], v1, s[32:35], s3 offen offset:0 sc1
  v_add_u32 v220, 98304, v220
  ds_read_b64_tr_b16 v[196:197], v220 offset:24576
  ds_read_b64_tr_b16 v[198:199], v220 offset:25600
  v_mfma_f32_32x32x16_bf16 v[144:159], v[204:207], v[16:19], v[144:159]
  s_waitcnt vmcnt(3)
  v_max3_u32 v14, v20, v21, v22
  v_max_u32 v14, v14, v23
  v_cmp_eq_u32 vcc, -1, v14
  s_cbranch_vccnz L_vslow_21
L_vok_20:
  ds_read_b64_tr_b16 v[200:201], v2 offset:32768
  ds_read_b64_tr_b16 v[202:203], v2 offset:33792
  s_waitcnt lgkmcnt(6)
  v_mfma_f32_32x32x16_bf16 v[128:143], v[208:211], v[20:23], v[128:143]
  buffer_load_dwordx4 v[36:39], v1, s[32:35], s3 offen offset:1024 sc1
  ds_read_b64_tr_b16 v[204:205], v220 offset:32768
  ds_read_b64_tr_b16 v[206:207], v220 offset:33792
  v_mfma_f32_32x32x16_bf16 v[144:159], v[212:215], v[20:23], v[144:159]
  s_waitcnt vmcnt(3)
  v_max3_u32 v14, v24, v25, v26
  v_max_u32 v14, v14, v27
  v_cmp_eq_u32 vcc, -1, v14
  s_cbranch_vccnz L_vslow_24
L_vok_23:
  v_add_u32 v2, 4294934528, v2
  ds_read_b64_tr_b16 v[208:209], v2 offset:0
  ds_read_b64_tr_b16 v[210:211], v2 offset:1024
  s_waitcnt lgkmcnt(6)
  v_mfma_f32_32x32x16_bf16 v[128:143], v[192:195], v[24:27], v[128:143]
  buffer_load_dwordx4 v[40:43], v1, s[32:35], s3 offen offset:2048 sc1
  v_add_u32 v220, 4294934528, v220
  ds_read_b64_tr_b16 v[212:213], v220 offset:0
  ds_read_b64_tr_b16 v[214:215], v220 offset:1024
  v_mfma_f32_32x32x16_bf16 v[144:159], v[196:199], v[24:27], v[144:159]
  s_waitcnt vmcnt(3)
  v_max3_u32 v14, v28, v29, v30
  v_max_u32 v14, v14, v31
  v_cmp_eq_u32 vcc, -1, v14
  s_cbranch_vccnz L_vslow_27
L_vok_26:
  ds_read_b64_tr_b16 v[192:193], v2 offset:8192
  ds_read_b64_tr_b16 v[194:195], v2 offset:9216
  s_waitcnt lgkmcnt(6)
  v_mfma_f32_32x32x16_bf16 v[128:143], v[200:203], v[28:31], v[128:143]
  ds_read_b64_tr_b16 v[196:197], v220 offset:8192
  ds_read_b64_tr_b16 v[198:199], v220 offset:9216
  v_mfma_f32_32x32x16_bf16 v[144:159], v[204:207], v[28:31], v[144:159]
  s_waitcnt vmcnt(2)
  v_max3_u32 v14, v32, v33, v34
  v_max_u32 v14, v14, v35
  v_cmp_eq_u32 vcc, -1, v14
  s_cbranch_vccnz L_vslow_30
L_vok_29:
  ds_read_b64_tr_b16 v[200:201], v2 offset:16384
  ds_read_b64_tr_b16 v[202:203], v2 offset:17408
  s_waitcnt lgkmcnt(6)
  v_mfma_f32_32x32x16_bf16 v[128:143], v[208:211], v[32:35], v[128:143]
  ds_read_b64_tr_b16 v[204:205], v220 offset:16384
  ds_read_b64_tr_b16 v[206:207], v220 offset:17408
  v_mfma_f32_32x32x16_bf16 v[144:159], v[212:215], v[32:35], v[144:159]
  s_waitcnt vmcnt(1)
  v_max3_u32 v14, v36, v37, v38
  v_max_u32 v14, v14, v39
  v_cmp_eq_u32 vcc, -1, v14
  s_cbranch_vccnz L_vslow_33
L_vok_32:
  s_waitcnt lgkmcnt(4)
  v_mfma_f32_32x32x16_bf16 v[128:143], v[192:195], v[36:39], v[128:143]
  v_mfma_f32_32x32x16_bf16 v[144:159], v[196:199], v[36:39], v[144:159]
  s_waitcnt vmcnt(0)
  v_max3_u32 v14, v40, v41, v42
  v_max_u32 v14, v14, v43
  v_cmp_eq_u32 vcc, -1, v14
  s_cbranch_vccnz L_vslow_36
L_vok_35:
  s_waitcnt lgkmcnt(0)
  v_mfma_f32_32x32x16_bf16 v[128:143], v[200:203], v[40:43], v[128:143]
  v_mfma_f32_32x32x16_bf16 v[144:159], v[204:207], v[40:43], v[144:159]
  v_mfma_f32_4x4x4_16b_bf16 v[64:67], v[248:249], v[224:225], 0
  v_mfma_f32_4x4x4_16b_bf16 v[68:71], v[248:249], v[226:227], 0
  s_nop 8
  v_cvt_pk_bf16_f32 v16, v128, v129
  v_cvt_pk_bf16_f32 v17, v130, v131
  v_cvt_pk_bf16_f32 v18, v132, v133
  v_cvt_pk_bf16_f32 v19, v134, v135
  ds_write_b128 v240, v[16:19] offset:0
  v_cvt_pk_bf16_f32 v20, v136, v137
  v_cvt_pk_bf16_f32 v21, v138, v139
  v_cvt_pk_bf16_f32 v22, v140, v141
  v_cvt_pk_bf16_f32 v23, v142, v143
  ds_write_b128 v241, v[20:23] offset:0
  v_cvt_pk_bf16_f32 v24, v144, v145
  v_cvt_pk_bf16_f32 v25, v146, v147
  v_cvt_pk_bf16_f32 v26, v148, v149
  v_cvt_pk_bf16_f32 v27, v150, v151
  ds_write_b128 v242, v[24:27] offset:0
  v_cvt_pk_bf16_f32 v28, v152, v153
  v_cvt_pk_bf16_f32 v29, v154, v155
  v_cvt_pk_bf16_f32 v30, v156, v157
  v_cvt_pk_bf16_f32 v31, v158, v159
  ds_write_b128 v243, v[28:31] offset:0
  s_mov_b32 m0, s52
  s_lshl_b32 s56, s82, 13
  s_add_u32 s56, s56, 4194304
  buffer_load_dwordx4 v246, s[32:35], s56 offen sc1 lds
  s_waitcnt lgkmcnt(0)
  s_barrier
  ds_read_b128 v[72:75], v244 offset:0
  ds_read_b128 v[76:79], v244 offset:4096
  ds_read_b128 v[80:83], v245 offset:0
  ds_read_b128 v[84:87], v245 offset:4096
  s_waitcnt lgkmcnt(3)
  v_mfma_f32_4x4x4_16b_bf16 v[64:67], v[248:249], v[72:73], v[64:67]
  v_mfma_f32_4x4x4_16b_bf16 v[68:71], v[248:249], v[74:75], v[68:71]
  s_waitcnt lgkmcnt(2)
  v_mfma_f32_4x4x4_16b_bf16 v[64:67], v[248:249], v[76:77], v[64:67]
  v_mfma_f32_4x4x4_16b_bf16 v[68:71], v[248:249], v[78:79], v[68:71]
  s_waitcnt lgkmcnt(1)
  v_mfma_f32_4x4x4_16b_bf16 v[64:67], v[248:249], v[80:81], v[64:67]
  v_mfma_f32_4x4x4_16b_bf16 v[68:71], v[248:249], v[82:83], v[68:71]
  s_waitcnt lgkmcnt(0)
  v_mfma_f32_4x4x4_16b_bf16 v[64:67], v[248:249], v[84:85], v[64:67]
  v_mfma_f32_4x4x4_16b_bf16 v[68:71], v[248:249], v[86:87], v[68:71]
  s_waitcnt vmcnt(0)
  ds_read_b128 v[88:91], v247
  s_waitcnt lgkmcnt(0)
  v_max3_u32 v11, v88, v89, v90
  v_max_u32 v11, v11, v91
  v_cmp_eq_u32 vcc, -1, v11
  s_nop 1
  s_cbranch_vccnz L_xslow_39
L_xok_38:
  v_mfma_f32_4x4x4_16b_bf16 v[64:67], v[248:249], v[88:89], v[64:67]
  v_mfma_f32_4x4x4_16b_bf16 v[68:71], v[248:249], v[90:91], v[68:71]
  s_nop 4
  v_cvt_pk_bf16_f32 v64, v64, v65
  v_cvt_pk_bf16_f32 v65, v66, v67
  v_cvt_pk_bf16_f32 v66, v68, v69
  v_cvt_pk_bf16_f32 v67, v70, v71
  buffer_store_dwordx4 v[64:67], v221, s[28:31], s101 offen sc1
  s_or_b32 s54, s2, s36
  s_cmp_lg_u32 s54, 0
  s_cbranch_scc1 L_nobump_41
  s_add_u32 s43, s44, 1
  v_mov_b32 v10, s43
  s_mov_b64 exec, 0xff
  buffer_store_dwordx4 v[10:13], v1, s[32:35], 0 offen sc1
  s_mov_b64 exec, -1
L_nobump_41:
  s_endpgm
.p2align 3
L_snd_4:
  v_add_u32 v2, 65536, v2
  ds_read_b64_tr_b16 v[192:193], v2 offset:16384
  ds_read_b64_tr_b16 v[194:195], v2 offset:17408
  v_add_u32 v220, 65536, v220
  ds_read_b64_tr_b16 v[196:197], v220 offset:16384
  ds_read_b64_tr_b16 v[198:199], v220 offset:17408
  ds_read_b64_tr_b16 v[200:201], v2 offset:18432
  ds_read_b64_tr_b16 v[202:203], v2 offset:19456
  ds_read_b64_tr_b16 v[204:205], v220 offset:18432
  ds_read_b64_tr_b16 v[206:207], v220 offset:19456
  v_add_u32 v2, 4294901760, v2
  ds_read_b64_tr_b16 v[208:209], v2 offset:0
  ds_read_b64_tr_b16 v[210:211], v2 offset:1024
  s_waitcnt lgkmcnt(6)
  v_mfma_f32_32x32x16_bf16 v[128:143], v[192:195], v[240:243], 0
  v_add_u32 v220, 4294901760, v220
  ds_read_b64_tr_b16 v[212:213], v220 offset:0
  ds_read_b64_tr_b16 v[214:215], v220 offset:1024
  v_mfma_f32_32x32x16_bf16 v[144:159], v[196:199], v[240:243], 0
  ds_read_b64_tr_b16 v[192:193], v2 offset:2048
  ds_read_b64_tr_b16 v[194:195], v2 offset:3072
  s_waitcnt lgkmcnt(6)
  v_mfma_f32_32x32x16_bf16 v[128:143], v[200:203], v[244:247], v[128:143]
  ds_read_b64_tr_b16 v[196:197], v220 offset:2048
  ds_read_b64_tr_b16 v[198:199], v220 offset:3072
  v_mfma_f32_32x32x16_bf16 v[144:159], v[204:207], v[244:247], v[144:159]
  v_add_u32 v2, 65536, v2
  ds_read_b64_tr_b16 v[200:201], v2 offset:24576
  ds_read_b64_tr_b16 v[202:203], v2 offset:25600
  s_waitcnt lgkmcnt(6)
  v_mfma_f32_32x32x16_bf16 v[128:143], v[208:211], v[248:251], v[128:143]
  v_add_u32 v220, 65536, v220
  ds_read_b64_tr_b16 v[204:205], v220 offset:24576
  ds_read_b64_tr_b16 v[206:207], v220 offset:25600
  v_mfma_f32_32x32x16_bf16 v[144:159], v[212:215], v[248:251], v[144:159]
  v_add_u32 v2, 32768, v2
  ds_read_b64_tr_b16 v[208:209], v2 offset:40960
  ds_read_b64_tr_b16 v[210:211], v2 offset:41984
  s_waitcnt lgkmcnt(6)
  v_mfma_f32_32x32x16_bf16 v[128:143], v[192:195], v[252:255], v[128:143]
  v_min_u32 v222, 1, v15
  v_lshlrev_b32 v222, 7, v222
  s_lshl_b32 s56, s82, 8
  s_add_u32 s56, s56, 262144
  buffer_load_dword v223, v222, s[32:35], s56 offen sc1
  v_add_u32 v220, 32768, v220
  ds_read_b64_tr_b16 v[212:213], v220 offset:40960
  ds_read_b64_tr_b16 v[214:215], v220 offset:41984
  v_mfma_f32_32x32x16_bf16 v[144:159], v[196:199], v[252:255], v[144:159]
  s_waitcnt vmcnt(5)
  s_add_u32 s47, s100, 3072
  v_mov_b32 v12, s43
  s_mov_b64 exec, 0xff
  buffer_store_dwordx4 v[12:15], v1, s[32:35], s47 offen sc1
  s_mov_b64 exec, -1
  ds_read_b64_tr_b16 v[192:193], v2 offset:49152
  ds_read_b64_tr_b16 v[194:195], v2 offset:50176
  s_waitcnt lgkmcnt(6)
  s_waitcnt vmcnt(5)
  v_mfma_f32_32x32x16_bf16 v[128:143], v[200:203], v[16:19], v[128:143]
  buffer_load_dwordx4 v[32:35], v1, s[32:35], s90 offen offset:0 sc1
  ds_read_b64_tr_b16 v[196:197], v220 offset:49152
  ds_read_b64_tr_b16 v[198:199], v220 offset:50176
  v_mfma_f32_32x32x16_bf16 v[144:159], v[204:207], v[16:19], v[144:159]
  ds_read_b64_tr_b16 v[200:201], v2 offset:0
  ds_read_b64_tr_b16 v[202:203], v2 offset:1024
  s_waitcnt lgkmcnt(6)
  s_waitcnt vmcnt(5)
  v_mfma_f32_32x32x16_bf16 v[128:143], v[208:211], v[20:23], v[128:143]
  buffer_load_dwordx4 v[36:39], v1, s[32:35], s91 offen offset:0 sc1
  v_and_b32 v11, 7, v15
  v_lshrrev_b32 v12, 4, v15
  ds_read_b64_tr_b16 v[204:205], v220 offset:0
  ds_read_b64_tr_b16 v[206:207], v220 offset:1024
  v_mfma_f32_32x32x16_bf16 v[144:159], v[212:215], v[20:23], v[144:159]
  v_and_b32 v12, 2, v12
  ds_read_b64_tr_b16 v[208:209], v2 offset:8192
  ds_read_b64_tr_b16 v[210:211], v2 offset:9216
  s_waitcnt lgkmcnt(6)
  s_waitcnt vmcnt(5)
  v_mfma_f32_32x32x16_bf16 v[128:143], v[192:195], v[24:27], v[128:143]
  buffer_load_dwordx4 v[40:43], v1, s[32:35], s86 offen offset:1024 sc1
  v_xor_b32 v12, v12, v11
  ds_read_b64_tr_b16 v[212:213], v220 offset:8192
  ds_read_b64_tr_b16 v[214:215], v220 offset:9216
  v_mfma_f32_32x32x16_bf16 v[144:159], v[196:199], v[24:27], v[144:159]
  v_and_b32 v13, 31, v15
  v_lshlrev_b32 v13, 7, v13
  ds_read_b64_tr_b16 v[192:193], v2 offset:16384
  ds_read_b64_tr_b16 v[194:195], v2 offset:17408
  s_waitcnt lgkmcnt(6)
  s_waitcnt vmcnt(5)
  v_mfma_f32_32x32x16_bf16 v[128:143], v[200:203], v[28:31], v[128:143]
  buffer_load_dwordx4 v[44:47], v1, s[32:35], s87 offen offset:1024 sc1
  v_lshl_add_u32 v12, v12, 4, v13
  ds_read_b64_tr_b16 v[196:197], v220 offset:16384
  ds_read_b64_tr_b16 v[198:199], v220 offset:17408
  v_mfma_f32_32x32x16_bf16 v[144:159], v[204:207], v[28:31], v[144:159]
  s_bitcmp1_b32 s37, 0
  s_cselect_b32 s54, 17, 0
  s_cselect_b32 s49, 18, 11
  s_cselect_b32 s52, 13, 12
  v_add_u32 v2, 4294934528, v2
  ds_read_b64_tr_b16 v[200:201], v2 offset:26624
  ds_read_b64_tr_b16 v[202:203], v2 offset:27648
  s_waitcnt lgkmcnt(6)
  s_waitcnt vmcnt(3)
  v_mfma_f32_32x32x16_bf16 v[128:143], v[208:211], v[32:35], v[128:143]
  buffer_load_dwordx4 v[48:51], v1, s[32:35], s88 offen offset:1024 sc1
  v_cmp_ne_u32 vcc, s43, v223
  s_nop 1
  s_cbranch_vccnz L_slow_43
L_ok_42:
  v_lshl_add_u32 v240, s54, 13, v12
  v_add_u32 v220, 4294934528, v220
  ds_read_b64_tr_b16 v[204:205], v220 offset:26624
  ds_read_b64_tr_b16 v[206:207], v220 offset:27648
  v_mfma_f32_32x32x16_bf16 v[144:159], v[212:215], v[32:35], v[144:159]
  v_xor_b32 v241, 16, v240
  v_xor_b32 v242, 64, v240
  v_add_u32 v2, 32768, v2
  ds_read_b64_tr_b16 v[208:209], v2 offset:43008
  ds_read_b64_tr_b16 v[210:211], v2 offset:44032
  s_waitcnt lgkmcnt(6)
  s_waitcnt vmcnt(3)
  v_mfma_f32_32x32x16_bf16 v[128:143], v[192:195], v[36:39], v[128:143]
  s_add_u32 s80, s99, 2048
  buffer_load_dword v10, v9, s[32:35], s80 offen sc1
  buffer_load_dwordx4 v[52:55], v1, s[32:35], s89 offen offset:1024 sc1
  v_xor_b32 v243, 80, v240
  v_add_u32 v220, 32768, v220
  ds_read_b64_tr_b16 v[212:213], v220 offset:43008
  ds_read_b64_tr_b16 v[214:215], v220 offset:44032
  v_mfma_f32_32x32x16_bf16 v[144:159], v[196:199], v[36:39], v[144:159]
  v_lshrrev_b32 v12, 3, v15
  ds_read_b64_tr_b16 v[192:193], v2 offset:51200
  ds_read_b64_tr_b16 v[194:195], v2 offset:52224
  s_waitcnt lgkmcnt(6)
  s_waitcnt vmcnt(4)
  v_mfma_f32_32x32x16_bf16 v[128:143], v[200:203], v[40:43], v[128:143]
  buffer_load_dwordx4 v[56:59], v1, s[32:35], s90 offen offset:1024 sc1
  v_lshlrev_b32 v13, 4, v12
  ds_read_b64_tr_b16 v[196:197], v220 offset:51200
  ds_read_b64_tr_b16 v[198:199], v220 offset:52224
  s_waitcnt vmcnt(4) lgkmcnt(6)
  v_mfma_f32_32x32x16_bf16 v[144:159], v[204:207], v[40:43], v[144:159]
  s_barrier
  v_mfma_f32_32x32x16_bf16 v[128:143], v[208:211], v[44:47], v[128:143]
  ds_read_b64_tr_b16 v[200:201], v2 offset:2048
  ds_read_b64_tr_b16 v[202:203], v2 offset:3072
  v_xor_b32 v13, v13, v1
  v_lshl_add_u32 v244, s54, 13, v13
  buffer_load_dwordx4 v[60:63], v1, s[32:35], s91 offen offset:1024 sc1
  v_lshl_add_u32 v245, s49, 13, v13
  ds_read_b64_tr_b16 v[204:205], v220 offset:2048
  ds_read_b64_tr_b16 v[206:207], v220 offset:3072
  s_waitcnt lgkmcnt(6)
  v_mfma_f32_32x32x16_bf16 v[144:159], v[212:215], v[44:47], v[144:159]
  s_add_u32 m0, s38, 81920
  s_mov_b32 s46, 0
  buffer_load_dwordx4 v238, s[16:19], s46 offen lds
  v_and_b32 v13, 2, v15
  ds_read_b64_tr_b16 v[208:209], v2 offset:10240
  ds_read_b64_tr_b16 v[210:211], v2 offset:11264
  s_waitcnt vmcnt(5)
  v_mfma_f32_32x32x16_bf16 v[128:143], v[192:195], v[48:51], v[128:143]
  s_waitcnt vmcnt(4)
  v_cmp_ne_u32 vcc, s43, v10
  s_nop 1
  s_cbranch_vccnz L_slow_46
L_ok_45:
  v_add_u32 v3, 4096, v1
  buffer_load_dwordx4 v[64:67], v3, s[32:35], s86 offen offset:0 sc1
  v_lshlrev_b32 v13, 1, v13
  ds_read_b64_tr_b16 v[212:213], v220 offset:10240
  ds_read_b64_tr_b16 v[214:215], v220 offset:11264
  s_waitcnt lgkmcnt(6)
  v_mfma_f32_32x32x16_bf16 v[144:159], v[196:199], v[48:51], v[144:159]
  v_xor_b32 v13, v13, v12
  v_lshlrev_b32 v13, 4, v13
  ds_read_b64_tr_b16 v[192:193], v2 offset:18432
  ds_read_b64_tr_b16 v[194:195], v2 offset:19456
  s_waitcnt vmcnt(4)
  v_mfma_f32_32x32x16_bf16 v[128:143], v[200:203], v[52:55], v[128:143]
  buffer_load_dwordx4 v[68:71], v3, s[32:35], s87 offen offset:0 sc1
  v_lshl_add_u32 v13, v11, 7, v13
  ds_read_b64_tr_b16 v[196:197], v220 offset:18432
  ds_read_b64_tr_b16 v[198:199], v220 offset:19456
  s_waitcnt lgkmcnt(6)
  v_mfma_f32_32x32x16_bf16 v[144:159], v[204:207], v[52:55], v[144:159]
  s_lshl_b32 s52, s52, 13
  ds_read_b64_tr_b16 v[200:201], v2 offset:57344
  ds_read_b64_tr_b16 v[202:203], v2 offset:58368
  s_waitcnt vmcnt(4)
  v_mfma_f32_32x32x16_bf16 v[128:143], v[208:211], v[56:59], v[128:143]
  buffer_load_dwordx4 v[72:75], v3, s[32:35], s88 offen offset:0 sc1
  s_lshl1_add_u32 s57, s40, 1
  s_lshl3_add_u32 s57, s57, s58
  s_lshl_b32 s57, s57, 12
  s_add_u32 s57, s57, 2097152
  v_mov_b32 v222, 896
  buffer_load_dword v223, v222, s[32:35], s57 offen sc1
  s_add_u32 s51, s51, 14336
  s_add_u32 s3, s51, 4096
  s_add_u32 s52, s52, 2048
  v_add_u32 v247, s52, v13
  ds_read_b64_tr_b16 v[204:205], v220 offset:57344
  ds_read_b64_tr_b16 v[206:207], v220 offset:58368
  s_waitcnt lgkmcnt(6)
  v_mfma_f32_32x32x16_bf16 v[144:159], v[212:215], v[56:59], v[144:159]
  v_bfe_u32 v13, v15, 4, 1
  v_add_u32 v2, 4294868992, v2
  ds_read_b64_tr_b16 v[208:209], v2 offset:8192
  ds_read_b64_tr_b16 v[210:211], v2 offset:9216
  s_waitcnt vmcnt(5)
  v_mfma_f32_32x32x16_bf16 v[128:143], v[192:195], v[60:63], v[128:143]
  s_add_u32 s80, s99, 3072
  buffer_load_dword v10, v9, s[32:35], s80 offen sc1
  buffer_load_dwordx4 v[76:79], v3, s[32:35], s89 offen offset:0 sc1
  v_lshlrev_b32 v246, 2, v13
  v_add_u32 v220, 4294868992, v220
  ds_read_b64_tr_b16 v[212:213], v220 offset:8192
  ds_read_b64_tr_b16 v[214:215], v220 offset:9216
  s_waitcnt lgkmcnt(6)
  v_mfma_f32_32x32x16_bf16 v[144:159], v[196:199], v[60:63], v[144:159]
  v_xor_b32 v246, v246, v11
  ds_read_b64_tr_b16 v[192:193], v2 offset:16384
  ds_read_b64_tr_b16 v[194:195], v2 offset:17408
  s_waitcnt vmcnt(5)
  v_mfma_f32_32x32x16_bf16 v[128:143], v[200:203], v[64:67], v[128:143]
  buffer_load_dwordx4 v[80:83], v3, s[32:35], s90 offen offset:0 sc1
  v_lshlrev_b32 v246, 4, v246
  v_lshl_add_u32 v246, v13, 9, v246
  ds_read_b64_tr_b16 v[196:197], v220 offset:16384
  ds_read_b64_tr_b16 v[198:199], v220 offset:17408
  s_waitcnt lgkmcnt(6)
  v_mfma_f32_32x32x16_bf16 v[144:159], v[204:207], v[64:67], v[144:159]
  v_and_b32 v13, 1, v12
  ds_read_b64_tr_b16 v[200:201], v2 offset:24576
  ds_read_b64_tr_b16 v[202:203], v2 offset:25600
  s_waitcnt vmcnt(5)
  v_mfma_f32_32x32x16_bf16 v[128:143], v[208:211], v[68:71], v[128:143]
  buffer_load_dwordx4 v[84:87], v3, s[32:35], s91 offen offset:0 sc1
  v_lshl_add_u32 v246, v13, 10, v246
  ds_read_b64_tr_b16 v[204:205], v220 offset:24576
  ds_read_b64_tr_b16 v[206:207], v220 offset:25600
  s_waitcnt lgkmcnt(6)
  v_mfma_f32_32x32x16_bf16 v[144:159], v[212:215], v[68:71], v[144:159]
  v_lshrrev_b32 v13, 5, v15
  ds_read_b64_tr_b16 v[208:209], v2 offset:32768
  ds_read_b64_tr_b16 v[210:211], v2 offset:33792
  s_waitcnt vmcnt(5)
  v_mfma_f32_32x32x16_bf16 v[128:143], v[192:195], v[72:75], v[128:143]
  s_waitcnt vmcnt(3)
  v_cmp_ne_u32 vcc, s43, v10
  s_nop 1
  s_cbranch_vccnz L_slow_49
L_ok_48:
  buffer_load_dwordx4 v[88:91], v3, s[32:35], s86 offen offset:1024 sc1
  v_lshl_add_u32 v246, v13, 11, v246
  v_mov_b32 v248, 0x3f80
  ds_read_b64_tr_b16 v[212:213], v220 offset:32768
  ds_read_b64_tr_b16 v[214:215], v220 offset:33792
  s_waitcnt lgkmcnt(6)
  v_mfma_f32_32x32x16_bf16 v[144:159], v[196:199], v[72:75], v[144:159]
  v_mov_b32 v249, 0
  ds_read_b64_tr_b16 v[192:193], v2 offset:40960
  ds_read_b64_tr_b16 v[194:195], v2 offset:41984
  s_waitcnt vmcnt(3)
  v_mfma_f32_32x32x16_bf16 v[128:143], v[200:203], v[76:79], v[128:143]
  buffer_load_dwordx4 v[92:95], v3, s[32:35], s87 offen offset:1024 sc1
  v_cmp_ne_u32 vcc, s43, v223
  s_nop 1
  s_cbranch_vccnz L_slow_52
L_ok_51:
  v_and_b32 v13, 0x30, v1
  ds_read_b64_tr_b16 v[196:197], v220 offset:40960
  ds_read_b64_tr_b16 v[198:199], v220 offset:41984
  s_waitcnt lgkmcnt(6)
  v_mfma_f32_32x32x16_bf16 v[144:159], v[204:207], v[76:79], v[144:159]
  v_lshlrev_b64 v[248:249], v13, v[248:249]
  v_add_u32 v2, 98304, v2
  ds_read_b64_tr_b16 v[200:201], v2 offset:59392
  ds_read_b64_tr_b16 v[202:203], v2 offset:60416
  s_waitcnt vmcnt(3)
  v_mfma_f32_32x32x16_bf16 v[128:143], v[208:211], v[80:83], v[128:143]
  buffer_load_dwordx4 v[96:99], v3, s[32:35], s88 offen offset:1024 sc1
  v_add_u32 v220, 98304, v220
  ds_read_b64_tr_b16 v[204:205], v220 offset:59392
  ds_read_b64_tr_b16 v[206:207], v220 offset:60416
  s_waitcnt vmcnt(3) lgkmcnt(6)
  v_mfma_f32_32x32x16_bf16 v[144:159], v[212:215], v[80:83], v[144:159]
  s_barrier
  v_mfma_f32_32x32x16_bf16 v[128:143], v[192:195], v[84:87], v[128:143]
  v_add_u32 v2, 4294868992, v2
  ds_read_b64_tr_b16 v[208:209], v2 offset:10240
  ds_read_b64_tr_b16 v[210:211], v2 offset:11264
  buffer_load_dwordx4 v[100:103], v3, s[32:35], s89 offen offset:1024 sc1
  v_add_u32 v220, 4294868992, v220
  ds_read_b64_tr_b16 v[212:213], v220 offset:10240
  ds_read_b64_tr_b16 v[214:215], v220 offset:11264
  s_waitcnt lgkmcnt(6)
  v_mfma_f32_32x32x16_bf16 v[144:159], v[196:199], v[84:87], v[144:159]
  ds_read_b64_tr_b16 v[192:193], v2 offset:18432
  ds_read_b64_tr_b16 v[194:195], v2 offset:19456
  s_waitcnt vmcnt(3)
  v_mfma_f32_32x32x16_bf16 v[128:143], v[200:203], v[88:91], v[128:143]
  buffer_load_dwordx4 v[104:107], v3, s[32:35], s90 offen offset:1024 sc1
  ds_read_b64_tr_b16 v[196:197], v220 offset:18432
  ds_read_b64_tr_b16 v[198:199], v220 offset:19456
  s_waitcnt lgkmcnt(6)
  v_mfma_f32_32x32x16_bf16 v[144:159], v[204:207], v[88:91], v[144:159]
  ds_read_b64_tr_b16 v[200:201], v2 offset:26624
  ds_read_b64_tr_b16 v[202:203], v2 offset:27648
  s_waitcnt vmcnt(3)
  v_mfma_f32_32x32x16_bf16 v[128:143], v[208:211], v[92:95], v[128:143]
  buffer_load_dwordx4 v[108:111], v3, s[32:35], s91 offen offset:1024 sc1
  ds_read_b64_tr_b16 v[204:205], v220 offset:26624
  ds_read_b64_tr_b16 v[206:207], v220 offset:27648
  s_waitcnt lgkmcnt(6)
  v_mfma_f32_32x32x16_bf16 v[144:159], v[212:215], v[92:95], v[144:159]
  ds_read_b64_tr_b16 v[208:209], v2 offset:34816
  ds_read_b64_tr_b16 v[210:211], v2 offset:35840
  s_waitcnt vmcnt(3)
  v_mfma_f32_32x32x16_bf16 v[128:143], v[192:195], v[96:99], v[128:143]
  buffer_load_dwordx4 v[16:19], v1, s[32:35], s51 offen offset:0 sc1
  ds_read_b64_tr_b16 v[212:213], v220 offset:34816
  ds_read_b64_tr_b16 v[214:215], v220 offset:35840
  s_waitcnt lgkmcnt(6)
  v_mfma_f32_32x32x16_bf16 v[144:159], v[196:199], v[96:99], v[144:159]
  ds_read_b64_tr_b16 v[192:193], v2 offset:43008
  ds_read_b64_tr_b16 v[194:195], v2 offset:44032
  s_waitcnt vmcnt(3)
  v_mfma_f32_32x32x16_bf16 v[128:143], v[200:203], v[100:103], v[128:143]
  buffer_load_dwordx4 v[20:23], v1, s[32:35], s51 offen offset:1024 sc1
  ds_read_b64_tr_b16 v[196:197], v220 offset:43008
  ds_read_b64_tr_b16 v[198:199], v220 offset:44032
  s_waitcnt lgkmcnt(6)
  v_mfma_f32_32x32x16_bf16 v[144:159], v[204:207], v[100:103], v[144:159]
  ds_read_b64_tr_b16 v[200:201], v2 offset:53248
  ds_read_b64_tr_b16 v[202:203], v2 offset:54272
  s_waitcnt vmcnt(3)
  v_mfma_f32_32x32x16_bf16 v[128:143], v[208:211], v[104:107], v[128:143]
  buffer_load_dwordx4 v[24:27], v1, s[32:35], s51 offen offset:2048 sc1
  ds_read_b64_tr_b16 v[204:205], v220 offset:53248
  ds_read_b64_tr_b16 v[206:207], v220 offset:54272
  s_waitcnt lgkmcnt(6)
  v_mfma_f32_32x32x16_bf16 v[144:159], v[212:215], v[104:107], v[144:159]
  ds_read_b64_tr_b16 v[208:209], v2 offset:61440
  ds_read_b64_tr_b16 v[210:211], v2 offset:62464
  s_waitcnt vmcnt(3)
  v_mfma_f32_32x32x16_bf16 v[128:143], v[192:195], v[108:111], v[128:143]
  buffer_load_dwordx4 v[28:31], v1, s[32:35], s51 offen offset:3072 sc1
  ds_read_b64_tr_b16 v[212:213], v220 offset:61440
  ds_read_b64_tr_b16 v[214:215], v220 offset:62464
  s_waitcnt lgkmcnt(6)
  v_mfma_f32_32x32x16_bf16 v[144:159], v[196:199], v[108:111], v[144:159]
  s_and_b32 s55, s37, 1
  s_add_u32 s55, s55, 28
  v_lshl_add_u32 v13, s55, 12, v1
  s_lshl_b32 s55, s81, 13
  s_add_u32 s55, s55, 4194304
  s_nop 6
  v_cvt_pk_bf16_f32 v48, v144, v145
  v_cvt_pk_bf16_f32 v49, v146, v147
  v_cvt_pk_bf16_f32 v50, v148, v149
  v_cvt_pk_bf16_f32 v51, v150, v151
  ds_write_b128 v13, v[48:51] offset:0
  v_cvt_pk_bf16_f32 v52, v152, v153
  v_cvt_pk_bf16_f32 v53, v154, v155
  v_cvt_pk_bf16_f32 v54, v156, v157
  v_cvt_pk_bf16_f32 v55, v158, v159
  ds_write_b128 v13, v[52:55] offset:1024
  s_waitcnt lgkmcnt(0)
  s_barrier
  ds_read_b128 v[56:59], v13 offset:2048
  ds_read_b128 v[60:63], v13 offset:3072
  s_waitcnt lgkmcnt(1)
  v_mfma_f32_4x4x4_16b_bf16 v[128:131], v[248:249], v[56:57], v[128:131]
  v_mfma_f32_4x4x4_16b_bf16 v[132:135], v[248:249], v[58:59], v[132:135]
  s_waitcnt lgkmcnt(0)
  v_mfma_f32_4x4x4_16b_bf16 v[136:139], v[248:249], v[60:61], v[136:139]
  v_mfma_f32_4x4x4_16b_bf16 v[140:143], v[248:249], v[62:63], v[140:143]
  s_nop 1
  v_cvt_pk_bf16_f32 v48, v128, v129
  v_cvt_pk_bf16_f32 v49, v130, v131
  v_cvt_pk_bf16_f32 v50, v132, v133
  v_cvt_pk_bf16_f32 v51, v134, v135
  buffer_store_dwordx4 v[48:51], v1, s[32:35], s55 offen offset:0 sc1
  v_cvt_pk_bf16_f32 v52, v136, v137
  v_cvt_pk_bf16_f32 v53, v138, v139
  v_cvt_pk_bf16_f32 v54, v140, v141
  v_cvt_pk_bf16_f32 v55, v142, v143
  buffer_store_dwordx4 v[52:55], v1, s[32:35], s55 offen offset:1024 sc1
  s_waitcnt vmcnt(5)
  v_max3_u32 v14, v16, v17, v18
  v_max_u32 v14, v14, v19
  v_cmp_eq_u32 vcc, -1, v14
  s_cbranch_vccnz L_vslow_55
L_vok_54:
  v_add_u32 v2, 98304, v2
  ds_read_b64_tr_b16 v[192:193], v2 offset:28672
  ds_read_b64_tr_b16 v[194:195], v2 offset:29696
  v_mfma_f32_32x32x16_bf16 v[160:175], v[200:203], v[16:19], 0
  buffer_load_dwordx4 v[32:35], v1, s[32:35], s3 offen offset:0 sc1
  v_add_u32 v220, 98304, v220
  ds_read_b64_tr_b16 v[196:197], v220 offset:28672
  ds_read_b64_tr_b16 v[198:199], v220 offset:29696
  v_mfma_f32_32x32x16_bf16 v[176:191], v[204:207], v[16:19], 0
  s_waitcnt vmcnt(5)
  v_max3_u32 v14, v20, v21, v22
  v_max_u32 v14, v14, v23
  v_cmp_eq_u32 vcc, -1, v14
  s_cbranch_vccnz L_vslow_58
L_vok_57:
  ds_read_b64_tr_b16 v[200:201], v2 offset:36864
  ds_read_b64_tr_b16 v[202:203], v2 offset:37888
  v_mfma_f32_32x32x16_bf16 v[160:175], v[208:211], v[20:23], v[160:175]
  buffer_load_dwordx4 v[36:39], v1, s[32:35], s3 offen offset:1024 sc1
  ds_read_b64_tr_b16 v[204:205], v220 offset:36864
  ds_read_b64_tr_b16 v[206:207], v220 offset:37888
  v_mfma_f32_32x32x16_bf16 v[176:191], v[212:215], v[20:23], v[176:191]
  s_waitcnt vmcnt(5)
  v_max3_u32 v14, v24, v25, v26
  v_max_u32 v14, v14, v27
  v_cmp_eq_u32 vcc, -1, v14
  s_cbranch_vccnz L_vslow_61
L_vok_60:
  v_add_u32 v2, 4294934528, v2
  ds_read_b64_tr_b16 v[208:209], v2 offset:4096
  ds_read_b64_tr_b16 v[210:211], v2 offset:5120
  s_waitcnt lgkmcnt(6)
  v_mfma_f32_32x32x16_bf16 v[160:175], v[192:195], v[24:27], v[160:175]
  buffer_load_dwordx4 v[40:43], v1, s[32:35], s3 offen offset:2048 sc1
  v_add_u32 v220, 4294934528, v220
  ds_read_b64_tr_b16 v[212:213], v220 offset:4096
  ds_read_b64_tr_b16 v[214:215], v220 offset:5120
  v_mfma_f32_32x32x16_bf16 v[176:191], v[196:199], v[24:27], v[176:191]
  s_waitcnt vmcnt(5)
  v_max3_u32 v14, v28, v29, v30
  v_max_u32 v14, v14, v31
  v_cmp_eq_u32 vcc, -1, v14
  s_cbranch_vccnz L_vslow_64
L_vok_63:
  ds_read_b64_tr_b16 v[192:193], v2 offset:12288
  ds_read_b64_tr_b16 v[194:195], v2 offset:13312
  s_waitcnt lgkmcnt(6)
  v_mfma_f32_32x32x16_bf16 v[160:175], v[200:203], v[28:31], v[160:175]
  ds_read_b64_tr_b16 v[196:197], v220 offset:12288
  ds_read_b64_tr_b16 v[198:199], v220 offset:13312
  v_mfma_f32_32x32x16_bf16 v[176:191], v[204:207], v[28:31], v[176:191]
  s_waitcnt vmcnt(2)
  v_max3_u32 v14, v32, v33, v34
  v_max_u32 v14, v14, v35
  v_cmp_eq_u32 vcc, -1, v14
  s_cbranch_vccnz L_vslow_67
L_vok_66:
  ds_read_b64_tr_b16 v[200:201], v2 offset:20480
  ds_read_b64_tr_b16 v[202:203], v2 offset:21504
  s_waitcnt lgkmcnt(6)
  v_mfma_f32_32x32x16_bf16 v[160:175], v[208:211], v[32:35], v[160:175]
  ds_read_b64_tr_b16 v[204:205], v220 offset:20480
  ds_read_b64_tr_b16 v[206:207], v220 offset:21504
  v_mfma_f32_32x32x16_bf16 v[176:191], v[212:215], v[32:35], v[176:191]
  s_waitcnt vmcnt(1)
  v_max3_u32 v14, v36, v37, v38
  v_max_u32 v14, v14, v39
  v_cmp_eq_u32 vcc, -1, v14
  s_cbranch_vccnz L_vslow_70
L_vok_69:
  s_waitcnt lgkmcnt(4)
  v_mfma_f32_32x32x16_bf16 v[160:175], v[192:195], v[36:39], v[160:175]
  v_mfma_f32_32x32x16_bf16 v[176:191], v[196:199], v[36:39], v[176:191]
  s_waitcnt vmcnt(0)
  v_max3_u32 v14, v40, v41, v42
  v_max_u32 v14, v14, v43
  v_cmp_eq_u32 vcc, -1, v14
  s_cbranch_vccnz L_vslow_73
L_vok_72:
  s_waitcnt lgkmcnt(0)
  v_mfma_f32_32x32x16_bf16 v[160:175], v[200:203], v[40:43], v[160:175]
  v_mfma_f32_32x32x16_bf16 v[176:191], v[204:207], v[40:43], v[176:191]
  v_mfma_f32_4x4x4_16b_bf16 v[64:67], v[248:249], v[224:225], 0
  v_mfma_f32_4x4x4_16b_bf16 v[68:71], v[248:249], v[226:227], 0
  s_nop 8
  v_cvt_pk_bf16_f32 v16, v160, v161
  v_cvt_pk_bf16_f32 v17, v162, v163
  v_cvt_pk_bf16_f32 v18, v164, v165
  v_cvt_pk_bf16_f32 v19, v166, v167
  ds_write_b128 v240, v[16:19] offset:4096
  v_cvt_pk_bf16_f32 v20, v168, v169
  v_cvt_pk_bf16_f32 v21, v170, v171
  v_cvt_pk_bf16_f32 v22, v172, v173
  v_cvt_pk_bf16_f32 v23, v174, v175
  ds_write_b128 v241, v[20:23] offset:4096
  v_cvt_pk_bf16_f32 v24, v176, v177
  v_cvt_pk_bf16_f32 v25, v178, v179
  v_cvt_pk_bf16_f32 v26, v180, v181
  v_cvt_pk_bf16_f32 v27, v182, v183
  ds_write_b128 v242, v[24:27] offset:4096
  v_cvt_pk_bf16_f32 v28, v184, v185
  v_cvt_pk_bf16_f32 v29, v186, v187
  v_cvt_pk_bf16_f32 v30, v188, v189
  v_cvt_pk_bf16_f32 v31, v190, v191
  ds_write_b128 v243, v[28:31] offset:4096
  s_mov_b32 m0, s52
  s_lshl_b32 s56, s82, 13
  s_add_u32 s56, s56, 4194432
  buffer_load_dwordx4 v246, s[32:35], s56 offen sc1 lds
  s_waitcnt lgkmcnt(0)
  s_barrier
  ds_read_b128 v[72:75], v244 offset:1024
  ds_read_b128 v[76:79], v244 offset:5120
  ds_read_b128 v[80:83], v245 offset:1024
  ds_read_b128 v[84:87], v245 offset:5120
  s_waitcnt lgkmcnt(3)
  v_mfma_f32_4x4x4_16b_bf16 v[64:67], v[248:249], v[72:73], v[64:67]
  v_mfma_f32_4x4x4_16b_bf16 v[68:71], v[248:249], v[74:75], v[68:71]
  s_waitcnt lgkmcnt(2)
  v_mfma_f32_4x4x4_16b_bf16 v[64:67], v[248:249], v[76:77], v[64:67]
  v_mfma_f32_4x4x4_16b_bf16 v[68:71], v[248:249], v[78:79], v[68:71]
  s_waitcnt lgkmcnt(1)
  v_mfma_f32_4x4x4_16b_bf16 v[64:67], v[248:249], v[80:81], v[64:67]
  v_mfma_f32_4x4x4_16b_bf16 v[68:71], v[248:249], v[82:83], v[68:71]
  s_waitcnt lgkmcnt(0)
  v_mfma_f32_4x4x4_16b_bf16 v[64:67], v[248:249], v[84:85], v[64:67]
  v_mfma_f32_4x4x4_16b_bf16 v[68:71], v[248:249], v[86:87], v[68:71]
  s_waitcnt vmcnt(0)
  ds_read_b128 v[88:91], v247
  s_waitcnt lgkmcnt(0)
  v_max3_u32 v11, v88, v89, v90
  v_max_u32 v11, v11, v91
  v_cmp_eq_u32 vcc, -1, v11
  s_nop 1
  s_cbranch_vccnz L_xslow_76
L_xok_75:
  v_mfma_f32_4x4x4_16b_bf16 v[64:67], v[248:249], v[88:89], v[64:67]
  v_mfma_f32_4x4x4_16b_bf16 v[68:71], v[248:249], v[90:91], v[68:71]
  s_nop 4
  v_cvt_pk_bf16_f32 v64, v64, v65
  v_cvt_pk_bf16_f32 v65, v66, v67
  v_cvt_pk_bf16_f32 v66, v68, v69
  v_cvt_pk_bf16_f32 v67, v70, v71
  buffer_store_dwordx4 v[64:67], v221, s[28:31], s101 offen sc1
  s_endpgm
.p2align 3
L_F1:
  s_and_b32 s37, s36, 3
  v_and_b32 v15, 63, v0
  s_lshl_b32 s38, s37, 10
  s_and_b32 s39, s2, 1
  s_lshl3_add_u32 s42, s39, s41
  s_mul_i32 s54, s42, 56
  s_and_b32 s57, s54, 15
  s_sub_u32 s54, s54, s57
  s_add_u32 s54, s54, 896
  s_add_u32 s62, s61, 1
  v_mov_b32 v208, 0x3f803f80
  v_mov_b32 v209, 0x3f803f80
  s_add_u32 s64, s63, 1
  v_mov_b32 v210, 0x3b124925
  v_bfe_u32 v240, v15, 4, 1
  s_add_u32 s66, s65, 1
  v_and_b32 v241, 3, v15
  v_bfe_u32 v242, v15, 2, 2
  s_mul_i32 s60, s60, 172032
  v_lshrrev_b32 v243, 5, v15
  v_mov_b32 v212, 0xffff
  s_mul_i32 s61, s61, 172032
  v_mov_b32 v213, 0
  v_lshlrev_b32 v11, 4, v241
  s_mul_i32 s62, s62, 172032
  v_lshlrev_b64 v[212:213], v11, v[212:213]
  v_lshlrev_b32 v1, 4, v15
  s_mul_i32 s63, s63, 172032
  v_xor_b32 v14, v248, v250
  v_lshlrev_b32 v224, 4, v14
  s_mul_i32 s64, s64, 172032
  v_lshrrev_b32 v14, 1, v250
  v_lshl_add_u32 v224, v14, 12, v224
  s_mul_i32 s65, s65, 172032
  v_and_b32 v14, 1, v250
  v_lshl_add_u32 v224, v14, 9, v224
  s_mul_i32 s66, s66, 172032
  v_lshl_add_u32 v224, s55, 10, v224
  v_add_u32 v225, 0x10000, v224
  s_mov_b64 s[84:85], s[14:15]
  v_xor_b32 v226, 2048, v224
  s_mov_b64 s[86:87], s[16:17]
  v_xor_b32 v227, 2048, v225
  v_xor_b32 v249, v242, v240
  s_mov_b64 s[24:25], s[18:19]
  v_and_b32 v249, 1, v249
  v_mul_u32_u24 v2, 2688, v248
  s_mov_b64 s[16:17], s[10:11]
  v_mul_u32_u24 v14, 896, v249
  v_add3_u32 v2, v2, v14, s54
  s_mov_b64 s[12:13], s[8:9]
  v_add_u32 v2, v11, v2
  v_xor_b32 v14, v243, v15
  s_mov_b64 s[8:9], s[82:83]
  v_lshl_add_u32 v244, v14, 4, s38
  v_xor_b32 v245, 32, v244
  s_mov_b32 s10, 1204224
  v_xor_b32 v246, 64, v244
  v_xor_b32 v247, 96, v244
  s_mov_b32 s11, 0x20000
  v_lshl_add_u32 v11, v240, 2, v241
  v_lshl_add_u32 v11, v11, 3, s57
  s_mov_b32 s34, 268435456
  v_and_b32 v11, 63, v11
  v_lshrrev_b32 v12, 1, v242
  s_mov_b32 s35, 0x20000
  v_xor_b32 v12, 1, v12
  v_lshl_add_u32 v11, v12, 6, v11
  s_mov_b32 s14, 25088
  v_lshl_add_u32 v11, v242, 7, v11
  v_lshl_add_u32 v220, v243, 10, v11
  s_mov_b32 s15, 0x20000
  v_add_u32 v220, 98304, v220
  s_mul_i32 s51, s42, 1568
  s_add_u32 s51, s51, s38
  s_cmp_ge_u32 s37, 2
  s_cselect_b32 s51, 0x1000000, s51
  s_bitcmp1_b32 s36, 0
  s_cselect_b32 s20, s86, s84
  s_cselect_b32 s21, s87, s85
  s_mov_b32 s22, 1605632
  s_mov_b32 s23, 0x20000
  v_lshrrev_b32 v11, 3, v15
  s_and_b32 s54, s37, 2
  v_lshl_add_u32 v11, s54, 2, v11
  v_mul_u32_u24 v3, 3584, v11
  v_bfe_u32 v11, v15, 1, 2
  s_and_b32 s54, s36, 1
  v_lshl_add_u32 v12, s54, 1, v240
  v_xor_b32 v11, v11, v12
  v_lshl_add_u32 v3, v11, 5, v3
  v_and_b32 v11, 16, v1
  s_mul_i32 s55, s39, 7
  s_add_u32 s92, s55, s41
  s_lshl_b32 s54, s92, 8
  v_add3_u32 v3, v3, v11, s54
  s_mov_b32 s18, 401408
  s_mov_b32 s19, 0x20000
  s_mov_b32 s26, 1605632
  s_mov_b32 s27, 0x20000
  s_waitcnt lgkmcnt(0)
  s_load_dword s44, s[32:33], 0
  v_lshrrev_b32 v11, 1, v242
  v_lshl_add_u32 v11, v240, 1, v11
  v_xor_b32 v11, 2, v11
  v_lshlrev_b32 v11, 5, v11
  v_lshl_add_u32 v11, v241, 3, v11
  v_lshl_add_u32 v11, v242, 7, v11
  v_lshl_add_u32 v11, v240, 10, v11
  v_lshl_add_u32 v6, v243, 11, v11
  buffer_load_dwordx4 v[132:135], v252, s[4:7], s89 offen offset:0
  buffer_load_dwordx4 v[136:139], v252, s[4:7], s89 offen offset:128
  buffer_load_dwordx4 v[140:143], v252, s[4:7], s90 offen offset:0
  buffer_load_dwordx4 v[144:147], v252, s[4:7], s90 offen offset:128
  buffer_load_dwordx4 v[148:151], v252, s[4:7], s91 offen offset:0
  buffer_load_dwordx4 v[152:155], v252, s[4:7], s91 offen offset:128
  s_setprio 1
  s_waitcnt vmcnt(6)
  v_mfma_f32_4x4x4_16b_bf16 v[192:195], v[208:209], v[128:129], 0
  v_mfma_f32_4x4x4_16b_bf16 v[196:199], v[128:129], v[128:129], 0
  v_mfma_f32_4x4x4_16b_bf16 v[200:203], v[208:209], v[130:131], 0
  v_mfma_f32_4x4x4_16b_bf16 v[204:207], v[130:131], v[130:131], 0
  s_waitcnt vmcnt(5)
  v_mfma_f32_4x4x4_16b_bf16 v[192:195], v[208:209], v[132:133], v[192:195]
  v_mfma_f32_4x4x4_16b_bf16 v[196:199], v[132:133], v[132:133], v[196:199]
  v_mfma_f32_4x4x4_16b_bf16 v[200:203], v[208:209], v[134:135], v[200:203]
  v_mfma_f32_4x4x4_16b_bf16 v[204:207], v[134:135], v[134:135], v[204:207]
  s_waitcnt vmcnt(4)
  v_mfma_f32_4x4x4_16b_bf16 v[192:195], v[208:209], v[136:137], v[192:195]
  buffer_load_dwordx4 v[156:159], v254, s[4:7], s88 offen offset:0
  v_mfma_f32_4x4x4_16b_bf16 v[196:199], v[136:137], v[136:137], v[196:199]
  v_mfma_f32_4x4x4_16b_bf16 v[200:203], v[208:209], v[138:139], v[200:203]
  v_mfma_f32_4x4x4_16b_bf16 v[204:207], v[138:139], v[138:139], v[204:207]
  s_waitcnt vmcnt(4)
  v_mfma_f32_4x4x4_16b_bf16 v[192:195], v[208:209], v[140:141], v[192:195]
  buffer_load_dwordx4 v[160:163], v254, s[4:7], s89 offen offset:0
  v_mfma_f32_4x4x4_16b_bf16 v[196:199], v[140:141], v[140:141], v[196:199]
  v_mfma_f32_4x4x4_16b_bf16 v[200:203], v[208:209], v[142:143], v[200:203]
  v_mfma_f32_4x4x4_16b_bf16 v[204:207], v[142:143], v[142:143], v[204:207]
  s_waitcnt vmcnt(4)
  v_mfma_f32_4x4x4_16b_bf16 v[192:195], v[208:209], v[144:145], v[192:195]
  buffer_load_dwordx4 v[164:167], v254, s[4:7], s89 offen offset:128
  v_mfma_f32_4x4x4_16b_bf16 v[196:199], v[144:145], v[144:145], v[196:199]
  v_mfma_f32_4x4x4_16b_bf16 v[200:203], v[208:209], v[146:147], v[200:203]
  v_mfma_f32_4x4x4_16b_bf16 v[204:207], v[146:147], v[146:147], v[204:207]
  s_waitcnt vmcnt(4)
  v_mfma_f32_4x4x4_16b_bf16 v[192:195], v[208:209], v[148:149], v[192:195]
  buffer_load_dwordx4 v[168:171], v254, s[4:7], s90 offen offset:0
  v_mfma_f32_4x4x4_16b_bf16 v[196:199], v[148:149], v[148:149], v[196:199]
  v_mfma_f32_4x4x4_16b_bf16 v[200:203], v[208:209], v[150:151], v[200:203]
  v_mfma_f32_4x4x4_16b_bf16 v[204:207], v[150:151], v[150:151], v[204:207]
  s_waitcnt vmcnt(4)
  v_mfma_f32_4x4x4_16b_bf16 v[192:195], v[208:209], v[152:153], v[192:195]
  buffer_load_dwordx4 v[172:175], v254, s[4:7], s90 offen offset:128
  v_mfma_f32_4x4x4_16b_bf16 v[196:199], v[152:153], v[152:153], v[196:199]
  v_mfma_f32_4x4x4_16b_bf16 v[200:203], v[208:209], v[154:155], v[200:203]
  v_mfma_f32_4x4x4_16b_bf16 v[204:207], v[154:155], v[154:155], v[204:207]
  buffer_load_dwordx4 v[176:179], v254, s[4:7], s91 offen offset:0
  s_nop 3
  v_add_f32 v192, v192, v200
  v_add_f32 v196, v196, v204
  v_add_f32 v197, v197, v205
  v_add_f32 v198, v198, v206
  v_add_f32 v199, v199, v207
  v_add_f32_dpp v216, v192, v192 quad_perm:[1,0,3,2] row_mask:0xf bank_mask:0xf
  v_mov_b32_dpp v217, v196 quad_perm:[0,0,0,0] row_mask:0xf bank_mask:0xf
  v_mov_b32_dpp v218, v197 quad_perm:[1,1,1,1] row_mask:0xf bank_mask:0xf
  v_add_f32_dpp v216, v216, v216 quad_perm:[2,3,0,1] row_mask:0xf bank_mask:0xf
  v_add_f32_dpp v217, v198, v217 quad_perm:[2,2,2,2] row_mask:0xf bank_mask:0xf
  v_add_f32_dpp v218, v199, v218 quad_perm:[3,3,3,3] row_mask:0xf bank_mask:0xf
  v_add_f32_dpp v216, v216, v216 row_half_mirror row_mask:0xf bank_mask:0xf
  v_add_f32 v217, v217, v218
  v_mul_f32 v216, 0xbb124925, v216
  v_mul_f32 v218, v216, v216
  v_add_f32_dpp v217, v217, v217 row_half_mirror row_mask:0xf bank_mask:0xf
  buffer_load_dwordx4 v[180:183], v254, s[4:7], s91 offen offset:128
  v_fma_f32 v217, v217, v210, -v218
  v_max_f32 v217, 0, v217
  v_add_f32 v217, 0x3727c5ac, v217
  v_rsq_f32 v217, v217
  s_nop 0
  v_cvt_pk_bf16_f32 v218, v217, v217
  v_and_b32 v184, v212, v218
  v_and_b32 v185, v213, v218
  v_and_b32 v218, 0xffff0000, v218
  v_sub_f32 v218, v217, v218
  v_cvt_pk_bf16_f32 v218, v218, v218
  v_and_b32 v186, v212, v218
  v_and_b32 v187, v213, v218
  v_mul_f32 v188, v216, v217
  v_mul_f32 v189, v216, v217
  v_mul_f32 v190, v216, v217
  v_mul_f32 v191, v216, v217
  s_nop 1
  v_mfma_f32_4x4x4_16b_bf16 v[16:19], v[184:185], v[128:129], v[188:191]
  v_mfma_f32_4x4x4_16b_bf16 v[20:23], v[184:185], v[130:131], v[188:191]
  v_mfma_f32_4x4x4_16b_bf16 v[24:27], v[184:185], v[132:133], v[188:191]
  v_mfma_f32_4x4x4_16b_bf16 v[16:19], v[186:187], v[128:129], v[16:19]
  v_mfma_f32_4x4x4_16b_bf16 v[20:23], v[186:187], v[130:131], v[20:23]
  v_mfma_f32_4x4x4_16b_bf16 v[28:31], v[184:185], v[134:135], v[188:191]
  s_nop 3
  v_cvt_pk_bf16_f32 v128, v16, v17
  v_mfma_f32_4x4x4_16b_bf16 v[24:27], v[186:187], v[132:133], v[24:27]
  v_cvt_pk_bf16_f32 v129, v18, v19
  v_mfma_f32_4x4x4_16b_bf16 v[32:35], v[184:185], v[136:137], v[188:191]
  v_cvt_pk_bf16_f32 v130, v20, v21
  v_mfma_f32_4x4x4_16b_bf16 v[28:31], v[186:187], v[134:135], v[28:31]
  v_cvt_pk_bf16_f32 v131, v22, v23
  ds_write_b128 v224, v[128:131] offset:0
  v_mfma_f32_4x4x4_16b_bf16 v[36:39], v[184:185], v[138:139], v[188:191]
  v_cvt_pk_bf16_f32 v132, v24, v25
  v_mfma_f32_4x4x4_16b_bf16 v[32:35], v[186:187], v[136:137], v[32:35]
  v_cvt_pk_bf16_f32 v133, v26, v27
  v_mfma_f32_4x4x4_16b_bf16 v[40:43], v[184:185], v[140:141], v[188:191]
  v_cvt_pk_bf16_f32 v134, v28, v29
  v_mfma_f32_4x4x4_16b_bf16 v[36:39], v[186:187], v[138:139], v[36:39]
  v_cvt_pk_bf16_f32 v135, v30, v31
  ds_write_b128 v224, v[132:135] offset:16384
  v_mfma_f32_4x4x4_16b_bf16 v[44:47], v[184:185], v[142:143], v[188:191]
  v_cvt_pk_bf16_f32 v136, v32, v33
  v_mfma_f32_4x4x4_16b_bf16 v[40:43], v[186:187], v[140:141], v[40:43]
  v_cvt_pk_bf16_f32 v137, v34, v35
  v_mfma_f32_4x4x4_16b_bf16 v[48:51], v[184:185], v[144:145], v[188:191]
  v_cvt_pk_bf16_f32 v138, v36, v37
  v_mfma_f32_4x4x4_16b_bf16 v[44:47], v[186:187], v[142:143], v[44:47]
  v_cvt_pk_bf16_f32 v139, v38, v39
  ds_write_b128 v224, v[136:139] offset:32768
  s_add_u32 m0, s38, 118784
  s_add_u32 s46, s60, 86016
  buffer_load_dwordx4 v2, s[8:11], s46 offen lds
  v_mfma_f32_4x4x4_16b_bf16 v[52:55], v[184:185], v[146:147], v[188:191]
  v_cvt_pk_bf16_f32 v140, v40, v41
  v_mfma_f32_4x4x4_16b_bf16 v[48:51], v[186:187], v[144:145], v[48:51]
  v_cvt_pk_bf16_f32 v141, v42, v43
  v_mfma_f32_4x4x4_16b_bf16 v[56:59], v[184:185], v[148:149], v[188:191]
  v_cvt_pk_bf16_f32 v142, v44, v45
  v_mfma_f32_4x4x4_16b_bf16 v[52:55], v[186:187], v[146:147], v[52:55]
  v_cvt_pk_bf16_f32 v143, v46, v47
  ds_write_b128 v224, v[140:143] offset:49152
  v_mfma_f32_4x4x4_16b_bf16 v[60:63], v[184:185], v[150:151], v[188:191]
  v_cvt_pk_bf16_f32 v144, v48, v49
  v_mfma_f32_4x4x4_16b_bf16 v[56:59], v[186:187], v[148:149], v[56:59]
  v_cvt_pk_bf16_f32 v145, v50, v51
  v_mfma_f32_4x4x4_16b_bf16 v[64:67], v[184:185], v[152:153], v[188:191]
  v_cvt_pk_bf16_f32 v146, v52, v53
  v_mfma_f32_4x4x4_16b_bf16 v[60:63], v[186:187], v[150:151], v[60:63]
  v_cvt_pk_bf16_f32 v147, v54, v55
  ds_write_b128 v225, v[144:147] offset:0
  v_mfma_f32_4x4x4_16b_bf16 v[68:71], v[184:185], v[154:155], v[188:191]
  v_cvt_pk_bf16_f32 v148, v56, v57
  v_mfma_f32_4x4x4_16b_bf16 v[64:67], v[186:187], v[152:153], v[64:67]
  v_cvt_pk_bf16_f32 v149, v58, v59
  v_cvt_pk_bf16_f32 v150, v60, v61
  v_mfma_f32_4x4x4_16b_bf16 v[68:71], v[186:187], v[154:155], v[68:71]
  v_cvt_pk_bf16_f32 v151, v62, v63
  ds_write_b128 v225, v[148:151] offset:16384
  s_add_u32 m0, s38, 126976
  s_add_u32 s46, s61, 86016
  buffer_load_dwordx4 v2, s[8:11], s46 offen lds
  v_cvt_pk_bf16_f32 v152, v64, v65
  v_cvt_pk_bf16_f32 v153, v66, v67
  v_cvt_pk_bf16_f32 v154, v68, v69
  v_cvt_pk_bf16_f32 v155, v70, v71
  ds_write_b128 v225, v[152:155] offset:32768
  s_setprio 0
  s_waitcnt vmcnt(8)
  v_mfma_f32_4x4x4_16b_bf16 v[192:195], v[208:209], v[156:157], 0
  v_mfma_f32_4x4x4_16b_bf16 v[196:199], v[156:157], v[156:157], 0
  v_mfma_f32_4x4x4_16b_bf16 v[200:203], v[208:209], v[158:159], 0
  v_mfma_f32_4x4x4_16b_bf16 v[204:207], v[158:159], v[158:159], 0
  s_waitcnt vmcnt(7)
  v_mfma_f32_4x4x4_16b_bf16 v[192:195], v[208:209], v[160:161], v[192:195]
  v_mfma_f32_4x4x4_16b_bf16 v[196:199], v[160:161], v[160:161], v[196:199]
  v_mfma_f32_4x4x4_16b_bf16 v[200:203], v[208:209], v[162:163], v[200:203]
  v_mfma_f32_4x4x4_16b_bf16 v[204:207], v[162:163], v[162:163], v[204:207]
  s_waitcnt vmcnt(6)
  v_mfma_f32_4x4x4_16b_bf16 v[192:195], v[208:209], v[164:165], v[192:195]
  v_mfma_f32_4x4x4_16b_bf16 v[196:199], v[164:165], v[164:165], v[196:199]
  v_mfma_f32_4x4x4_16b_bf16 v[200:203], v[208:209], v[166:167], v[200:203]
  v_mfma_f32_4x4x4_16b_bf16 v[204:207], v[166:167], v[166:167], v[204:207]
  s_waitcnt vmcnt(5)
  v_mfma_f32_4x4x4_16b_bf16 v[192:195], v[208:209], v[168:169], v[192:195]
  v_mfma_f32_4x4x4_16b_bf16 v[196:199], v[168:169], v[168:169], v[196:199]
  v_mfma_f32_4x4x4_16b_bf16 v[200:203], v[208:209], v[170:171], v[200:203]
  v_mfma_f32_4x4x4_16b_bf16 v[204:207], v[170:171], v[170:171], v[204:207]
  s_waitcnt vmcnt(4)
  v_mfma_f32_4x4x4_16b_bf16 v[192:195], v[208:209], v[172:173], v[192:195]
  v_mfma_f32_4x4x4_16b_bf16 v[196:199], v[172:173], v[172:173], v[196:199]
  v_mfma_f32_4x4x4_16b_bf16 v[200:203], v[208:209], v[174:175], v[200:203]
  v_mfma_f32_4x4x4_16b_bf16 v[204:207], v[174:175], v[174:175], v[204:207]
  s_waitcnt vmcnt(3)
  v_mfma_f32_4x4x4_16b_bf16 v[192:195], v[208:209], v[176:177], v[192:195]
  v_mfma_f32_4x4x4_16b_bf16 v[196:199], v[176:177], v[176:177], v[196:199]
  v_mfma_f32_4x4x4_16b_bf16 v[200:203], v[208:209], v[178:179], v[200:203]
  v_mfma_f32_4x4x4_16b_bf16 v[204:207], v[178:179], v[178:179], v[204:207]
  s_waitcnt vmcnt(2)
  v_mfma_f32_4x4x4_16b_bf16 v[192:195], v[208:209], v[180:181], v[192:195]
  v_mfma_f32_4x4x4_16b_bf16 v[196:199], v[180:181], v[180:181], v[196:199]
  v_mfma_f32_4x4x4_16b_bf16 v[200:203], v[208:209], v[182:183], v[200:203]
  v_mfma_f32_4x4x4_16b_bf16 v[204:207], v[182:183], v[182:183], v[204:207]
  s_nop 4
  v_add_f32 v192, v192, v200
  v_add_f32 v196, v196, v204
  v_add_f32 v197, v197, v205
  v_add_f32 v198, v198, v206
  v_add_f32 v199, v199, v207
  v_add_f32_dpp v216, v192, v192 quad_perm:[1,0,3,2] row_mask:0xf bank_mask:0xf
  v_mov_b32_dpp v217, v196 quad_perm:[0,0,0,0] row_mask:0xf bank_mask:0xf
  v_mov_b32_dpp v218, v197 quad_perm:[1,1,1,1] row_mask:0xf bank_mask:0xf
  v_add_f32_dpp v216, v216, v216 quad_perm:[2,3,0,1] row_mask:0xf bank_mask:0xf
  v_add_f32_dpp v217, v198, v217 quad_perm:[2,2,2,2] row_mask:0xf bank_mask:0xf
  v_add_f32_dpp v218, v199, v218 quad_perm:[3,3,3,3] row_mask:0xf bank_mask:0xf
  v_add_f32_dpp v216, v216, v216 row_half_mirror row_mask:0xf bank_mask:0xf
  v_add_f32 v217, v217, v218
  v_mul_f32 v216, 0xbb124925, v216
  v_mul_f32 v218, v216, v216
  v_add_f32_dpp v217, v217, v217 row_half_mirror row_mask:0xf bank_mask:0xf
  v_fma_f32 v217, v217, v210, -v218
  v_max_f32 v217, 0, v217
  v_add_f32 v217, 0x3727c5ac, v217
  v_rsq_f32 v217, v217
  s_nop 0
  v_cvt_pk_bf16_f32 v218, v217, v217
  v_and_b32 v184, v212, v218
  v_and_b32 v185, v213, v218
  v_and_b32 v218, 0xffff0000, v218
  v_sub_f32 v218, v217, v218
  v_cvt_pk_bf16_f32 v218, v218, v218
  v_and_b32 v186, v212, v218
  v_and_b32 v187, v213, v218
  v_mul_f32 v188, v216, v217
  v_mul_f32 v189, v216, v217
  v_mul_f32 v190, v216, v217
  v_mul_f32 v191, v216, v217
  s_nop 1
  v_mfma_f32_4x4x4_16b_bf16 v[72:75], v[184:185], v[156:157], v[188:191]
  v_mfma_f32_4x4x4_16b_bf16 v[76:79], v[184:185], v[158:159], v[188:191]
  v_mfma_f32_4x4x4_16b_bf16 v[80:83], v[184:185], v[160:161], v[188:191]
  v_mfma_f32_4x4x4_16b_bf16 v[72:75], v[186:187], v[156:157], v[72:75]
  v_mfma_f32_4x4x4_16b_bf16 v[76:79], v[186:187], v[158:159], v[76:79]
  v_mfma_f32_4x4x4_16b_bf16 v[84:87], v[184:185], v[162:163], v[188:191]
  s_nop 3
  v_cvt_pk_bf16_f32 v156, v72, v73
  v_mfma_f32_4x4x4_16b_bf16 v[80:83], v[186:187], v[160:161], v[80:83]
  v_cvt_pk_bf16_f32 v157, v74, v75
  v_mfma_f32_4x4x4_16b_bf16 v[88:91], v[184:185], v[164:165], v[188:191]
  v_cvt_pk_bf16_f32 v158, v76, v77
  v_mfma_f32_4x4x4_16b_bf16 v[84:87], v[186:187], v[162:163], v[84:87]
  v_cvt_pk_bf16_f32 v159, v78, v79
  ds_write_b128 v226, v[156:159] offset:0
  v_mfma_f32_4x4x4_16b_bf16 v[92:95], v[184:185], v[166:167], v[188:191]
  v_cvt_pk_bf16_f32 v160, v80, v81
  v_mfma_f32_4x4x4_16b_bf16 v[88:91], v[186:187], v[164:165], v[88:91]
  v_cvt_pk_bf16_f32 v161, v82, v83
  v_mfma_f32_4x4x4_16b_bf16 v[96:99], v[184:185], v[168:169], v[188:191]
  v_cvt_pk_bf16_f32 v162, v84, v85
  v_mfma_f32_4x4x4_16b_bf16 v[92:95], v[186:187], v[166:167], v[92:95]
  v_cvt_pk_bf16_f32 v163, v86, v87
  ds_write_b128 v226, v[160:163] offset:16384
  v_mfma_f32_4x4x4_16b_bf16 v[100:103], v[184:185], v[170:171], v[188:191]
  v_cvt_pk_bf16_f32 v164, v88, v89
  v_mfma_f32_4x4x4_16b_bf16 v[96:99], v[186:187], v[168:169], v[96:99]
  v_cvt_pk_bf16_f32 v165, v90, v91
  v_mfma_f32_4x4x4_16b_bf16 v[104:107], v[184:185], v[172:173], v[188:191]
  v_cvt_pk_bf16_f32 v166, v92, v93
  v_mfma_f32_4x4x4_16b_bf16 v[100:103], v[186:187], v[170:171], v[100:103]
  v_cvt_pk_bf16_f32 v167, v94, v95
  ds_write_b128 v226, v[164:167] offset:32768
  v_mfma_f32_4x4x4_16b_bf16 v[108:111], v[184:185], v[174:175], v[188:191]
  v_cvt_pk_bf16_f32 v168, v96, v97
  v_mfma_f32_4x4x4_16b_bf16 v[104:107], v[186:187], v[172:173], v[104:107]
  v_cvt_pk_bf16_f32 v169, v98, v99
  v_mfma_f32_4x4x4_16b_bf16 v[112:115], v[184:185], v[176:177], v[188:191]
  v_cvt_pk_bf16_f32 v170, v100, v101
  v_mfma_f32_4x4x4_16b_bf16 v[108:111], v[186:187], v[174:175], v[108:111]
  v_cvt_pk_bf16_f32 v171, v102, v103
  ds_write_b128 v226, v[168:171] offset:49152
  v_mfma_f32_4x4x4_16b_bf16 v[116:119], v[184:185], v[178:179], v[188:191]
  v_cvt_pk_bf16_f32 v172, v104, v105
  v_mfma_f32_4x4x4_16b_bf16 v[112:115], v[186:187], v[176:177], v[112:115]
  v_cvt_pk_bf16_f32 v173, v106, v107
  v_mfma_f32_4x4x4_16b_bf16 v[120:123], v[184:185], v[180:181], v[188:191]
  v_cvt_pk_bf16_f32 v174, v108, v109
  v_mfma_f32_4x4x4_16b_bf16 v[116:119], v[186:187], v[178:179], v[116:119]
  v_cvt_pk_bf16_f32 v175, v110, v111
  ds_write_b128 v227, v[172:175] offset:0
  v_mfma_f32_4x4x4_16b_bf16 v[124:127], v[184:185], v[182:183], v[188:191]
  v_cvt_pk_bf16_f32 v176, v112, v113
  v_mfma_f32_4x4x4_16b_bf16 v[120:123], v[186:187], v[180:181], v[120:123]
  v_cvt_pk_bf16_f32 v177, v114, v115
  v_cvt_pk_bf16_f32 v178, v116, v117
  v_mfma_f32_4x4x4_16b_bf16 v[124:127], v[186:187], v[182:183], v[124:127]
  v_cvt_pk_bf16_f32 v179, v118, v119
  ds_write_b128 v227, v[176:179] offset:16384
  s_nop 0
  v_cvt_pk_bf16_f32 v180, v120, v121
  v_cvt_pk_bf16_f32 v181, v122, v123
  s_nop 0
  v_cvt_pk_bf16_f32 v182, v124, v125
  v_cvt_pk_bf16_f32 v183, v126, v127
  ds_write_b128 v227, v[180:183] offset:32768
  s_waitcnt vmcnt(0) lgkmcnt(0)
  s_barrier
  ds_read_b128 v[16:19], v244 offset:0
  ds_read_b64_tr_b16 v[192:193], v220 offset:16384
  ds_read_b64_tr_b16 v[194:195], v220 offset:16896
  ds_read_b128 v[20:23], v245 offset:4096
  ds_read_b64_tr_b16 v[196:197], v220 offset:18432
  ds_read_b64_tr_b16 v[198:199], v220 offset:18944
  ds_read_b128 v[24:27], v246 offset:8192
  ds_read_b64_tr_b16 v[200:201], v220 offset:20480
  ds_read_b64_tr_b16 v[202:203], v220 offset:20992
  ds_read_b128 v[28:31], v247 offset:12288
  ds_read_b64_tr_b16 v[204:205], v220 offset:22528
  ds_read_b64_tr_b16 v[206:207], v220 offset:23040
  ds_read_b64_tr_b16 v[208:209], v220 offset:24576
  ds_read_b64_tr_b16 v[210:211], v220 offset:25088
  s_waitcnt lgkmcnt(8)
  v_mfma_f32_32x32x16_bf16 v[160:175], v[16:19], v[192:195], 0
  v_xor_b32 v7, 32, v6
  s_lshl2_add_u32 s50, s40, s37
  v_mov_b32 v8, 0xc0135761
  ds_read_b128 v[32:35], v244 offset:16384
  s_mul_i32 s43, s44, 0x9E3779B1
  s_add_u32 s43, s43, 0x7F4A7C15
  ds_read_b64_tr_b16 v[212:213], v220 offset:26624
  ds_read_b64_tr_b16 v[214:215], v220 offset:27136
  v_mfma_f32_32x32x16_bf16 v[160:175], v[20:23], v[196:199], v[160:175]
  v_lshlrev_b32 v12, 4, v241
  s_mul_i32 s50, s50, 147456
  ds_read_b128 v[36:39], v245 offset:20480
  s_and_b32 s45, s44, 0xfff
  s_add_u32 s45, s45, 1
  ds_read_b64_tr_b16 v[192:193], v220 offset:28672
  ds_read_b64_tr_b16 v[194:195], v220 offset:29184
  s_waitcnt lgkmcnt(8)
  v_mfma_f32_32x32x16_bf16 v[160:175], v[24:27], v[200:203], v[160:175]
  v_lshl_add_u32 v12, v249, 6, v12
  s_add_u32 s50, s50, 8388608
  ds_read_b128 v[40:43], v246 offset:24576
  s_lshl_b32 s45, s45, 16
  s_add_u32 s45, s45, s44
  ds_read_b64_tr_b16 v[196:197], v220 offset:30720
  ds_read_b64_tr_b16 v[198:199], v220 offset:31232
  s_waitcnt lgkmcnt(8)
  v_mfma_f32_32x32x16_bf16 v[160:175], v[28:31], v[204:207], v[160:175]
  s_barrier
  v_mfma_f32_32x32x16_bf16 v[160:175], v[32:35], v[208:211], v[160:175]
  ds_read_b64_tr_b16 v[200:201], v220 offset:32768
  ds_read_b64_tr_b16 v[202:203], v220 offset:33280
  v_lshl_add_u32 v12, s41, 7, v12
  s_mul_i32 s55, s39, 7
  v_mul_u32_u24 v4, 896, v248
  ds_read_b128 v[44:47], v247 offset:28672
  s_and_b32 s45, s45, 0x1fff0000
  s_or_b32 s45, s45, 0x40000000
  s_add_u32 s56, s55, 7
  v_add_u32 v4, v4, v12
  ds_read_b128 v[48:51], v244 offset:32768
  ds_read_b64_tr_b16 v[204:205], v220 offset:34816
  ds_read_b64_tr_b16 v[206:207], v220 offset:35328
  s_waitcnt lgkmcnt(9)
  v_mfma_f32_32x32x16_bf16 v[160:175], v[36:39], v[212:215], v[160:175]
  s_lshr_b32 s54, s37, 1
  s_and_b32 s52, s40, 3
  ds_read_b128 v[52:55], v245 offset:36864
  ds_read_b64_tr_b16 v[208:209], v220 offset:36864
  ds_read_b64_tr_b16 v[210:211], v220 offset:37376
  s_waitcnt lgkmcnt(11)
  v_mfma_f32_32x32x16_bf16 v[160:175], v[40:43], v[192:195], v[160:175]
  s_mul_i32 s54, s54, 14
  s_lshl_b32 s52, s52, 1
  v_add_u32 v14, s54, v243
  ds_read_b128 v[56:59], v246 offset:40960
  s_bfe_u32 s60, s58, 0x40000
  s_mul_i32 s60, s60, 229376
  s_bfe_u32 s61, s58, 0x40004
  s_mul_i32 s61, s61, 229376
  s_bfe_u32 s62, s58, 0x40008
  s_mul_i32 s62, s62, 229376
  ds_read_b64_tr_b16 v[212:213], v220 offset:38912
  ds_read_b64_tr_b16 v[214:215], v220 offset:39424
  s_waitcnt lgkmcnt(10)
  s_waitcnt lgkmcnt(9)
  v_mfma_f32_32x32x16_bf16 v[160:175], v[44:47], v[196:199], v[160:175]
  s_max_u32 s52, s52, 1
  v_mul_u32_u24 v14, 1792, v14
  ds_read_b128 v[60:63], v247 offset:45056
  s_bfe_u32 s63, s58, 0x4000c
  s_mul_i32 s63, s63, 229376
  s_bfe_u32 s64, s58, 0x40010
  s_mul_i32 s64, s64, 229376
  ds_read_b64_tr_b16 v[192:193], v220 offset:40960
  ds_read_b64_tr_b16 v[194:195], v220 offset:41472
  s_waitcnt lgkmcnt(11)
  v_mfma_f32_32x32x16_bf16 v[160:175], v[48:51], v[200:203], v[160:175]
  s_add_u32 s93, s92, s52
  s_cmp_ge_u32 s93, s56
  s_cselect_b32 s46, 7, 0
  s_sub_u32 s93, s93, s46
  v_add_u32 v5, v14, v12
  ds_read_b128 v[64:67], v244 offset:49152
  s_bfe_u32 s65, s58, 0x40014
  s_mul_i32 s65, s65, 229376
  s_bfe_u32 s66, s58, 0x40018
  s_mul_i32 s66, s66, 229376
  ds_read_b64_tr_b16 v[196:197], v220 offset:43008
  ds_read_b64_tr_b16 v[198:199], v220 offset:43520
  s_waitcnt lgkmcnt(8)
  v_mfma_f32_32x32x16_bf16 v[160:175], v[52:55], v[204:207], v[160:175]
  s_barrier
  v_mfma_f32_32x32x16_bf16 v[160:175], v[56:59], v[208:211], v[160:175]
  ds_read_b64_tr_b16 v[200:201], v220 offset:45056
  ds_read_b64_tr_b16 v[202:203], v220 offset:45568
  v_and_b32 v11, 1, v241
  s_add_u32 s94, s93, s52
  s_cmp_ge_u32 s94, s56
  s_cselect_b32 s46, 7, 0
  s_sub_u32 s94, s94, s46
  v_lshlrev_b32 v11, 2, v11
  ds_read_b128 v[68:71], v245 offset:53248
  s_add_u32 s95, s94, s52
  s_cmp_ge_u32 s95, s56
  s_cselect_b32 s46, 7, 0
  s_sub_u32 s95, s95, s46
  v_lshl_add_u32 v11, v240, 1, v11
  ds_read_b128 v[72:75], v246 offset:57344
  ds_read_b64_tr_b16 v[204:205], v220 offset:47104
  ds_read_b64_tr_b16 v[206:207], v220 offset:47616
  s_waitcnt lgkmcnt(9)
  v_mfma_f32_32x32x16_bf16 v[160:175], v[60:63], v[212:215], v[160:175]
  s_add_u32 s96, s95, s52
  s_cmp_ge_u32 s96, s56
  s_cselect_b32 s46, 7, 0
  s_sub_u32 s96, s96, s46
  v_lshrrev_b32 v12, 1, v241
  ds_read_b128 v[76:79], v247 offset:61440
  ds_read_b64_tr_b16 v[208:209], v220 offset:49152
  ds_read_b64_tr_b16 v[210:211], v220 offset:49664
  s_waitcnt lgkmcnt(11)
  v_mfma_f32_32x32x16_bf16 v[160:175], v[64:67], v[192:195], v[160:175]
  s_add_u32 s97, s96, s52
  s_cmp_ge_u32 s97, s56
  s_cselect_b32 s46, 7, 0
  s_sub_u32 s97, s97, s46
  v_add_lshl_u32 v11, v11, v12, 3
  v_lshl_add_u32 v11, v242, 7, v11
  v_add_u32 v244, 65536, v244
  ds_read_b128 v[80:83], v244 offset:0
  ds_read_b64_tr_b16 v[212:213], v220 offset:51200
  ds_read_b64_tr_b16 v[214:215], v220 offset:51712
  s_waitcnt lgkmcnt(10)
  s_waitcnt lgkmcnt(9)
  v_mfma_f32_32x32x16_bf16 v[160:175], v[68:71], v[196:199], v[160:175]
  s_add_u32 s98, s97, s52
  s_cmp_ge_u32 s98, s56
  s_cselect_b32 s46, 7, 0
  s_sub_u32 s98, s98, s46
  v_lshl_add_u32 v11, v243, 9, v11
  v_add_u32 v245, 65536, v245
  ds_read_b128 v[84:87], v245 offset:4096
  ds_read_b64_tr_b16 v[192:193], v220 offset:53248
  ds_read_b64_tr_b16 v[194:195], v220 offset:53760
  s_waitcnt lgkmcnt(11)
  v_mfma_f32_32x32x16_bf16 v[160:175], v[72:75], v[200:203], v[160:175]
  s_mov_b32 s30, 1835008
  v_lshrrev_b32 v12, 1, v242
  v_add_u32 v246, 65536, v246
  ds_read_b128 v[88:91], v246 offset:8192
  ds_read_b64_tr_b16 v[196:197], v220 offset:55296
  ds_read_b64_tr_b16 v[198:199], v220 offset:55808
  s_waitcnt lgkmcnt(8)
  v_mfma_f32_32x32x16_bf16 v[160:175], v[76:79], v[204:207], v[160:175]
  s_barrier
  v_mfma_f32_32x32x16_bf16 v[160:175], v[80:83], v[208:211], v[160:175]
  ds_read_b64_tr_b16 v[200:201], v220 offset:57344
  ds_read_b64_tr_b16 v[202:203], v220 offset:57856
  s_mov_b32 s31, 0x20000
  v_lshl_add_u32 v251, v12, 6, v11
  v_and_b32 v11, 1, v242
  v_add_u32 v247, 65536, v247
  ds_read_b128 v[92:95], v247 offset:12288
  v_xor_b32 v11, v11, v240
  v_and_b32 v12, 1, v241
  ds_read_b128 v[96:99], v244 offset:16384
  ds_read_b64_tr_b16 v[204:205], v220 offset:59392
  ds_read_b64_tr_b16 v[206:207], v220 offset:59904
  s_waitcnt lgkmcnt(9)
  v_mfma_f32_32x32x16_bf16 v[160:175], v[84:87], v[212:215], v[160:175]
  v_xor_b32 v12, v12, v243
  v_lshl_add_u32 v11, v12, 1, v11
  ds_read_b128 v[100:103], v245 offset:20480
  ds_read_b64_tr_b16 v[208:209], v220 offset:61440
  ds_read_b64_tr_b16 v[210:211], v220 offset:61952
  s_waitcnt lgkmcnt(11)
  v_mfma_f32_32x32x16_bf16 v[160:175], v[88:91], v[192:195], v[160:175]
  s_and_b32 s54, s37, 1
  v_lshrrev_b32 v12, 1, v242
  v_xor_b32 v12, s54, v12
  ds_read_b128 v[104:107], v246 offset:24576
  ds_read_b64_tr_b16 v[212:213], v220 offset:63488
  ds_read_b64_tr_b16 v[214:215], v220 offset:64000
  s_waitcnt lgkmcnt(10)
  s_waitcnt lgkmcnt(9)
  v_mfma_f32_32x32x16_bf16 v[160:175], v[92:95], v[196:199], v[160:175]
  v_lshl_add_u32 v11, v12, 2, v11
  v_lshrrev_b32 v12, 1, v241
  ds_read_b128 v[108:111], v247 offset:28672
  ds_read_b64_tr_b16 v[192:193], v220 offset:16384
  ds_read_b64_tr_b16 v[194:195], v220 offset:16896
  s_waitcnt lgkmcnt(11)
  v_mfma_f32_32x32x16_bf16 v[160:175], v[96:99], v[200:203], v[160:175]
  v_lshl_add_u32 v11, v11, 1, v12
  v_lshl_add_u32 v12, v243, 2, v242
  ds_read_b128 v[112:115], v244 offset:32768
  ds_read_b64_tr_b16 v[196:197], v220 offset:18432
  ds_read_b64_tr_b16 v[198:199], v220 offset:18944
  s_waitcnt lgkmcnt(8)
  v_mfma_f32_32x32x16_bf16 v[160:175], v[100:103], v[204:207], v[160:175]
  s_barrier
  v_mfma_f32_32x32x16_bf16 v[160:175], v[104:107], v[208:211], v[160:175]
  ds_read_b64_tr_b16 v[200:201], v220 offset:20480
  ds_read_b64_tr_b16 v[202:203], v220 offset:20992
  v_lshlrev_b32 v12, 7, v12
  v_lshl_add_u32 v222, v11, 3, v12
  ds_read_b128 v[116:119], v245 offset:36864
  ds_read_b128 v[120:123], v246 offset:40960
  v_lshl_add_u32 v14, s37, 11, v1
  ds_read_b64_tr_b16 v[204:205], v220 offset:22528
  ds_read_b64_tr_b16 v[206:207], v220 offset:23040
  s_waitcnt lgkmcnt(9)
  v_mfma_f32_32x32x16_bf16 v[160:175], v[108:111], v[212:215], v[160:175]
  ds_read_b128 v[124:127], v247 offset:45056
  v_and_b32 v11, 31, v15
  v_subrev_u32 v12, 26, v11
  ds_read_b64_tr_b16 v[208:209], v6 offset:8192
  ds_read_b64_tr_b16 v[210:211], v6 offset:8704
  s_waitcnt lgkmcnt(11)
  v_mfma_f32_32x32x16_bf16 v[160:175], v[112:115], v[192:195], v[160:175]
  v_mov_b32 v2, v251
  v_cmp_gt_u32 vcc, 4, v12
  ds_read_b64_tr_b16 v[212:213], v6 offset:12288
  ds_read_b64_tr_b16 v[214:215], v6 offset:12800
  s_waitcnt lgkmcnt(9)
  s_waitcnt lgkmcnt(8)
  v_mfma_f32_32x32x16_bf16 v[160:175], v[116:119], v[196:199], v[160:175]
  v_xor_b32 v12, 96, v14
  v_cndmask_b32 v13, v14, v12, vcc
  ds_read_b64_tr_b16 v[192:193], v6 offset:16384
  ds_read_b64_tr_b16 v[194:195], v6 offset:16896
  s_waitcnt lgkmcnt(9)
  v_mfma_f32_32x32x16_bf16 v[160:175], v[120:123], v[200:203], v[160:175]
  v_mov_b32 v12, 0x3f803f80
  ds_read_b64_tr_b16 v[196:197], v6 offset:20480
  ds_read_b64_tr_b16 v[198:199], v6 offset:20992
  s_waitcnt lgkmcnt(6)
  v_mfma_f32_32x32x16_bf16 v[160:175], v[124:127], v[204:207], v[160:175]
  s_barrier
  v_mfma_f32_32x32x16_bf16 v[128:143], v[208:211], v[16:19], 0
  ds_read_b64_tr_b16 v[200:201], v6 offset:24576
  ds_read_b64_tr_b16 v[202:203], v6 offset:25088
  v_cmp_lt_u32 vcc, 27, v11
  ds_read_b64_tr_b16 v[204:205], v6 offset:28672
  ds_read_b64_tr_b16 v[206:207], v6 offset:29184
  s_waitcnt lgkmcnt(6)
  v_mfma_f32_32x32x16_bf16 v[128:143], v[212:215], v[20:23], v[128:143]
  s_add_u32 m0, s38, 147456
  s_add_u32 s46, s65, 0
  buffer_load_dwordx4 v3, s[20:23], s46 offen lds
  s_and_b32 s49, s40, 3
  s_lshl2_add_u32 s49, s49, s37
  s_mul_i32 s49, s49, 28
  v_min_u32 v14, 27, v15
  v_add_u32 v14, s49, v14
  s_mul_i32 s49, s39, 6272
  v_and_b32 v10, 0x1c0, v14
  s_add_u32 s49, s49, s41
  v_add_u32 v14, v14, v10
  s_lshl_b32 s49, s49, 7
  s_add_u32 s49, s49, 57344
  v_mul_u32_u24 v14, 896, v14
  buffer_load_dword v225, v14, s[24:27], s49 offen
  s_and_b32 s49, s40, 3
  s_lshl2_add_u32 s49, s49, s37
  s_mul_i32 s49, s49, 28
  v_min_u32 v14, 27, v15
  v_add_u32 v14, s49, v14
  s_lshl_b32 s49, s41, 7
  v_mul_u32_u24 v14, 896, v14
  buffer_load_dword v226, v14, s[16:19], s49 offen
  v_add_u32 v6, 98304, v6
  ds_read_b64_tr_b16 v[208:209], v6 offset:24576
  ds_read_b64_tr_b16 v[210:211], v6 offset:25088
  v_mfma_f32_32x32x16_bf16 v[128:143], v[192:195], v[24:27], v[128:143]
  s_add_u32 m0, s38, 151552
  s_add_u32 s46, s65, 57344
  buffer_load_dwordx4 v3, s[20:23], s46 offen lds
  v_cvt_pk_bf16_f32 v160, v160, v161
  v_cvt_pk_bf16_f32 v161, v162, v163
  v_cndmask_b32 v160, v160, v12, vcc
  v_cvt_pk_bf16_f32 v162, v164, v165
  ds_read_b64_tr_b16 v[212:213], v6 offset:28672
  ds_read_b64_tr_b16 v[214:215], v6 offset:29184
  s_waitcnt lgkmcnt(6)
  v_mfma_f32_32x32x16_bf16 v[128:143], v[196:199], v[28:31], v[128:143]
  s_add_u32 m0, s38, 90112
  s_add_u32 s46, s65, 114688
  buffer_load_dwordx4 v3, s[20:23], s46 offen lds
  v_cndmask_b32 v161, v161, v12, vcc
  v_cvt_pk_bf16_f32 v163, v166, v167
  v_cndmask_b32 v162, v162, v12, vcc
  v_add_u32 v6, 4294901760, v6
  ds_read_b64_tr_b16 v[192:193], v6 offset:24576
  ds_read_b64_tr_b16 v[194:195], v6 offset:25088
  v_mfma_f32_32x32x16_bf16 v[128:143], v[200:203], v[32:35], v[128:143]
  s_add_u32 m0, s38, 94208
  s_add_u32 s46, s65, 172032
  buffer_load_dwordx4 v3, s[20:23], s46 offen lds
  v_cvt_pk_bf16_f32 v164, v168, v169
  v_cndmask_b32 v163, v163, v12, vcc
  v_cvt_pk_bf16_f32 v165, v170, v171
  ds_read_b64_tr_b16 v[196:197], v6 offset:28672
  ds_read_b64_tr_b16 v[198:199], v6 offset:29184
  s_waitcnt lgkmcnt(6)
  v_mfma_f32_32x32x16_bf16 v[128:143], v[204:207], v[36:39], v[128:143]
  s_barrier
  v_mfma_f32_32x32x16_bf16 v[128:143], v[208:211], v[40:43], v[128:143]
  v_add_u32 v6, 65536, v6
  ds_read_b64_tr_b16 v[200:201], v6 offset:32768
  ds_read_b64_tr_b16 v[202:203], v6 offset:33280
  v_cndmask_b32 v164, v164, v12, vcc
  v_cvt_pk_bf16_f32 v166, v172, v173
  v_cndmask_b32 v165, v165, v12, vcc
  s_add_u32 m0, s38, 98304
  s_add_u32 s46, s66, 0
  buffer_load_dwordx4 v3, s[20:23], s46 offen lds
  v_cvt_pk_bf16_f32 v167, v174, v175
  v_cndmask_b32 v166, v166, v12, vcc
  v_cndmask_b32 v167, v167, v12, vcc
  ds_read_b64_tr_b16 v[204:205], v6 offset:36864
  ds_read_b64_tr_b16 v[206:207], v6 offset:37376
  s_waitcnt lgkmcnt(6)
  v_mfma_f32_32x32x16_bf16 v[128:143], v[212:215], v[44:47], v[128:143]
  s_add_u32 m0, s38, 102400
  s_add_u32 s46, s66, 57344
  buffer_load_dwordx4 v3, s[20:23], s46 offen lds
  ds_write_b128 v13, v[160:163] offset:49152
  ds_read_b64_tr_b16 v[208:209], v6 offset:40960
  ds_read_b64_tr_b16 v[210:211], v6 offset:41472
  v_mfma_f32_32x32x16_bf16 v[128:143], v[192:195], v[48:51], v[128:143]
  ds_read_b64_tr_b16 v[212:213], v6 offset:45056
  ds_read_b64_tr_b16 v[214:215], v6 offset:45568
  s_waitcnt lgkmcnt(7)
  v_mfma_f32_32x32x16_bf16 v[128:143], v[196:199], v[52:55], v[128:143]
  s_add_u32 m0, s38, 106496
  s_add_u32 s46, s66, 114688
  buffer_load_dwordx4 v3, s[20:23], s46 offen lds
  ds_write_b128 v13, v[164:167] offset:50176
  v_add_u32 v6, 4294934528, v6
  ds_read_b64_tr_b16 v[192:193], v6 offset:0
  ds_read_b64_tr_b16 v[194:195], v6 offset:512
  v_mfma_f32_32x32x16_bf16 v[128:143], v[200:203], v[56:59], v[128:143]
  s_add_u32 m0, s38, 110592
  s_add_u32 s46, s66, 172032
  buffer_load_dwordx4 v3, s[20:23], s46 offen lds
  ds_read_b64_tr_b16 v[196:197], v7 offset:8192
  ds_read_b64_tr_b16 v[198:199], v7 offset:8704
  s_waitcnt lgkmcnt(7)
  v_mfma_f32_32x32x16_bf16 v[128:143], v[204:207], v[60:63], v[128:143]
  s_barrier
  v_mfma_f32_32x32x16_bf16 v[128:143], v[208:211], v[64:67], v[128:143]
  ds_read_b64_tr_b16 v[200:201], v6 offset:4096
  ds_read_b64_tr_b16 v[202:203], v6 offset:4608
  s_add_u32 m0, s38, 114688
  s_add_u32 s46, s60, 128
  buffer_load_dwordx4 v3, s[20:23], s46 offen lds
  ds_read_b64_tr_b16 v[204:205], v7 offset:12288
  ds_read_b64_tr_b16 v[206:207], v7 offset:12800
  s_waitcnt lgkmcnt(6)
  v_mfma_f32_32x32x16_bf16 v[128:143], v[212:215], v[68:71], v[128:143]
  s_add_u32 m0, s38, 118784
  s_add_u32 s46, s60, 57472
  buffer_load_dwordx4 v3, s[20:23], s46 offen lds
  s_and_b32 s49, s40, 3
  s_lshl2_add_u32 s49, s49, s37
  s_mul_i32 s49, s49, 28
  v_min_u32 v14, 27, v15
  v_add_u32 v14, s49, v14
  s_mul_i32 s49, s39, 6272
  v_and_b32 v10, 0x1c0, v14
  s_add_u32 s49, s49, s41
  v_add_u32 v14, v14, v10
  s_lshl_b32 s49, s49, 7
  v_mul_u32_u24 v14, 896, v14
  buffer_load_dword v224, v14, s[24:27], s49 offen
  ds_read_b64_tr_b16 v[208:209], v6 offset:8192
  ds_read_b64_tr_b16 v[210:211], v6 offset:8704
  v_mfma_f32_32x32x16_bf16 v[128:143], v[192:195], v[72:75], v[128:143]
  ds_read_b64_tr_b16 v[212:213], v7 offset:16384
  ds_read_b64_tr_b16 v[214:215], v7 offset:16896
  s_waitcnt lgkmcnt(6)
  v_mfma_f32_32x32x16_bf16 v[144:159], v[196:199], v[16:19], 0
  s_add_u32 m0, s38, 155648
  s_add_u32 s46, s60, 114816
  buffer_load_dwordx4 v3, s[20:23], s46 offen lds
  ds_read_b64_tr_b16 v[192:193], v6 offset:12288
  ds_read_b64_tr_b16 v[194:195], v6 offset:12800
  v_mfma_f32_32x32x16_bf16 v[128:143], v[200:203], v[76:79], v[128:143]
  s_add_u32 m0, s38, 159744
  s_add_u32 s46, s60, 172160
  buffer_load_dwordx4 v3, s[20:23], s46 offen lds
  ds_read_b64_tr_b16 v[196:197], v7 offset:20480
  ds_read_b64_tr_b16 v[198:199], v7 offset:20992
  s_waitcnt lgkmcnt(6)
  v_mfma_f32_32x32x16_bf16 v[144:159], v[204:207], v[20:23], v[144:159]
  ds_read_b64_tr_b16 v[200:201], v6 offset:16384
  ds_read_b64_tr_b16 v[202:203], v6 offset:16896
  v_mfma_f32_32x32x16_bf16 v[128:143], v[208:211], v[80:83], v[128:143]
  s_add_u32 m0, s38, 0
  s_add_u32 s46, s61, 128
  buffer_load_dwordx4 v3, s[20:23], s46 offen lds
  ds_read_b64_tr_b16 v[204:205], v7 offset:24576
  ds_read_b64_tr_b16 v[206:207], v7 offset:25088
  s_waitcnt vmcnt(10)
  s_waitcnt lgkmcnt(6)
  v_mfma_f32_32x32x16_bf16 v[144:159], v[212:215], v[24:27], v[144:159]
  s_barrier
  v_mfma_f32_32x32x16_bf16 v[128:143], v[192:195], v[84:87], v[128:143]
  ds_read_b64_tr_b16 v[208:209], v6 offset:20480
  ds_read_b64_tr_b16 v[210:211], v6 offset:20992
  s_add_u32 m0, s38, 4096
  s_add_u32 s46, s61, 57472
  buffer_load_dwordx4 v3, s[20:23], s46 offen lds
  ds_read_b64_tr_b16 v[240:241], v222 offset:32768
  ds_read_b64_tr_b16 v[242:243], v222 offset:33792
  ds_read_b128 v[160:163], v1 offset:49152
  ds_read_b64_tr_b16 v[244:245], v222 offset:34816
  ds_read_b64_tr_b16 v[246:247], v222 offset:35840
  ds_read_b128 v[164:167], v1 offset:50176
  ds_read_b64_tr_b16 v[248:249], v222 offset:36864
  ds_read_b64_tr_b16 v[250:251], v222 offset:37888
  ds_read_b128 v[168:171], v1 offset:51200
  s_waitcnt lgkmcnt(6)
  v_mfma_f32_32x32x16_bf16 v[176:191], v[240:243], v[160:163], 0
  ds_read_b64_tr_b16 v[252:253], v222 offset:38912
  ds_read_b64_tr_b16 v[254:255], v222 offset:39936
  ds_read_b128 v[172:175], v1 offset:52224
  ds_read_b64_tr_b16 v[212:213], v7 offset:28672
  ds_read_b64_tr_b16 v[214:215], v7 offset:29184
  v_mfma_f32_32x32x16_bf16 v[144:159], v[196:199], v[28:31], v[144:159]
  s_waitcnt lgkmcnt(8)
  v_mfma_f32_32x32x16_bf16 v[176:191], v[244:247], v[164:167], v[176:191]
  ds_read_b64_tr_b16 v[240:241], v222 offset:40960
  ds_read_b64_tr_b16 v[242:243], v222 offset:41984
  ds_read_b128 v[160:163], v1 offset:53248
  v_add_u32 v6, 32768, v6
  ds_read_b64_tr_b16 v[192:193], v6 offset:49152
  ds_read_b64_tr_b16 v[194:195], v6 offset:49664
  v_mfma_f32_32x32x16_bf16 v[128:143], v[200:203], v[88:91], v[128:143]
  s_waitcnt lgkmcnt(10)
  v_mfma_f32_32x32x16_bf16 v[176:191], v[248:251], v[168:171], v[176:191]
  ds_read_b64_tr_b16 v[244:245], v222 offset:43008
  ds_read_b64_tr_b16 v[246:247], v222 offset:44032
  ds_read_b128 v[164:167], v1 offset:54272
  v_add_u32 v7, 98304, v7
  ds_read_b64_tr_b16 v[196:197], v7 offset:24576
  ds_read_b64_tr_b16 v[198:199], v7 offset:25088
  v_mfma_f32_32x32x16_bf16 v[144:159], v[204:207], v[32:35], v[144:159]
  s_waitcnt lgkmcnt(12)
  v_mfma_f32_32x32x16_bf16 v[176:191], v[252:255], v[172:175], v[176:191]
  ds_read_b64_tr_b16 v[248:249], v222 offset:45056
  ds_read_b64_tr_b16 v[250:251], v222 offset:46080
  ds_read_b128 v[168:171], v1 offset:55296
  s_waitcnt lgkmcnt(10)
  v_mfma_f32_32x32x16_bf16 v[176:191], v[240:243], v[160:163], v[176:191]
  ds_read_b64_tr_b16 v[252:253], v222 offset:47104
  ds_read_b64_tr_b16 v[254:255], v222 offset:48128
  ds_read_b128 v[172:175], v1 offset:56320
  ds_read_b64_tr_b16 v[200:201], v6 offset:53248
  ds_read_b64_tr_b16 v[202:203], v6 offset:53760
  v_mfma_f32_32x32x16_bf16 v[128:143], v[208:211], v[92:95], v[128:143]
  s_waitcnt lgkmcnt(10)
  v_mfma_f32_32x32x16_bf16 v[176:191], v[244:247], v[164:167], v[176:191]
  ds_read_b64_tr_b16 v[204:205], v7 offset:28672
  ds_read_b64_tr_b16 v[206:207], v7 offset:29184
  v_mfma_f32_32x32x16_bf16 v[144:159], v[212:215], v[36:39], v[144:159]
  s_waitcnt lgkmcnt(7)
  v_mfma_f32_32x32x16_bf16 v[176:191], v[248:251], v[168:171], v[176:191]
  v_add_u32 v6, 4294934528, v6
  ds_read_b64_tr_b16 v[208:209], v6 offset:24576
  ds_read_b64_tr_b16 v[210:211], v6 offset:25088
  v_mfma_f32_32x32x16_bf16 v[128:143], v[192:195], v[96:99], v[128:143]
  s_waitcnt lgkmcnt(6)
  v_mfma_f32_32x32x16_bf16 v[176:191], v[252:255], v[172:175], v[176:191]
  v_add_u32 v7, 4294901760, v7
  ds_read_b64_tr_b16 v[212:213], v7 offset:24576
  ds_read_b64_tr_b16 v[214:215], v7 offset:25088
  v_mfma_f32_32x32x16_bf16 v[144:159], v[196:199], v[40:43], v[144:159]
  s_lshl1_add_u32 s49, s42, s37
  s_lshl4_add_u32 s49, s49, s40
  s_lshl_b32 s52, s49, 11
  s_add_u32 s52, s52, 1048576
  s_cmp_ge_u32 s37, 2
  s_cselect_b32 s57, 0x20000000, s52
  s_nop 1
  v_cvt_pk_bf16_f32 v176, v176, v177
  v_cvt_pk_bf16_f32 v177, v178, v179
  v_cvt_pk_bf16_f32 v178, v180, v181
  v_cvt_pk_bf16_f32 v179, v182, s45
  buffer_store_dwordx4 v[176:179], v1, s[32:35], s57 offen offset:0 sc1
  v_cvt_pk_bf16_f32 v180, v183, v184
  v_cvt_pk_bf16_f32 v181, v185, v186
  v_cvt_pk_bf16_f32 v182, v187, v188
  v_cvt_pk_bf16_f32 v183, v189, s45
  buffer_store_dwordx4 v[180:183], v1, s[32:35], s57 offen offset:1024 sc1
  ds_read_b64_tr_b16 v[192:193], v6 offset:28672
  ds_read_b64_tr_b16 v[194:195], v6 offset:29184
  s_waitcnt vmcnt(9)
  s_waitcnt lgkmcnt(6)
  v_mfma_f32_32x32x16_bf16 v[128:143], v[200:203], v[100:103], v[128:143]
  s_barrier
  v_mfma_f32_32x32x16_bf16 v[144:159], v[204:207], v[44:47], v[144:159]
  ds_read_b64_tr_b16 v[196:197], v7 offset:28672
  ds_read_b64_tr_b16 v[198:199], v7 offset:29184
  s_lshl1_add_u32 s99, s40, s39
  s_lshl3_add_u32 s99, s99, s36
  s_lshl_b32 s99, s99, 12
  s_add_u32 s99, s99, 2097152
  s_lshl_b32 s100, s41, 7
  s_add_u32 s100, s100, s99
  v_min_u32 v9, 6, v15
  v_lshlrev_b32 v9, 7, v9
  s_lshl_b32 s83, s92, 13
  ds_read_b64_tr_b16 v[200:201], v6 offset:32768
  ds_read_b64_tr_b16 v[202:203], v6 offset:33280
  s_waitcnt lgkmcnt(6)
  v_mfma_f32_32x32x16_bf16 v[128:143], v[208:211], v[104:107], v[128:143]
  s_add_u32 s83, s83, s50
  v_xor_b32 v220, 64, v2
  v_lshrrev_b32 v11, 3, v15
  v_mul_u32_u24 v11, 768, v11
  v_add_u32 v7, 65536, v7
  ds_read_b64_tr_b16 v[204:205], v7 offset:32768
  ds_read_b64_tr_b16 v[206:207], v7 offset:33280
  v_mfma_f32_32x32x16_bf16 v[144:159], v[212:215], v[48:51], v[144:159]
  v_add_u32 v221, v11, v1
  s_and_b32 s54, s37, 1
  s_lshl1_add_u32 s54, s39, s54
  s_lshl2_add_u32 s55, s40, s54
  ds_read_b64_tr_b16 v[208:209], v6 offset:36864
  ds_read_b64_tr_b16 v[210:211], v6 offset:37376
  s_waitcnt lgkmcnt(6)
  v_mfma_f32_32x32x16_bf16 v[128:143], v[192:195], v[108:111], v[128:143]
  s_mul_i32 s101, s55, 28672
  s_lshl_b32 s56, s41, 7
  s_add_u32 s101, s101, s56
  s_cmp_lg_u32 s54, s37
  s_cselect_b32 s67, 1, 0
  s_add_u32 s56, s67, 2
  ds_read_b64_tr_b16 v[212:213], v7 offset:36864
  ds_read_b64_tr_b16 v[214:215], v7 offset:37376
  v_mfma_f32_32x32x16_bf16 v[144:159], v[196:199], v[52:55], v[144:159]
  s_mul_i32 s56, s56, 7168
  s_add_u32 s101, s101, s56
  s_mul_i32 s51, s55, 147456
  s_add_u32 s51, s51, 8510464
  ds_read_b64_tr_b16 v[192:193], v6 offset:40960
  ds_read_b64_tr_b16 v[194:195], v6 offset:41472
  s_waitcnt lgkmcnt(6)
  v_mfma_f32_32x32x16_bf16 v[128:143], v[200:203], v[112:115], v[128:143]
  s_mul_i32 s56, s40, 7
  s_add_u32 s56, s56, s41
  s_lshl2_add_u32 s82, s56, s54
  s_lshl2_add_u32 s81, s56, s37
  ds_read_b64_tr_b16 v[196:197], v7 offset:40960
  ds_read_b64_tr_b16 v[198:199], v7 offset:41472
  v_mfma_f32_32x32x16_bf16 v[144:159], v[204:207], v[56:59], v[144:159]
  s_add_u32 s58, s54, 4
  s_and_b32 s54, s37, 1
  v_bfe_u32 v228, v15, 3, 2
  v_lshl_add_u32 v228, s54, 2, v228
  ds_read_b64_tr_b16 v[200:201], v6 offset:45056
  ds_read_b64_tr_b16 v[202:203], v6 offset:45568
  s_waitcnt lgkmcnt(6)
  v_mfma_f32_32x32x16_bf16 v[128:143], v[208:211], v[116:119], v[128:143]
  v_lshrrev_b32 v229, 4, v15
  v_and_b32 v229, 2, v229
  s_lshl_b32 s86, s93, 13
  s_add_u32 s86, s86, s50
  s_lshl_b32 s87, s94, 13
  ds_read_b64_tr_b16 v[204:205], v7 offset:45056
  ds_read_b64_tr_b16 v[206:207], v7 offset:45568
  v_mfma_f32_32x32x16_bf16 v[144:159], v[212:215], v[60:63], v[144:159]
  s_add_u32 s87, s87, s50
  s_lshl_b32 s88, s95, 13
  s_add_u32 s88, s88, s50
  s_lshl_b32 s89, s96, 13
  v_add_u32 v7, 4294934528, v7
  ds_read_b64_tr_b16 v[208:209], v7 offset:0
  ds_read_b64_tr_b16 v[210:211], v7 offset:512
  s_waitcnt lgkmcnt(6)
  v_mfma_f32_32x32x16_bf16 v[128:143], v[192:195], v[120:123], v[128:143]
  s_add_u32 s89, s89, s50
  s_lshl_b32 s90, s97, 13
  s_add_u32 s90, s90, s50
  s_lshl_b32 s91, s98, 13
  ds_read_b64_tr_b16 v[212:213], v7 offset:4096
  ds_read_b64_tr_b16 v[214:215], v7 offset:4608
  v_mfma_f32_32x32x16_bf16 v[144:159], v[196:199], v[64:67], v[144:159]
  s_add_u32 s91, s91, s50
  s_mul_i32 s92, s92, 114688
  s_mul_i32 s93, s93, 114688
  s_mul_i32 s94, s94, 114688
  ds_read_b64_tr_b16 v[192:193], v7 offset:8192
  ds_read_b64_tr_b16 v[194:195], v7 offset:8704
  s_waitcnt lgkmcnt(6)
  v_mfma_f32_32x32x16_bf16 v[128:143], v[200:203], v[124:127], v[128:143]
  s_barrier
  v_mfma_f32_32x32x16_bf16 v[144:159], v[204:207], v[68:71], v[144:159]
  ds_read_b64_tr_b16 v[196:197], v7 offset:12288
  ds_read_b64_tr_b16 v[198:199], v7 offset:12800
  s_mul_i32 s95, s95, 114688
  s_mul_i32 s96, s96, 114688
  s_mul_i32 s97, s97, 114688
  s_mul_i32 s98, s98, 114688
  s_waitcnt vmcnt(6)
  buffer_load_dwordx4 v[224:227], v221, s[4:7], s101 offen
  ds_read_b64_tr_b16 v[200:201], v7 offset:16384
  ds_read_b64_tr_b16 v[202:203], v7 offset:16896
  s_waitcnt lgkmcnt(6)
  v_mfma_f32_32x32x16_bf16 v[144:159], v[208:211], v[72:75], v[144:159]
  v_mul_f32 v216, v128, v128
  v_mul_f32 v217, v129, v129
  v_mul_f32 v218, v130, v130
  v_mul_f32 v219, v131, v131
  v_fmamk_f32 v216, v216, 0xbdd2d3e8, v8
  v_fmamk_f32 v217, v217, 0xbdd2d3e8, v8
  v_fmamk_f32 v218, v218, 0xbdd2d3e8, v8
  s_getpc_b64 s[84:85]
L_pc_78:
  s_sub_u32 s84, s84, L_pc_78-parallel_sum__linear_kernel_hedgehog__glu_gated_geglu__prompt_kernel
  s_subb_u32 s85, s85, 0
  s_lshr_b32 s49, s2, 3
  s_lshl2_add_u32 s49, s49, s37
  s_mul_i32 s49, s49, 5
  v_min_u32 v13, 4, v15
  v_add_u32 v13, s49, v13
  v_lshlrev_b32 v13, 7, v13
  v_min_u32 v13, L_code_end-parallel_sum__linear_kernel_hedgehog__glu_gated_geglu__prompt_kernel-4, v13
  global_load_dword v13, v13, s[84:85]
  ds_read_b64_tr_b16 v[204:205], v7 offset:20480
  ds_read_b64_tr_b16 v[206:207], v7 offset:20992
  v_mfma_f32_32x32x16_bf16 v[144:159], v[212:215], v[76:79], v[144:159]
  v_fmamk_f32 v219, v219, 0xbdd2d3e8, v8
  v_mul_f32 v216, v216, v128
  v_mul_f32 v217, v217, v129
  v_mul_f32 v218, v218, v130
  v_mul_f32 v219, v219, v131
  v_exp_f32 v216, v216
  v_add_u32 v7, 32768, v7
  ds_read_b64_tr_b16 v[208:209], v7 offset:49152
  ds_read_b64_tr_b16 v[210:211], v7 offset:49664
  s_waitcnt lgkmcnt(6)
  v_mfma_f32_32x32x16_bf16 v[144:159], v[192:195], v[80:83], v[144:159]
  v_mul_f32 v136, v128, v136
  v_exp_f32 v217, v217
  v_mul_f32 v137, v129, v137
  v_exp_f32 v218, v218
  ds_read_b64_tr_b16 v[212:213], v7 offset:53248
  ds_read_b64_tr_b16 v[214:215], v7 offset:53760
  v_mfma_f32_32x32x16_bf16 v[144:159], v[196:199], v[84:87], v[144:159]
  v_mul_f32 v138, v130, v138
  v_exp_f32 v219, v219
  v_mul_f32 v139, v131, v139
  v_add_f32 v216, 1.0, v216
  v_add_u32 v7, 4294934528, v7
  ds_read_b64_tr_b16 v[192:193], v7 offset:24576
  ds_read_b64_tr_b16 v[194:195], v7 offset:25088
  s_waitcnt lgkmcnt(6)
  v_mfma_f32_32x32x16_bf16 v[144:159], v[200:203], v[88:91], v[144:159]
  v_add_f32 v217, 1.0, v217
  v_add_f32 v218, 1.0, v218
  v_add_f32 v219, 1.0, v219
  v_rcp_f32 v216, v216
  v_rcp_f32 v217, v217
  ds_read_b64_tr_b16 v[196:197], v7 offset:28672
  ds_read_b64_tr_b16 v[198:199], v7 offset:29184
  v_mfma_f32_32x32x16_bf16 v[144:159], v[204:207], v[92:95], v[144:159]
  v_rcp_f32 v218, v218
  v_rcp_f32 v219, v219
  v_mul_f32 v136, v136, v216
  ds_read_b64_tr_b16 v[200:201], v7 offset:32768
  ds_read_b64_tr_b16 v[202:203], v7 offset:33280
  s_waitcnt lgkmcnt(6)
  v_mfma_f32_32x32x16_bf16 v[144:159], v[208:211], v[96:99], v[144:159]
  v_mul_f32 v137, v137, v217
  v_mul_f32 v138, v138, v218
  v_mul_f32 v139, v139, v219
  v_mul_f32 v216, v132, v132
  v_mul_f32 v217, v133, v133
  v_mul_f32 v218, v134, v134
  ds_read_b64_tr_b16 v[204:205], v7 offset:36864
  ds_read_b64_tr_b16 v[206:207], v7 offset:37376
  v_mfma_f32_32x32x16_bf16 v[144:159], v[212:215], v[100:103], v[144:159]
  v_mul_f32 v219, v135, v135
  v_fmamk_f32 v216, v216, 0xbdd2d3e8, v8
  v_fmamk_f32 v217, v217, 0xbdd2d3e8, v8
  v_fmamk_f32 v218, v218, 0xbdd2d3e8, v8
  v_fmamk_f32 v219, v219, 0xbdd2d3e8, v8
  v_mul_f32 v216, v216, v132
  ds_read_b64_tr_b16 v[208:209], v7 offset:40960
  ds_read_b64_tr_b16 v[210:211], v7 offset:41472
  s_waitcnt lgkmcnt(6)
  v_mfma_f32_32x32x16_bf16 v[144:159], v[192:195], v[104:107], v[144:159]
  v_mul_f32 v217, v217, v133
  v_mul_f32 v218, v218, v134
  v_mul_f32 v219, v219, v135
  v_exp_f32 v216, v216
  v_mul_f32 v140, v132, v140
  v_exp_f32 v217, v217
  ds_read_b64_tr_b16 v[212:213], v7 offset:45056
  ds_read_b64_tr_b16 v[214:215], v7 offset:45568
  s_waitcnt vmcnt(4)
  s_waitcnt lgkmcnt(6)
  v_mfma_f32_32x32x16_bf16 v[144:159], v[196:199], v[108:111], v[144:159]
  s_barrier
  v_mfma_f32_32x32x16_bf16 v[144:159], v[200:203], v[112:115], v[144:159]
  ds_read_b64_tr_b16 v[192:193], v6 offset:49152
  ds_read_b64_tr_b16 v[194:195], v6 offset:49664
  v_mul_f32 v141, v133, v141
  v_exp_f32 v218, v218
  v_mul_f32 v142, v134, v142
  v_exp_f32 v219, v219
  v_mul_f32 v143, v135, v143
  v_add_f32 v216, 1.0, v216
  v_add_f32 v217, 1.0, v217
  v_add_f32 v218, 1.0, v218
  v_add_f32 v219, 1.0, v219
  ds_read_b64_tr_b16 v[196:197], v6 offset:53248
  ds_read_b64_tr_b16 v[198:199], v6 offset:53760
  s_waitcnt lgkmcnt(6)
  v_mfma_f32_32x32x16_bf16 v[144:159], v[204:207], v[116:119], v[144:159]
  v_rcp_f32 v216, v216
  v_rcp_f32 v217, v217
  v_rcp_f32 v218, v218
  v_add_u32 v6, 32768, v6
  ds_read_b64_tr_b16 v[200:201], v6 offset:57344
  ds_read_b64_tr_b16 v[202:203], v6 offset:57856
  v_mfma_f32_32x32x16_bf16 v[144:159], v[208:211], v[120:123], v[144:159]
  v_rcp_f32 v219, v219
  v_mul_f32 v140, v140, v216
  v_mul_f32 v141, v141, v217
  v_mul_f32 v142, v142, v218
  v_mul_f32 v143, v143, v219
  ds_read_b64_tr_b16 v[204:205], v6 offset:61440
  ds_read_b64_tr_b16 v[206:207], v6 offset:61952
  s_waitcnt lgkmcnt(6)
  v_mfma_f32_32x32x16_bf16 v[144:159], v[212:215], v[124:127], v[144:159]
  v_cvt_pk_bf16_f32 v240, v136, v137
  v_cvt_pk_bf16_f32 v241, v138, v139
  v_cvt_pk_bf16_f32 v242, v140, v141
  v_cvt_pk_bf16_f32 v243, v142, v143
  s_add_u32 s47, s83, 0
  buffer_store_dwordx4 v[240:243], v1, s[32:35], s47 offen offset:2048 sc1
  v_add_u32 v6, 4294868992, v6
  ds_read_b64_tr_b16 v[208:209], v6 offset:0
  ds_read_b64_tr_b16 v[210:211], v6 offset:512
  v_mfma_f32_32x32x16_bf16 v[160:175], v[192:195], v[16:19], 0
  ds_read_b64_tr_b16 v[212:213], v6 offset:4096
  ds_read_b64_tr_b16 v[214:215], v6 offset:4608
  s_waitcnt lgkmcnt(6)
  v_mfma_f32_32x32x16_bf16 v[160:175], v[196:199], v[20:23], v[160:175]
  v_mul_f32 v216, v144, v144
  v_mul_f32 v217, v145, v145
  v_mul_f32 v218, v146, v146
  v_mul_f32 v219, v147, v147
  v_fmamk_f32 v216, v216, 0xbdd2d3e8, v8
  v_fmamk_f32 v217, v217, 0xbdd2d3e8, v8
  ds_read_b64_tr_b16 v[192:193], v6 offset:8192
  ds_read_b64_tr_b16 v[194:195], v6 offset:8704
  v_mfma_f32_32x32x16_bf16 v[160:175], v[200:203], v[24:27], v[160:175]
  v_fmamk_f32 v218, v218, 0xbdd2d3e8, v8
  v_fmamk_f32 v219, v219, 0xbdd2d3e8, v8
  v_mul_f32 v216, v216, v144
  v_mul_f32 v217, v217, v145
  ds_read_b64_tr_b16 v[196:197], v6 offset:12288
  ds_read_b64_tr_b16 v[198:199], v6 offset:12800
  s_waitcnt lgkmcnt(6)
  v_mfma_f32_32x32x16_bf16 v[160:175], v[204:207], v[28:31], v[160:175]
  v_mul_f32 v218, v218, v146
  v_mul_f32 v219, v219, v147
  v_exp_f32 v216, v216
  v_mul_f32 v152, v144, v152
  ds_read_b64_tr_b16 v[200:201], v6 offset:16384
  ds_read_b64_tr_b16 v[202:203], v6 offset:16896
  v_mfma_f32_32x32x16_bf16 v[160:175], v[208:211], v[32:35], v[160:175]
  v_exp_f32 v217, v217
  v_mul_f32 v153, v145, v153
  v_exp_f32 v218, v218
  v_lshrrev_b32 v11, 3, v15
  v_mul_u32_u24 v11, 896, v11
  v_add_u32 v11, v11, v1
  s_add_u32 s49, s100, 1024
  v_not_b32 v12, s43
  s_bfm_b64 exec, 24, 0
  s_waitcnt vmcnt(1)
  buffer_store_dwordx4 v[12:15], v11, s[32:35], s49 offen sc1
  s_mov_b64 exec, -1
  ds_read_b64_tr_b16 v[204:205], v6 offset:20480
  ds_read_b64_tr_b16 v[206:207], v6 offset:20992
  s_waitcnt lgkmcnt(6)
  v_mfma_f32_32x32x16_bf16 v[160:175], v[212:215], v[36:39], v[160:175]
  s_barrier
  v_mfma_f32_32x32x16_bf16 v[160:175], v[192:195], v[40:43], v[160:175]
  ds_read_b64_tr_b16 v[208:209], v6 offset:24576
  ds_read_b64_tr_b16 v[210:211], v6 offset:25088
  v_mul_f32 v154, v146, v154
  v_exp_f32 v219, v219
  v_mul_f32 v155, v147, v155
  v_mov_b32 v252, -1
  v_mov_b32 v253, -1
  v_mov_b32 v254, -1
  v_mov_b32 v255, -1
  v_add_f32 v216, 1.0, v216
  v_add_f32 v217, 1.0, v217
  v_add_f32 v218, 1.0, v218
  v_add_f32 v219, 1.0, v219
  v_rcp_f32 v216, v216
  s_lshl_b32 s49, s81, 13
  s_add_u32 s49, s49, 4196352
  s_cmp_lg_u32 s67, 0
  s_cselect_b32 s49, s49, 0x20000000
  buffer_store_dwordx4 v[252:255], v1, s[32:35], s49 offen offset:0 sc1
  buffer_store_dwordx4 v[252:255], v1, s[32:35], s49 offen offset:1024 sc1
  ds_read_b64_tr_b16 v[212:213], v6 offset:28672
  ds_read_b64_tr_b16 v[214:215], v6 offset:29184
  s_waitcnt lgkmcnt(6)
  v_mfma_f32_32x32x16_bf16 v[160:175], v[196:199], v[44:47], v[160:175]
  v_rcp_f32 v217, v217
  v_rcp_f32 v218, v218
  ds_read_b64_tr_b16 v[192:193], v6 offset:32768
  ds_read_b64_tr_b16 v[194:195], v6 offset:33280
  v_mfma_f32_32x32x16_bf16 v[160:175], v[200:203], v[48:51], v[160:175]
  v_rcp_f32 v219, v219
  v_mul_f32 v152, v152, v216
  v_mul_f32 v153, v153, v217
  ds_read_b64_tr_b16 v[196:197], v6 offset:36864
  ds_read_b64_tr_b16 v[198:199], v6 offset:37376
  s_waitcnt lgkmcnt(6)
  v_mfma_f32_32x32x16_bf16 v[160:175], v[204:207], v[52:55], v[160:175]
  v_mul_f32 v154, v154, v218
  v_mul_f32 v155, v155, v219
  v_mul_f32 v216, v148, v148
  v_mul_f32 v217, v149, v149
  v_mul_f32 v218, v150, v150
  ds_read_b64_tr_b16 v[200:201], v6 offset:40960
  ds_read_b64_tr_b16 v[202:203], v6 offset:41472
  v_mfma_f32_32x32x16_bf16 v[160:175], v[208:211], v[56:59], v[160:175]
  v_mul_f32 v219, v151, v151
  v_fmamk_f32 v216, v216, 0xbdd2d3e8, v8
  v_fmamk_f32 v217, v217, 0xbdd2d3e8, v8
  v_fmamk_f32 v218, v218, 0xbdd2d3e8, v8
  v_fmamk_f32 v219, v219, 0xbdd2d3e8, v8
  ds_read_b64_tr_b16 v[204:205], v7 offset:49152
  ds_read_b64_tr_b16 v[206:207], v7 offset:49664
  s_waitcnt lgkmcnt(6)
  v_mfma_f32_32x32x16_bf16 v[160:175], v[212:215], v[60:63], v[160:175]
  v_mul_f32 v216, v216, v148
  v_mul_f32 v217, v217, v149
  v_mul_f32 v218, v218, v150
  v_mul_f32 v219, v219, v151
  v_exp_f32 v216, v216
  ds_read_b64_tr_b16 v[208:209], v6 offset:45056
  ds_read_b64_tr_b16 v[210:211], v6 offset:45568
  v_mfma_f32_32x32x16_bf16 v[160:175], v[192:195], v[64:67], v[160:175]
  v_mul_f32 v156, v148, v156
  v_exp_f32 v217, v217
  ds_read_b64_tr_b16 v[212:213], v7 offset:53248
  ds_read_b64_tr_b16 v[214:215], v7 offset:53760
  s_waitcnt lgkmcnt(6)
  v_mfma_f32_32x32x16_bf16 v[160:175], v[196:199], v[68:71], v[160:175]
  v_mul_f32 v157, v149, v157
  v_exp_f32 v218, v218
  v_mul_f32 v158, v150, v158
  v_exp_f32 v219, v219
  ds_read_b64_tr_b16 v[192:193], v6 offset:49152
  ds_read_b64_tr_b16 v[194:195], v6 offset:49664
  v_mfma_f32_32x32x16_bf16 v[160:175], v[200:203], v[72:75], v[160:175]
  v_mul_f32 v159, v151, v159
  v_add_f32 v216, 1.0, v216
  v_add_f32 v217, 1.0, v217
  v_add_f32 v218, 1.0, v218
  v_add_u32 v7, 32768, v7
  ds_read_b64_tr_b16 v[196:197], v7 offset:57344
  ds_read_b64_tr_b16 v[198:199], v7 offset:57856
  s_waitcnt lgkmcnt(6)
  v_mfma_f32_32x32x16_bf16 v[176:191], v[204:207], v[16:19], 0
  v_add_f32 v219, 1.0, v219
  v_rcp_f32 v216, v216
  v_rcp_f32 v217, v217
  ds_read_b64_tr_b16 v[200:201], v6 offset:53248
  ds_read_b64_tr_b16 v[202:203], v6 offset:53760
  v_mfma_f32_32x32x16_bf16 v[160:175], v[208:211], v[76:79], v[160:175]
  v_rcp_f32 v218, v218
  v_rcp_f32 v219, v219
  ds_read_b64_tr_b16 v[204:205], v7 offset:61440
  ds_read_b64_tr_b16 v[206:207], v7 offset:61952
  s_waitcnt lgkmcnt(6)
  v_mfma_f32_32x32x16_bf16 v[176:191], v[212:215], v[20:23], v[176:191]
  s_barrier
  v_mfma_f32_32x32x16_bf16 v[160:175], v[192:195], v[80:83], v[160:175]
  ds_read_b64_tr_b16 v[208:209], v6 offset:57344
  ds_read_b64_tr_b16 v[210:211], v6 offset:57856
  v_mul_f32 v156, v156, v216
  v_mul_f32 v157, v157, v217
  v_mul_f32 v158, v158, v218
  v_mul_f32 v159, v159, v219
  v_cvt_pk_bf16_f32 v244, v152, v153
  v_cvt_pk_bf16_f32 v245, v154, v155
  v_cvt_pk_bf16_f32 v246, v156, v157
  v_cvt_pk_bf16_f32 v247, v158, v159
  s_add_u32 s47, s83, 0
  buffer_store_dwordx4 v[244:247], v1, s[32:35], s47 offen offset:3072 sc1
  v_add_u32 v7, 4294868992, v7
  ds_read_b64_tr_b16 v[212:213], v7 offset:0
  ds_read_b64_tr_b16 v[214:215], v7 offset:512
  s_waitcnt lgkmcnt(6)
  v_mfma_f32_32x32x16_bf16 v[176:191], v[196:199], v[24:27], v[176:191]
  ds_read_b64_tr_b16 v[192:193], v6 offset:61440
  ds_read_b64_tr_b16 v[194:195], v6 offset:61952
  v_mfma_f32_32x32x16_bf16 v[160:175], v[200:203], v[84:87], v[160:175]
  v_add_u32 v222, 0, v228
  v_add_u32 v232, 0, v222
  v_cmp_gt_u32 vcc, 12, v222
  v_and_b32 v222, 12, v222
  v_add_u32 v232, v232, v222
  v_cndmask_b32 v222, 0, v229, vcc
  ds_read_b64_tr_b16 v[196:197], v7 offset:4096
  ds_read_b64_tr_b16 v[198:199], v7 offset:4608
  s_waitcnt lgkmcnt(6)
  v_mfma_f32_32x32x16_bf16 v[176:191], v[204:207], v[28:31], v[176:191]
  v_add_u32 v232, v232, v222
  v_mul_u32_u24 v232, 896, v232
  v_add_u32 v232, v232, v5
  v_add_u32 v6, 98304, v6
  ds_read_b64_tr_b16 v[200:201], v6 offset:24576
  ds_read_b64_tr_b16 v[202:203], v6 offset:25088
  v_mfma_f32_32x32x16_bf16 v[160:175], v[208:211], v[88:91], v[160:175]
  s_lshl_b32 s49, s81, 8
  s_add_u32 s49, s49, 262272
  s_cmp_lg_u32 s67, 0
  s_cselect_b32 s49, s49, 0x20000000
  s_waitcnt vmcnt(1)
  v_mov_b32 v12, s43
  s_mov_b64 exec, 0xff
  buffer_store_dwordx4 v[12:15], v1, s[32:35], s49 offen sc1
  s_mov_b64 exec, -1
  v_add_u32 v222, 8, v228
  v_mul_u32_u24 v233, 74, v222
  ds_read_b64_tr_b16 v[204:205], v7 offset:8192
  ds_read_b64_tr_b16 v[206:207], v7 offset:8704
  s_waitcnt lgkmcnt(6)
  v_mfma_f32_32x32x16_bf16 v[176:191], v[212:215], v[32:35], v[176:191]
  v_lshrrev_b32 v233, 10, v233
  v_mad_i32_i24 v222, v233, -14, v222
  v_mad_u32_u24 v233, v233, 56, v222
  ds_read_b64_tr_b16 v[208:209], v6 offset:28672
  ds_read_b64_tr_b16 v[210:211], v6 offset:29184
  v_mfma_f32_32x32x16_bf16 v[160:175], v[192:195], v[92:95], v[160:175]
  v_cmp_gt_u32 vcc, 12, v222
  v_and_b32 v222, 12, v222
  v_add_u32 v233, v233, v222
  v_cndmask_b32 v222, 0, v229, vcc
  v_add_u32 v233, v233, v222
  ds_read_b64_tr_b16 v[212:213], v7 offset:12288
  ds_read_b64_tr_b16 v[214:215], v7 offset:12800
  s_waitcnt lgkmcnt(6)
  v_mfma_f32_32x32x16_bf16 v[176:191], v[196:199], v[36:39], v[176:191]
  s_barrier
  v_mfma_f32_32x32x16_bf16 v[160:175], v[200:203], v[96:99], v[160:175]
  ds_read_b64_tr_b16 v[192:193], v6 offset:32768
  ds_read_b64_tr_b16 v[194:195], v6 offset:33280
  v_mul_u32_u24 v233, 896, v233
  v_add_u32 v233, v233, v5
  v_add_u32 v222, 16, v228
  v_subrev_u32 v222, 14, v222
  v_add_u32 v234, 56, v222
  ds_read_b64_tr_b16 v[196:197], v7 offset:16384
  ds_read_b64_tr_b16 v[198:199], v7 offset:16896
  s_waitcnt lgkmcnt(6)
  v_mfma_f32_32x32x16_bf16 v[176:191], v[204:207], v[40:43], v[176:191]
  v_cmp_gt_u32 vcc, 12, v222
  v_and_b32 v222, 12, v222
  v_add_u32 v234, v234, v222
  v_cndmask_b32 v222, 0, v229, vcc
  v_add_u32 v234, v234, v222
  v_mul_u32_u24 v234, 896, v234
  ds_read_b64_tr_b16 v[200:201], v6 offset:36864
  ds_read_b64_tr_b16 v[202:203], v6 offset:37376
  v_mfma_f32_32x32x16_bf16 v[160:175], v[208:211], v[100:103], v[160:175]
  v_add_u32 v234, v234, v5
  v_add_u32 v222, 24, v228
  v_mul_u32_u24 v235, 74, v222
  ds_read_b64_tr_b16 v[204:205], v7 offset:20480
  ds_read_b64_tr_b16 v[206:207], v7 offset:20992
  s_waitcnt lgkmcnt(6)
  v_mfma_f32_32x32x16_bf16 v[176:191], v[212:215], v[44:47], v[176:191]
  v_lshrrev_b32 v235, 10, v235
  v_mad_i32_i24 v222, v235, -14, v222
  v_add_u32 v6, 4294934528, v6
  ds_read_b64_tr_b16 v[208:209], v6 offset:0
  ds_read_b64_tr_b16 v[210:211], v6 offset:512
  v_mfma_f32_32x32x16_bf16 v[160:175], v[192:195], v[104:107], v[160:175]
  v_mad_u32_u24 v235, v235, 56, v222
  v_cmp_gt_u32 vcc, 12, v222
  v_and_b32 v222, 12, v222
  v_add_u32 v235, v235, v222
  v_cndmask_b32 v222, 0, v229, vcc
  v_add_u32 v235, v235, v222
  ds_read_b64_tr_b16 v[212:213], v7 offset:24576
  ds_read_b64_tr_b16 v[214:215], v7 offset:25088
  s_waitcnt lgkmcnt(6)
  v_mfma_f32_32x32x16_bf16 v[176:191], v[196:199], v[48:51], v[176:191]
  v_mul_u32_u24 v235, 896, v235
  v_add_u32 v235, v235, v5
  ds_read_b64_tr_b16 v[192:193], v6 offset:4096
  ds_read_b64_tr_b16 v[194:195], v6 offset:4608
  v_mfma_f32_32x32x16_bf16 v[160:175], v[200:203], v[108:111], v[160:175]
  v_add_u32 v222, 32, v228
  v_subrev_u32 v222, 28, v222
  v_add_u32 v236, 112, v222
  ds_read_b64_tr_b16 v[196:197], v7 offset:28672
  ds_read_b64_tr_b16 v[198:199], v7 offset:29184
  s_waitcnt lgkmcnt(6)
  v_mfma_f32_32x32x16_bf16 v[176:191], v[204:207], v[52:55], v[176:191]
  s_barrier
  v_mfma_f32_32x32x16_bf16 v[160:175], v[208:211], v[112:115], v[160:175]
  ds_read_b64_tr_b16 v[200:201], v6 offset:8192
  ds_read_b64_tr_b16 v[202:203], v6 offset:8704
  v_cmp_gt_u32 vcc, 12, v222
  v_and_b32 v222, 12, v222
  v_add_u32 v236, v236, v222
  v_cndmask_b32 v222, 0, v229, vcc
  v_add_u32 v236, v236, v222
  v_mul_u32_u24 v236, 896, v236
  v_add_u32 v236, v236, v5
  v_add_u32 v222, 40, v228
  ds_read_b64_tr_b16 v[204:205], v7 offset:32768
  ds_read_b64_tr_b16 v[206:207], v7 offset:33280
  s_waitcnt lgkmcnt(6)
  v_mfma_f32_32x32x16_bf16 v[176:191], v[212:215], v[56:59], v[176:191]
  v_mul_u32_u24 v237, 74, v222
  v_lshrrev_b32 v237, 10, v237
  v_mad_i32_i24 v222, v237, -14, v222
  ds_read_b64_tr_b16 v[208:209], v6 offset:12288
  ds_read_b64_tr_b16 v[210:211], v6 offset:12800
  v_mfma_f32_32x32x16_bf16 v[160:175], v[192:195], v[116:119], v[160:175]
  v_mad_u32_u24 v237, v237, 56, v222
  v_cmp_gt_u32 vcc, 12, v222
  v_and_b32 v222, 12, v222
  v_add_u32 v237, v237, v222
  v_cndmask_b32 v222, 0, v229, vcc
  v_min_u32 v11, 15, v15
  v_lshlrev_b32 v11, 7, v11
  s_add_u32 s49, s83, 2048
  s_waitcnt vmcnt(1)
  s_add_u32 s47, s100, 1024
  v_mov_b32 v12, s43
  s_mov_b64 exec, 0xff
  buffer_store_dwordx4 v[12:15], v1, s[32:35], s47 offen sc1
  s_mov_b64 exec, -1
  buffer_load_dword v231, v11, s[32:35], s49 offen sc1
  ds_read_b64_tr_b16 v[212:213], v7 offset:36864
  ds_read_b64_tr_b16 v[214:215], v7 offset:37376
  s_waitcnt lgkmcnt(6)
  v_mfma_f32_32x32x16_bf16 v[176:191], v[196:199], v[60:63], v[176:191]
  v_add_u32 v237, v237, v222
  v_mul_u32_u24 v237, 896, v237
  v_add_u32 v237, v237, v5
  ds_read_b64_tr_b16 v[192:193], v7 offset:40960
  ds_read_b64_tr_b16 v[194:195], v7 offset:41472
  v_mfma_f32_32x32x16_bf16 v[160:175], v[200:203], v[120:123], v[160:175]
  v_add_u32 v222, 48, v228
  v_subrev_u32 v222, 42, v222
  ds_read_b64_tr_b16 v[196:197], v7 offset:45056
  ds_read_b64_tr_b16 v[198:199], v7 offset:45568
  s_waitcnt lgkmcnt(6)
  v_mfma_f32_32x32x16_bf16 v[176:191], v[204:207], v[64:67], v[176:191]
  v_add_u32 v238, 168, v222
  v_cmp_gt_u32 vcc, 12, v222
  v_and_b32 v222, 12, v222
  v_add_u32 v238, v238, v222
  v_cndmask_b32 v222, 0, v229, vcc
  v_add_u32 v238, v238, v222
  ds_read_b64_tr_b16 v[200:201], v7 offset:49152
  ds_read_b64_tr_b16 v[202:203], v7 offset:49664
  v_mfma_f32_32x32x16_bf16 v[160:175], v[208:211], v[124:127], v[160:175]
  v_mul_u32_u24 v238, 896, v238
  v_add_u32 v238, v238, v5
  ds_read_b64_tr_b16 v[204:205], v7 offset:53248
  ds_read_b64_tr_b16 v[206:207], v7 offset:53760
  s_waitcnt lgkmcnt(6)
  v_mfma_f32_32x32x16_bf16 v[176:191], v[212:215], v[68:71], v[176:191]
  s_barrier
  v_mfma_f32_32x32x16_bf16 v[176:191], v[192:195], v[72:75], v[176:191]
  ds_read_b64_tr_b16 v[208:209], v7 offset:57344
  ds_read_b64_tr_b16 v[210:211], v7 offset:57856
  s_nop 1
  v_mul_f32 v216, v160, v160
  v_mul_f32 v217, v161, v161
  v_mul_f32 v218, v162, v162
  v_mul_f32 v219, v163, v163
  v_fmamk_f32 v216, v216, 0xbdd2d3e8, v8
  v_fmamk_f32 v217, v217, 0xbdd2d3e8, v8
  v_fmamk_f32 v218, v218, 0xbdd2d3e8, v8
  v_fmamk_f32 v219, v219, 0xbdd2d3e8, v8
  ds_read_b64_tr_b16 v[212:213], v7 offset:61440
  ds_read_b64_tr_b16 v[214:215], v7 offset:61952
  s_waitcnt lgkmcnt(6)
  v_mfma_f32_32x32x16_bf16 v[176:191], v[196:199], v[76:79], v[176:191]
  v_mul_f32 v216, v216, v160
  v_mul_f32 v217, v217, v161
  v_mul_f32 v218, v218, v162
  v_mul_f32 v219, v219, v163
  v_exp_f32 v216, v216
  v_mul_f32 v168, v160, v168
  v_add_u32 v7, 98304, v7
  ds_read_b64_tr_b16 v[192:193], v7 offset:24576
  ds_read_b64_tr_b16 v[194:195], v7 offset:25088
  v_mfma_f32_32x32x16_bf16 v[176:191], v[200:203], v[80:83], v[176:191]
  v_exp_f32 v217, v217
  v_mul_f32 v169, v161, v169
  v_exp_f32 v218, v218
  v_mul_f32 v170, v162, v170
  v_exp_f32 v219, v219
  ds_read_b64_tr_b16 v[196:197], v7 offset:28672
  ds_read_b64_tr_b16 v[198:199], v7 offset:29184
  s_waitcnt lgkmcnt(6)
  v_mfma_f32_32x32x16_bf16 v[176:191], v[204:207], v[84:87], v[176:191]
  v_mul_f32 v171, v163, v171
  v_add_f32 v216, 1.0, v216
  v_add_f32 v217, 1.0, v217
  v_add_f32 v218, 1.0, v218
  v_add_f32 v219, 1.0, v219
  v_rcp_f32 v216, v216
  ds_read_b64_tr_b16 v[200:201], v7 offset:32768
  ds_read_b64_tr_b16 v[202:203], v7 offset:33280
  v_mfma_f32_32x32x16_bf16 v[176:191], v[208:211], v[88:91], v[176:191]
  v_rcp_f32 v217, v217
  v_rcp_f32 v218, v218
  v_rcp_f32 v219, v219
  ds_read_b64_tr_b16 v[204:205], v7 offset:36864
  ds_read_b64_tr_b16 v[206:207], v7 offset:37376
  s_waitcnt lgkmcnt(6)
  v_mfma_f32_32x32x16_bf16 v[176:191], v[212:215], v[92:95], v[176:191]
  s_barrier
  v_mfma_f32_32x32x16_bf16 v[176:191], v[192:195], v[96:99], v[176:191]
  v_add_u32 v7, 4294934528, v7
  ds_read_b64_tr_b16 v[208:209], v7 offset:0
  ds_read_b64_tr_b16 v[210:211], v7 offset:512
  v_mul_f32 v168, v168, v216
  v_mul_f32 v169, v169, v217
  v_mul_f32 v170, v170, v218
  v_mul_f32 v171, v171, v219
  v_mul_f32 v216, v164, v164
  v_mul_f32 v217, v165, v165
  v_mul_f32 v218, v166, v166
  v_mul_f32 v219, v167, v167
  v_fmamk_f32 v216, v216, 0xbdd2d3e8, v8
  v_fmamk_f32 v217, v217, 0xbdd2d3e8, v8
  v_fmamk_f32 v218, v218, 0xbdd2d3e8, v8
  v_fmamk_f32 v219, v219, 0xbdd2d3e8, v8
  v_mul_f32 v216, v216, v164
  v_mul_f32 v217, v217, v165
  ds_read_b64_tr_b16 v[212:213], v7 offset:4096
  ds_read_b64_tr_b16 v[214:215], v7 offset:4608
  s_waitcnt lgkmcnt(6)
  v_mfma_f32_32x32x16_bf16 v[176:191], v[196:199], v[100:103], v[176:191]
  v_mul_f32 v218, v218, v166
  v_mul_f32 v219, v219, v167
  v_exp_f32 v216, v216
  v_mul_f32 v172, v164, v172
  v_exp_f32 v217, v217
  ds_read_b64_tr_b16 v[192:193], v7 offset:8192
  ds_read_b64_tr_b16 v[194:195], v7 offset:8704
  v_mfma_f32_32x32x16_bf16 v[176:191], v[200:203], v[104:107], v[176:191]
  v_mul_f32 v173, v165, v173
  v_exp_f32 v218, v218
  v_mul_f32 v174, v166, v174
  v_exp_f32 v219, v219
  v_mul_f32 v175, v167, v175
  ds_read_b64_tr_b16 v[196:197], v7 offset:12288
  ds_read_b64_tr_b16 v[198:199], v7 offset:12800
  s_waitcnt lgkmcnt(6)
  v_mfma_f32_32x32x16_bf16 v[176:191], v[204:207], v[108:111], v[176:191]
  v_add_f32 v216, 1.0, v216
  v_add_f32 v217, 1.0, v217
  v_add_f32 v218, 1.0, v218
  v_add_f32 v219, 1.0, v219
  v_rcp_f32 v216, v216
  v_rcp_f32 v217, v217
  v_mfma_f32_32x32x16_bf16 v[176:191], v[208:211], v[112:115], v[176:191]
  v_rcp_f32 v218, v218
  v_rcp_f32 v219, v219
  v_mul_f32 v172, v172, v216
  v_mul_f32 v173, v173, v217
  s_waitcnt lgkmcnt(2)
  v_mfma_f32_32x32x16_bf16 v[176:191], v[212:215], v[116:119], v[176:191]
  v_mul_f32 v174, v174, v218
  v_mul_f32 v175, v175, v219
  v_cvt_pk_bf16_f32 v248, v168, v169
  v_cvt_pk_bf16_f32 v249, v170, v171
  v_cvt_pk_bf16_f32 v250, v172, v173
  v_cvt_pk_bf16_f32 v251, v174, v175
  s_add_u32 s47, s83, 4096
  buffer_store_dwordx4 v[248:251], v1, s[32:35], s47 offen offset:2048 sc1
  v_mfma_f32_32x32x16_bf16 v[176:191], v[192:195], v[120:123], v[176:191]
  s_waitcnt lgkmcnt(0)
  v_mfma_f32_32x32x16_bf16 v[176:191], v[196:199], v[124:127], v[176:191]
  s_add_u32 s80, s99, 1024
  buffer_load_dword v10, v9, s[32:35], s80 offen sc1
  s_barrier
  s_nop 8
  v_mul_f32 v216, v176, v176
  v_mul_f32 v217, v177, v177
  v_mul_f32 v218, v178, v178
  v_mul_f32 v219, v179, v179
  v_fmamk_f32 v216, v216, 0xbdd2d3e8, v8
  s_add_u32 m0, s38, 126976
  s_mov_b32 s46, 200704
  buffer_load_dwordx4 v234, s[16:19], s46 offen lds
  v_fmamk_f32 v217, v217, 0xbdd2d3e8, v8
  v_fmamk_f32 v218, v218, 0xbdd2d3e8, v8
  v_fmamk_f32 v219, v219, 0xbdd2d3e8, v8
  v_mul_f32 v216, v216, v176
  v_mul_f32 v217, v217, v177
  v_mul_f32 v218, v218, v178
  v_mul_f32 v219, v219, v179
  v_exp_f32 v216, v216
  v_mul_f32 v184, v176, v184
  v_exp_f32 v217, v217
  v_mul_f32 v185, v177, v185
  v_exp_f32 v218, v218
  v_mul_f32 v186, v178, v186
  s_add_u32 m0, s38, 135168
  s_mov_b32 s46, 200704
  buffer_load_dwordx4 v235, s[16:19], s46 offen lds
  v_exp_f32 v219, v219
  v_mul_f32 v187, v179, v187
  v_add_f32 v216, 1.0, v216
  v_add_f32 v217, 1.0, v217
  v_add_f32 v218, 1.0, v218
  v_add_f32 v219, 1.0, v219
  v_rcp_f32 v216, v216
  v_rcp_f32 v217, v217
  v_rcp_f32 v218, v218
  v_rcp_f32 v219, v219
  v_mul_f32 v184, v184, v216
  v_mul_f32 v185, v185, v217
  v_mul_f32 v186, v186, v218
  s_add_u32 m0, s38, 69632
  s_mov_b32 s46, 200704
  buffer_load_dwordx4 v236, s[16:19], s46 offen lds
  v_mul_f32 v187, v187, v219
  v_mul_f32 v216, v180, v180
  v_mul_f32 v217, v181, v181
  v_mul_f32 v218, v182, v182
  v_mul_f32 v219, v183, v183
  v_fmamk_f32 v216, v216, 0xbdd2d3e8, v8
  v_fmamk_f32 v217, v217, 0xbdd2d3e8, v8
  v_fmamk_f32 v218, v218, 0xbdd2d3e8, v8
  v_fmamk_f32 v219, v219, 0xbdd2d3e8, v8
  v_mul_f32 v216, v216, v180
  v_mul_f32 v217, v217, v181
  v_mul_f32 v218, v218, v182
  v_mul_f32 v219, v219, v183
  s_add_u32 m0, s38, 77824
  s_mov_b32 s46, 200704
  buffer_load_dwordx4 v237, s[16:19], s46 offen lds
  v_exp_f32 v216, v216
  v_mul_f32 v188, v180, v188
  v_exp_f32 v217, v217
  v_mul_f32 v189, v181, v189
  v_exp_f32 v218, v218
  v_mul_f32 v190, v182, v190
  v_exp_f32 v219, v219
  v_mul_f32 v191, v183, v191
  v_add_f32 v216, 1.0, v216
  v_add_f32 v217, 1.0, v217
  v_add_f32 v218, 1.0, v218
  v_add_f32 v219, 1.0, v219
  v_rcp_f32 v216, v216
  v_rcp_f32 v217, v217
  v_rcp_f32 v218, v218
  v_rcp_f32 v219, v219
  s_waitcnt vmcnt(5)
  s_add_u32 s47, s100, 2048
  v_mov_b32 v12, s43
  s_mov_b64 exec, 0xff
  buffer_store_dwordx4 v[12:15], v1, s[32:35], s47 offen sc1
  s_mov_b64 exec, -1
  v_mul_f32 v188, v188, v216
  v_mul_f32 v189, v189, v217
  v_mul_f32 v190, v190, v218
  v_mul_f32 v191, v191, v219
  v_cvt_pk_bf16_f32 v252, v184, v185
  v_cvt_pk_bf16_f32 v253, v186, v187
  v_cvt_pk_bf16_f32 v254, v188, v189
  v_cvt_pk_bf16_f32 v255, v190, v191
  s_add_u32 s47, s83, 4096
  buffer_store_dwordx4 v[252:255], v1, s[32:35], s47 offen offset:3072 sc1
  s_waitcnt vmcnt(6)
  v_cmp_ne_u32 vcc, s43, v10
  s_nop 1
  s_cbranch_vccnz L_slow_80
L_ok_79:
  buffer_load_dwordx4 v[16:19], v1, s[32:35], s86 offen offset:2048 sc1
  buffer_load_dwordx4 v[20:23], v1, s[32:35], s87 offen offset:2048 sc1
  buffer_load_dwordx4 v[24:27], v1, s[32:35], s88 offen offset:2048 sc1
  buffer_load_dwordx4 v[28:31], v1, s[32:35], s89 offen offset:2048 sc1
  s_cmp_lg_u32 s67, 0
  s_cbranch_scc1 L_snd_82
  v_add_u32 v2, 65536, v2
  ds_read_b64_tr_b16 v[192:193], v2 offset:20480
  ds_read_b64_tr_b16 v[194:195], v2 offset:21504
  v_add_u32 v220, 65536, v220
  ds_read_b64_tr_b16 v[196:197], v220 offset:20480
  ds_read_b64_tr_b16 v[198:199], v220 offset:21504
  ds_read_b64_tr_b16 v[200:201], v2 offset:22528
  ds_read_b64_tr_b16 v[202:203], v2 offset:23552
  ds_read_b64_tr_b16 v[204:205], v220 offset:22528
  ds_read_b64_tr_b16 v[206:207], v220 offset:23552
  v_add_u32 v2, 4294901760, v2
  ds_read_b64_tr_b16 v[208:209], v2 offset:4096
  ds_read_b64_tr_b16 v[210:211], v2 offset:5120
  s_waitcnt lgkmcnt(6)
  v_mfma_f32_32x32x16_bf16 v[128:143], v[192:195], v[240:243], 0
  v_add_u32 v220, 4294901760, v220
  ds_read_b64_tr_b16 v[212:213], v220 offset:4096
  ds_read_b64_tr_b16 v[214:215], v220 offset:5120
  v_mfma_f32_32x32x16_bf16 v[144:159], v[196:199], v[240:243], 0
  ds_read_b64_tr_b16 v[192:193], v2 offset:6144
  ds_read_b64_tr_b16 v[194:195], v2 offset:7168
  s_waitcnt lgkmcnt(6)
  v_mfma_f32_32x32x16_bf16 v[128:143], v[200:203], v[244:247], v[128:143]
  ds_read_b64_tr_b16 v[196:197], v220 offset:6144
  ds_read_b64_tr_b16 v[198:199], v220 offset:7168
  v_mfma_f32_32x32x16_bf16 v[144:159], v[204:207], v[244:247], v[144:159]
  v_add_u32 v2, 65536, v2
  ds_read_b64_tr_b16 v[200:201], v2 offset:28672
  ds_read_b64_tr_b16 v[202:203], v2 offset:29696
  s_waitcnt lgkmcnt(6)
  v_mfma_f32_32x32x16_bf16 v[128:143], v[208:211], v[248:251], v[128:143]
  v_add_u32 v220, 65536, v220
  ds_read_b64_tr_b16 v[204:205], v220 offset:28672
  ds_read_b64_tr_b16 v[206:207], v220 offset:29696
  v_mfma_f32_32x32x16_bf16 v[144:159], v[212:215], v[248:251], v[144:159]
  v_add_u32 v2, 32768, v2
  ds_read_b64_tr_b16 v[208:209], v2 offset:45056
  ds_read_b64_tr_b16 v[210:211], v2 offset:46080
  s_waitcnt lgkmcnt(6)
  v_mfma_f32_32x32x16_bf16 v[128:143], v[192:195], v[252:255], v[128:143]
  v_min_u32 v222, 1, v15
  v_lshlrev_b32 v222, 7, v222
  s_lshl_b32 s56, s82, 8
  s_add_u32 s56, s56, 262144
  buffer_load_dword v223, v222, s[32:35], s56 offen sc1
  v_add_u32 v220, 32768, v220
  ds_read_b64_tr_b16 v[212:213], v220 offset:45056
  ds_read_b64_tr_b16 v[214:215], v220 offset:46080
  v_mfma_f32_32x32x16_bf16 v[144:159], v[196:199], v[252:255], v[144:159]
  s_waitcnt vmcnt(5)
  s_add_u32 s47, s100, 3072
  v_mov_b32 v12, s43
  s_mov_b64 exec, 0xff
  buffer_store_dwordx4 v[12:15], v1, s[32:35], s47 offen sc1
  s_mov_b64 exec, -1
  ds_read_b64_tr_b16 v[192:193], v2 offset:53248
  ds_read_b64_tr_b16 v[194:195], v2 offset:54272
  s_waitcnt lgkmcnt(6)
  s_waitcnt vmcnt(5)
  v_mfma_f32_32x32x16_bf16 v[128:143], v[200:203], v[16:19], v[128:143]
  buffer_load_dwordx4 v[32:35], v1, s[32:35], s90 offen offset:2048 sc1
  ds_read_b64_tr_b16 v[196:197], v220 offset:53248
  ds_read_b64_tr_b16 v[198:199], v220 offset:54272
  v_mfma_f32_32x32x16_bf16 v[144:159], v[204:207], v[16:19], v[144:159]
  ds_read_b64_tr_b16 v[200:201], v2 offset:4096
  ds_read_b64_tr_b16 v[202:203], v2 offset:5120
  s_waitcnt lgkmcnt(6)
  s_waitcnt vmcnt(5)
  v_mfma_f32_32x32x16_bf16 v[128:143], v[208:211], v[20:23], v[128:143]
  buffer_load_dwordx4 v[36:39], v1, s[32:35], s91 offen offset:2048 sc1
  v_and_b32 v11, 7, v15
  v_lshrrev_b32 v12, 4, v15
  ds_read_b64_tr_b16 v[204:205], v220 offset:4096
  ds_read_b64_tr_b16 v[206:207], v220 offset:5120
  v_mfma_f32_32x32x16_bf16 v[144:159], v[212:215], v[20:23], v[144:159]
  v_and_b32 v12, 2, v12
  ds_read_b64_tr_b16 v[208:209], v2 offset:12288
  ds_read_b64_tr_b16 v[210:211], v2 offset:13312
  s_waitcnt lgkmcnt(6)
  s_waitcnt vmcnt(5)
  v_mfma_f32_32x32x16_bf16 v[128:143], v[192:195], v[24:27], v[128:143]
  buffer_load_dwordx4 v[40:43], v1, s[32:35], s86 offen offset:3072 sc1
  v_xor_b32 v12, v12, v11
  ds_read_b64_tr_b16 v[212:213], v220 offset:12288
  ds_read_b64_tr_b16 v[214:215], v220 offset:13312
  v_mfma_f32_32x32x16_bf16 v[144:159], v[196:199], v[24:27], v[144:159]
  v_and_b32 v13, 31, v15
  v_lshlrev_b32 v13, 7, v13
  ds_read_b64_tr_b16 v[192:193], v2 offset:20480
  ds_read_b64_tr_b16 v[194:195], v2 offset:21504
  s_waitcnt lgkmcnt(6)
  s_waitcnt vmcnt(5)
  v_mfma_f32_32x32x16_bf16 v[128:143], v[200:203], v[28:31], v[128:143]
  buffer_load_dwordx4 v[44:47], v1, s[32:35], s87 offen offset:3072 sc1
  v_lshl_add_u32 v12, v12, 4, v13
  ds_read_b64_tr_b16 v[196:197], v220 offset:20480
  ds_read_b64_tr_b16 v[198:199], v220 offset:21504
  v_mfma_f32_32x32x16_bf16 v[144:159], v[204:207], v[28:31], v[144:159]
  s_bitcmp1_b32 s37, 0
  s_cselect_b32 s54, 17, 0
  s_cselect_b32 s49, 18, 11
  s_cselect_b32 s52, 13, 12
  v_add_u32 v2, 4294934528, v2
  ds_read_b64_tr_b16 v[200:201], v2 offset:30720
  ds_read_b64_tr_b16 v[202:203], v2 offset:31744
  s_waitcnt lgkmcnt(6)
  s_waitcnt vmcnt(3)
  v_mfma_f32_32x32x16_bf16 v[128:143], v[208:211], v[32:35], v[128:143]
  buffer_load_dwordx4 v[48:51], v1, s[32:35], s88 offen offset:3072 sc1
  v_cmp_ne_u32 vcc, s43, v223
  s_nop 1
  s_cbranch_vccnz L_slow_84
L_ok_83:
  v_lshl_add_u32 v240, s49, 13, v12
  v_add_u32 v220, 4294934528, v220
  ds_read_b64_tr_b16 v[204:205], v220 offset:30720
  ds_read_b64_tr_b16 v[206:207], v220 offset:31744
  v_mfma_f32_32x32x16_bf16 v[144:159], v[212:215], v[32:35], v[144:159]
  v_xor_b32 v241, 16, v240
  v_xor_b32 v242, 64, v240
  v_add_u32 v2, 32768, v2
  ds_read_b64_tr_b16 v[208:209], v2 offset:47104
  ds_read_b64_tr_b16 v[210:211], v2 offset:48128
  s_waitcnt lgkmcnt(6)
  s_waitcnt vmcnt(3)
  v_mfma_f32_32x32x16_bf16 v[128:143], v[192:195], v[36:39], v[128:143]
  s_add_u32 s80, s99, 2048
  buffer_load_dword v10, v9, s[32:35], s80 offen sc1
  buffer_load_dwordx4 v[52:55], v1, s[32:35], s89 offen offset:3072 sc1
  v_xor_b32 v243, 80, v240
  v_add_u32 v220, 32768, v220
  ds_read_b64_tr_b16 v[212:213], v220 offset:47104
  ds_read_b64_tr_b16 v[214:215], v220 offset:48128
  v_mfma_f32_32x32x16_bf16 v[144:159], v[196:199], v[36:39], v[144:159]
  v_lshrrev_b32 v12, 3, v15
  ds_read_b64_tr_b16 v[192:193], v2 offset:55296
  ds_read_b64_tr_b16 v[194:195], v2 offset:56320
  s_waitcnt lgkmcnt(6)
  s_waitcnt vmcnt(4)
  v_mfma_f32_32x32x16_bf16 v[128:143], v[200:203], v[40:43], v[128:143]
  buffer_load_dwordx4 v[56:59], v1, s[32:35], s90 offen offset:3072 sc1
  v_lshlrev_b32 v13, 4, v12
  ds_read_b64_tr_b16 v[196:197], v220 offset:55296
  ds_read_b64_tr_b16 v[198:199], v220 offset:56320
  s_waitcnt vmcnt(4) lgkmcnt(6)
  v_mfma_f32_32x32x16_bf16 v[144:159], v[204:207], v[40:43], v[144:159]
  s_barrier
  v_mfma_f32_32x32x16_bf16 v[128:143], v[208:211], v[44:47], v[128:143]
  ds_read_b64_tr_b16 v[200:201], v2 offset:6144
  ds_read_b64_tr_b16 v[202:203], v2 offset:7168
  v_xor_b32 v13, v13, v1
  v_lshl_add_u32 v244, s54, 13, v13
  buffer_load_dwordx4 v[60:63], v1, s[32:35], s91 offen offset:3072 sc1
  v_lshl_add_u32 v245, s49, 13, v13
  ds_read_b64_tr_b16 v[204:205], v220 offset:6144
  ds_read_b64_tr_b16 v[206:207], v220 offset:7168
  s_waitcnt lgkmcnt(6)
  v_mfma_f32_32x32x16_bf16 v[144:159], v[212:215], v[44:47], v[144:159]
  s_add_u32 m0, s38, 86016
  s_mov_b32 s46, 200704
  buffer_load_dwordx4 v238, s[16:19], s46 offen lds
  v_and_b32 v13, 2, v15
  ds_read_b64_tr_b16 v[208:209], v2 offset:14336
  ds_read_b64_tr_b16 v[210:211], v2 offset:15360
  s_waitcnt vmcnt(5)
  v_mfma_f32_32x32x16_bf16 v[128:143], v[192:195], v[48:51], v[128:143]
  s_waitcnt vmcnt(4)
  v_cmp_ne_u32 vcc, s43, v10
  s_nop 1
  s_cbranch_vccnz L_slow_87
L_ok_86:
  v_add_u32 v3, 4096, v1
  buffer_load_dwordx4 v[64:67], v3, s[32:35], s86 offen offset:2048 sc1
  v_lshlrev_b32 v13, 1, v13
  ds_read_b64_tr_b16 v[212:213], v220 offset:14336
  ds_read_b64_tr_b16 v[214:215], v220 offset:15360
  s_waitcnt lgkmcnt(6)
  v_mfma_f32_32x32x16_bf16 v[144:159], v[196:199], v[48:51], v[144:159]
  v_xor_b32 v13, v13, v12
  v_lshlrev_b32 v13, 4, v13
  ds_read_b64_tr_b16 v[192:193], v2 offset:22528
  ds_read_b64_tr_b16 v[194:195], v2 offset:23552
  s_waitcnt vmcnt(4)
  v_mfma_f32_32x32x16_bf16 v[128:143], v[200:203], v[52:55], v[128:143]
  buffer_load_dwordx4 v[68:71], v3, s[32:35], s87 offen offset:2048 sc1
  v_lshl_add_u32 v13, v11, 7, v13
  ds_read_b64_tr_b16 v[196:197], v220 offset:22528
  ds_read_b64_tr_b16 v[198:199], v220 offset:23552
  s_waitcnt lgkmcnt(6)
  v_mfma_f32_32x32x16_bf16 v[144:159], v[204:207], v[52:55], v[144:159]
  s_lshl_b32 s52, s52, 13
  ds_read_b64_tr_b16 v[200:201], v2 offset:61440
  ds_read_b64_tr_b16 v[202:203], v2 offset:62464
  s_waitcnt vmcnt(4)
  v_mfma_f32_32x32x16_bf16 v[128:143], v[208:211], v[56:59], v[128:143]
  buffer_load_dwordx4 v[72:75], v3, s[32:35], s88 offen offset:2048 sc1
  s_lshl1_add_u32 s57, s40, 0
  s_lshl3_add_u32 s57, s57, s58
  s_lshl_b32 s57, s57, 12
  s_add_u32 s57, s57, 2097152
  v_mov_b32 v222, 896
  buffer_load_dword v223, v222, s[32:35], s57 offen sc1
  s_add_u32 s3, s51, 4096
  s_add_u32 s52, s52, 4096
  v_add_u32 v247, s52, v13
  ds_read_b64_tr_b16 v[204:205], v220 offset:61440
  ds_read_b64_tr_b16 v[206:207], v220 offset:62464
  s_waitcnt lgkmcnt(6)
  v_mfma_f32_32x32x16_bf16 v[144:159], v[212:215], v[56:59], v[144:159]
  v_bfe_u32 v13, v15, 4, 1
  v_add_u32 v2, 4294868992, v2
  ds_read_b64_tr_b16 v[208:209], v2 offset:12288
  ds_read_b64_tr_b16 v[210:211], v2 offset:13312
  s_waitcnt vmcnt(5)
  v_mfma_f32_32x32x16_bf16 v[128:143], v[192:195], v[60:63], v[128:143]
  s_add_u32 s80, s99, 3072
  buffer_load_dword v10, v9, s[32:35], s80 offen sc1
  buffer_load_dwordx4 v[76:79], v3, s[32:35], s89 offen offset:2048 sc1
  v_lshlrev_b32 v246, 2, v13
  v_add_u32 v220, 4294868992, v220
  ds_read_b64_tr_b16 v[212:213], v220 offset:12288
  ds_read_b64_tr_b16 v[214:215], v220 offset:13312
  s_waitcnt lgkmcnt(6)
  v_mfma_f32_32x32x16_bf16 v[144:159], v[196:199], v[60:63], v[144:159]
  v_xor_b32 v246, v246, v11
  ds_read_b64_tr_b16 v[192:193], v2 offset:20480
  ds_read_b64_tr_b16 v[194:195], v2 offset:21504
  s_waitcnt vmcnt(5)
  v_mfma_f32_32x32x16_bf16 v[128:143], v[200:203], v[64:67], v[128:143]
  buffer_load_dwordx4 v[80:83], v3, s[32:35], s90 offen offset:2048 sc1
  v_lshlrev_b32 v246, 4, v246
  v_lshl_add_u32 v246, v13, 9, v246
  ds_read_b64_tr_b16 v[196:197], v220 offset:20480
  ds_read_b64_tr_b16 v[198:199], v220 offset:21504
  s_waitcnt lgkmcnt(6)
  v_mfma_f32_32x32x16_bf16 v[144:159], v[204:207], v[64:67], v[144:159]
  v_and_b32 v13, 1, v12
  ds_read_b64_tr_b16 v[200:201], v2 offset:28672
  ds_read_b64_tr_b16 v[202:203], v2 offset:29696
  s_waitcnt vmcnt(5)
  v_mfma_f32_32x32x16_bf16 v[128:143], v[208:211], v[68:71], v[128:143]
  buffer_load_dwordx4 v[84:87], v3, s[32:35], s91 offen offset:2048 sc1
  v_lshl_add_u32 v246, v13, 10, v246
  ds_read_b64_tr_b16 v[204:205], v220 offset:28672
  ds_read_b64_tr_b16 v[206:207], v220 offset:29696
  s_waitcnt lgkmcnt(6)
  v_mfma_f32_32x32x16_bf16 v[144:159], v[212:215], v[68:71], v[144:159]
  v_lshrrev_b32 v13, 5, v15
  ds_read_b64_tr_b16 v[208:209], v2 offset:36864
  ds_read_b64_tr_b16 v[210:211], v2 offset:37888
  s_waitcnt vmcnt(5)
  v_mfma_f32_32x32x16_bf16 v[128:143], v[192:195], v[72:75], v[128:143]
  s_waitcnt vmcnt(3)
  v_cmp_ne_u32 vcc, s43, v10
  s_nop 1
  s_cbranch_vccnz L_slow_90
L_ok_89:
  buffer_load_dwordx4 v[88:91], v3, s[32:35], s86 offen offset:3072 sc1
  v_lshl_add_u32 v246, v13, 11, v246
  v_mov_b32 v248, 0x3f80
  ds_read_b64_tr_b16 v[212:213], v220 offset:36864
  ds_read_b64_tr_b16 v[214:215], v220 offset:37888
  s_waitcnt lgkmcnt(6)
  v_mfma_f32_32x32x16_bf16 v[144:159], v[196:199], v[72:75], v[144:159]
  v_mov_b32 v249, 0
  ds_read_b64_tr_b16 v[192:193], v2 offset:45056
  ds_read_b64_tr_b16 v[194:195], v2 offset:46080
  s_waitcnt vmcnt(3)
  v_mfma_f32_32x32x16_bf16 v[128:143], v[200:203], v[76:79], v[128:143]
  buffer_load_dwordx4 v[92:95], v3, s[32:35], s87 offen offset:3072 sc1
  v_cmp_ne_u32 vcc, s43, v223
  s_nop 1
  s_cbranch_vccnz L_slow_93
L_ok_92:
  v_and_b32 v13, 0x30, v1
  ds_read_b64_tr_b16 v[196:197], v220 offset:45056
  ds_read_b64_tr_b16 v[198:199], v220 offset:46080
  s_waitcnt lgkmcnt(6)
  v_mfma_f32_32x32x16_bf16 v[144:159], v[204:207], v[76:79], v[144:159]
  v_lshlrev_b64 v[248:249], v13, v[248:249]
  v_add_u32 v2, 98304, v2
  ds_read_b64_tr_b16 v[200:201], v2 offset:63488
  ds_read_b64_tr_b16 v[202:203], v2 offset:64512
  s_waitcnt vmcnt(3)
  v_mfma_f32_32x32x16_bf16 v[128:143], v[208:211], v[80:83], v[128:143]
  buffer_load_dwordx4 v[96:99], v3, s[32:35], s88 offen offset:3072 sc1
  v_add_u32 v220, 98304, v220
  ds_read_b64_tr_b16 v[204:205], v220 offset:63488
  ds_read_b64_tr_b16 v[206:207], v220 offset:64512
  s_waitcnt vmcnt(3) lgkmcnt(6)
  v_mfma_f32_32x32x16_bf16 v[144:159], v[212:215], v[80:83], v[144:159]
  s_barrier
  v_mfma_f32_32x32x16_bf16 v[128:143], v[192:195], v[84:87], v[128:143]
  v_add_u32 v2, 4294868992, v2
  ds_read_b64_tr_b16 v[208:209], v2 offset:14336
  ds_read_b64_tr_b16 v[210:211], v2 offset:15360
  buffer_load_dwordx4 v[100:103], v3, s[32:35], s89 offen offset:3072 sc1
  v_add_u32 v220, 4294868992, v220
  ds_read_b64_tr_b16 v[212:213], v220 offset:14336
  ds_read_b64_tr_b16 v[214:215], v220 offset:15360
  s_waitcnt lgkmcnt(6)
  v_mfma_f32_32x32x16_bf16 v[144:159], v[196:199], v[84:87], v[144:159]
  ds_read_b64_tr_b16 v[192:193], v2 offset:22528
  ds_read_b64_tr_b16 v[194:195], v2 offset:23552
  s_waitcnt vmcnt(3)
  v_mfma_f32_32x32x16_bf16 v[128:143], v[200:203], v[88:91], v[128:143]
  buffer_load_dwordx4 v[104:107], v3, s[32:35], s90 offen offset:3072 sc1
  ds_read_b64_tr_b16 v[196:197], v220 offset:22528
  ds_read_b64_tr_b16 v[198:199], v220 offset:23552
  s_waitcnt lgkmcnt(6)
  v_mfma_f32_32x32x16_bf16 v[144:159], v[204:207], v[88:91], v[144:159]
  ds_read_b64_tr_b16 v[200:201], v2 offset:30720
  ds_read_b64_tr_b16 v[202:203], v2 offset:31744
  s_waitcnt vmcnt(3)
  v_mfma_f32_32x32x16_bf16 v[128:143], v[208:211], v[92:95], v[128:143]
  buffer_load_dwordx4 v[108:111], v3, s[32:35], s91 offen offset:3072 sc1
  ds_read_b64_tr_b16 v[204:205], v220 offset:30720
  ds_read_b64_tr_b16 v[206:207], v220 offset:31744
  s_waitcnt lgkmcnt(6)
  v_mfma_f32_32x32x16_bf16 v[144:159], v[212:215], v[92:95], v[144:159]
  ds_read_b64_tr_b16 v[208:209], v2 offset:38912
  ds_read_b64_tr_b16 v[210:211], v2 offset:39936
  s_waitcnt vmcnt(3)
  v_mfma_f32_32x32x16_bf16 v[128:143], v[192:195], v[96:99], v[128:143]
  buffer_load_dwordx4 v[16:19], v1, s[32:35], s51 offen offset:0 sc1
  ds_read_b64_tr_b16 v[212:213], v220 offset:38912
  ds_read_b64_tr_b16 v[214:215], v220 offset:39936
  s_waitcnt lgkmcnt(6)
  v_mfma_f32_32x32x16_bf16 v[144:159], v[196:199], v[96:99], v[144:159]
  ds_read_b64_tr_b16 v[192:193], v2 offset:47104
  ds_read_b64_tr_b16 v[194:195], v2 offset:48128
  s_waitcnt vmcnt(3)
  v_mfma_f32_32x32x16_bf16 v[128:143], v[200:203], v[100:103], v[128:143]
  buffer_load_dwordx4 v[20:23], v1, s[32:35], s51 offen offset:1024 sc1
  ds_read_b64_tr_b16 v[196:197], v220 offset:47104
  ds_read_b64_tr_b16 v[198:199], v220 offset:48128
  s_waitcnt lgkmcnt(6)
  v_mfma_f32_32x32x16_bf16 v[144:159], v[204:207], v[100:103], v[144:159]
  ds_read_b64_tr_b16 v[200:201], v2 offset:51200
  ds_read_b64_tr_b16 v[202:203], v2 offset:52224
  s_waitcnt vmcnt(3)
  v_mfma_f32_32x32x16_bf16 v[128:143], v[208:211], v[104:107], v[128:143]
  buffer_load_dwordx4 v[24:27], v1, s[32:35], s51 offen offset:2048 sc1
  ds_read_b64_tr_b16 v[204:205], v220 offset:51200
  ds_read_b64_tr_b16 v[206:207], v220 offset:52224
  s_waitcnt lgkmcnt(6)
  v_mfma_f32_32x32x16_bf16 v[144:159], v[212:215], v[104:107], v[144:159]
  ds_read_b64_tr_b16 v[208:209], v2 offset:59392
  ds_read_b64_tr_b16 v[210:211], v2 offset:60416
  s_waitcnt vmcnt(3) lgkmcnt(6)
  v_mfma_f32_32x32x16_bf16 v[128:143], v[192:195], v[108:111], v[128:143]
  s_barrier
  v_mfma_f32_32x32x16_bf16 v[144:159], v[196:199], v[108:111], v[144:159]
  ds_read_b64_tr_b16 v[212:213], v220 offset:59392
  ds_read_b64_tr_b16 v[214:215], v220 offset:60416
  buffer_load_dwordx4 v[28:31], v1, s[32:35], s51 offen offset:3072 sc1
  s_waitcnt vmcnt(3)
  v_max3_u32 v14, v16, v17, v18
  v_max_u32 v14, v14, v19
  v_cmp_eq_u32 vcc, -1, v14
  s_cbranch_vccnz L_vslow_96
L_vok_95:
  v_add_u32 v2, 98304, v2
  ds_read_b64_tr_b16 v[192:193], v2 offset:26624
  ds_read_b64_tr_b16 v[194:195], v2 offset:27648
  s_waitcnt lgkmcnt(6)
  v_mfma_f32_32x32x16_bf16 v[128:143], v[200:203], v[16:19], v[128:143]
  buffer_load_dwordx4 v[32:35], v1, s[32:35], s3 offen offset:0 sc1
  v_add_u32 v220, 98304, v220
  ds_read_b64_tr_b16 v[196:197], v220 offset:26624
  ds_read_b64_tr_b16 v[198:199], v220 offset:27648
  v_mfma_f32_32x32x16_bf16 v[144:159], v[204:207], v[16:19], v[144:159]
  s_waitcnt vmcnt(3)
  v_max3_u32 v14, v20, v21, v22
  v_max_u32 v14, v14, v23
  v_cmp_eq_u32 vcc, -1, v14
  s_cbranch_vccnz L_vslow_99
L_vok_98:
  ds_read_b64_tr_b16 v[200:201], v2 offset:34816
  ds_read_b64_tr_b16 v[202:203], v2 offset:35840
  s_waitcnt lgkmcnt(6)
  v_mfma_f32_32x32x16_bf16 v[128:143], v[208:211], v[20:23], v[128:143]
  buffer_load_dwordx4 v[36:39], v1, s[32:35], s3 offen offset:1024 sc1
  ds_read_b64_tr_b16 v[204:205], v220 offset:34816
  ds_read_b64_tr_b16 v[206:207], v220 offset:35840
  v_mfma_f32_32x32x16_bf16 v[144:159], v[212:215], v[20:23], v[144:159]
  s_waitcnt vmcnt(3)
  v_max3_u32 v14, v24, v25, v26
  v_max_u32 v14, v14, v27
  v_cmp_eq_u32 vcc, -1, v14
  s_cbranch_vccnz L_vslow_102
L_vok_101:
  v_add_u32 v2, 4294934528, v2
  ds_read_b64_tr_b16 v[208:209], v2 offset:2048
  ds_read_b64_tr_b16 v[210:211], v2 offset:3072
  s_waitcnt lgkmcnt(6)
  v_mfma_f32_32x32x16_bf16 v[128:143], v[192:195], v[24:27], v[128:143]
  buffer_load_dwordx4 v[40:43], v1, s[32:35], s3 offen offset:2048 sc1
  v_add_u32 v220, 4294934528, v220
  ds_read_b64_tr_b16 v[212:213], v220 offset:2048
  ds_read_b64_tr_b16 v[214:215], v220 offset:3072
  v_mfma_f32_32x32x16_bf16 v[144:159], v[196:199], v[24:27], v[144:159]
  s_waitcnt vmcnt(3)
  v_max3_u32 v14, v28, v29, v30
  v_max_u32 v14, v14, v31
  v_cmp_eq_u32 vcc, -1, v14
  s_cbranch_vccnz L_vslow_105
L_vok_104:
  ds_read_b64_tr_b16 v[192:193], v2 offset:10240
  ds_read_b64_tr_b16 v[194:195], v2 offset:11264
  s_waitcnt lgkmcnt(6)
  v_mfma_f32_32x32x16_bf16 v[128:143], v[200:203], v[28:31], v[128:143]
  ds_read_b64_tr_b16 v[196:197], v220 offset:10240
  ds_read_b64_tr_b16 v[198:199], v220 offset:11264
  v_mfma_f32_32x32x16_bf16 v[144:159], v[204:207], v[28:31], v[144:159]
  s_waitcnt vmcnt(2)
  v_max3_u32 v14, v32, v33, v34
  v_max_u32 v14, v14, v35
  v_cmp_eq_u32 vcc, -1, v14
  s_cbranch_vccnz L_vslow_108
L_vok_107:
  ds_read_b64_tr_b16 v[200:201], v2 offset:18432
  ds_read_b64_tr_b16 v[202:203], v2 offset:19456
  s_waitcnt lgkmcnt(6)
  v_mfma_f32_32x32x16_bf16 v[128:143], v[208:211], v[32:35], v[128:143]
  ds_read_b64_tr_b16 v[204:205], v220 offset:18432
  ds_read_b64_tr_b16 v[206:207], v220 offset:19456
  v_mfma_f32_32x32x16_bf16 v[144:159], v[212:215], v[32:35], v[144:159]
  s_waitcnt vmcnt(1)
  v_max3_u32 v14, v36, v37, v38
  v_max_u32 v14, v14, v39
  v_cmp_eq_u32 vcc, -1, v14
  s_cbranch_vccnz L_vslow_111
L_vok_110:
  s_waitcnt lgkmcnt(4)
  v_mfma_f32_32x32x16_bf16 v[128:143], v[192:195], v[36:39], v[128:143]
  v_mfma_f32_32x32x16_bf16 v[144:159], v[196:199], v[36:39], v[144:159]
  s_waitcnt vmcnt(0)
  v_max3_u32 v14, v40, v41, v42
  v_max_u32 v14, v14, v43
  v_cmp_eq_u32 vcc, -1, v14
  s_cbranch_vccnz L_vslow_114
L_vok_113:
  s_waitcnt lgkmcnt(0)
  v_mfma_f32_32x32x16_bf16 v[128:143], v[200:203], v[40:43], v[128:143]
  v_mfma_f32_32x32x16_bf16 v[144:159], v[204:207], v[40:43], v[144:159]
  v_mfma_f32_4x4x4_16b_bf16 v[64:67], v[248:249], v[224:225], 0
  v_mfma_f32_4x4x4_16b_bf16 v[68:71], v[248:249], v[226:227], 0
  s_nop 8
  v_cvt_pk_bf16_f32 v16, v128, v129
  v_cvt_pk_bf16_f32 v17, v130, v131
  v_cvt_pk_bf16_f32 v18, v132, v133
  v_cvt_pk_bf16_f32 v19, v134, v135
  ds_write_b128 v240, v[16:19] offset:0
  v_cvt_pk_bf16_f32 v20, v136, v137
  v_cvt_pk_bf16_f32 v21, v138, v139
  v_cvt_pk_bf16_f32 v22, v140, v141
  v_cvt_pk_bf16_f32 v23, v142, v143
  ds_write_b128 v241, v[20:23] offset:0
  v_cvt_pk_bf16_f32 v24, v144, v145
  v_cvt_pk_bf16_f32 v25, v146, v147
  v_cvt_pk_bf16_f32 v26, v148, v149
  v_cvt_pk_bf16_f32 v27, v150, v151
  ds_write_b128 v242, v[24:27] offset:0
  v_cvt_pk_bf16_f32 v28, v152, v153
  v_cvt_pk_bf16_f32 v29, v154, v155
  v_cvt_pk_bf16_f32 v30, v156, v157
  v_cvt_pk_bf16_f32 v31, v158, v159
  ds_write_b128 v243, v[28:31] offset:0
  s_mov_b32 m0, s52
  s_lshl_b32 s56, s82, 13
  s_add_u32 s56, s56, 4194560
  buffer_load_dwordx4 v246, s[32:35], s56 offen sc1 lds
  s_waitcnt lgkmcnt(0)
  s_barrier
  ds_read_b128 v[72:75], v244 offset:2048
  ds_read_b128 v[76:79], v244 offset:6144
  ds_read_b128 v[80:83], v245 offset:2048
  ds_read_b128 v[84:87], v245 offset:6144
  s_waitcnt lgkmcnt(3)
  v_mfma_f32_4x4x4_16b_bf16 v[64:67], v[248:249], v[72:73], v[64:67]
  v_mfma_f32_4x4x4_16b_bf16 v[68:71], v[248:249], v[74:75], v[68:71]
  s_waitcnt lgkmcnt(2)
  v_mfma_f32_4x4x4_16b_bf16 v[64:67], v[248:249], v[76:77], v[64:67]
  v_mfma_f32_4x4x4_16b_bf16 v[68:71], v[248:249], v[78:79], v[68:71]
  s_waitcnt lgkmcnt(1)
  v_mfma_f32_4x4x4_16b_bf16 v[64:67], v[248:249], v[80:81], v[64:67]
  v_mfma_f32_4x4x4_16b_bf16 v[68:71], v[248:249], v[82:83], v[68:71]
  s_waitcnt lgkmcnt(0)
  v_mfma_f32_4x4x4_16b_bf16 v[64:67], v[248:249], v[84:85], v[64:67]
  v_mfma_f32_4x4x4_16b_bf16 v[68:71], v[248:249], v[86:87], v[68:71]
  s_waitcnt vmcnt(0)
  ds_read_b128 v[88:91], v247
  s_waitcnt lgkmcnt(0)
  v_max3_u32 v11, v88, v89, v90
  v_max_u32 v11, v11, v91
  v_cmp_eq_u32 vcc, -1, v11
  s_nop 1
  s_cbranch_vccnz L_xslow_117
L_xok_116:
  v_mfma_f32_4x4x4_16b_bf16 v[64:67], v[248:249], v[88:89], v[64:67]
  v_mfma_f32_4x4x4_16b_bf16 v[68:71], v[248:249], v[90:91], v[68:71]
  s_nop 4
  v_cvt_pk_bf16_f32 v64, v64, v65
  v_cvt_pk_bf16_f32 v65, v66, v67
  v_cvt_pk_bf16_f32 v66, v68, v69
  v_cvt_pk_bf16_f32 v67, v70, v71
  buffer_store_dwordx4 v[64:67], v221, s[28:31], s101 offen sc1
  s_endpgm
.p2align 3
L_snd_82:
  v_add_u32 v2, 65536, v2
  ds_read_b64_tr_b16 v[192:193], v2 offset:20480
  ds_read_b64_tr_b16 v[194:195], v2 offset:21504
  v_add_u32 v220, 65536, v220
  ds_read_b64_tr_b16 v[196:197], v220 offset:20480
  ds_read_b64_tr_b16 v[198:199], v220 offset:21504
  ds_read_b64_tr_b16 v[200:201], v2 offset:22528
  ds_read_b64_tr_b16 v[202:203], v2 offset:23552
  ds_read_b64_tr_b16 v[204:205], v220 offset:22528
  ds_read_b64_tr_b16 v[206:207], v220 offset:23552
  v_add_u32 v2, 4294901760, v2
  ds_read_b64_tr_b16 v[208:209], v2 offset:4096
  ds_read_b64_tr_b16 v[210:211], v2 offset:5120
  s_waitcnt lgkmcnt(6)
  v_mfma_f32_32x32x16_bf16 v[128:143], v[192:195], v[240:243], 0
  v_add_u32 v220, 4294901760, v220
  ds_read_b64_tr_b16 v[212:213], v220 offset:4096
  ds_read_b64_tr_b16 v[214:215], v220 offset:5120
  v_mfma_f32_32x32x16_bf16 v[144:159], v[196:199], v[240:243], 0
  ds_read_b64_tr_b16 v[192:193], v2 offset:6144
  ds_read_b64_tr_b16 v[194:195], v2 offset:7168
  s_waitcnt lgkmcnt(6)
  v_mfma_f32_32x32x16_bf16 v[128:143], v[200:203], v[244:247], v[128:143]
  ds_read_b64_tr_b16 v[196:197], v220 offset:6144
  ds_read_b64_tr_b16 v[198:199], v220 offset:7168
  v_mfma_f32_32x32x16_bf16 v[144:159], v[204:207], v[244:247], v[144:159]
  v_add_u32 v2, 65536, v2
  ds_read_b64_tr_b16 v[200:201], v2 offset:28672
  ds_read_b64_tr_b16 v[202:203], v2 offset:29696
  s_waitcnt lgkmcnt(6)
  v_mfma_f32_32x32x16_bf16 v[128:143], v[208:211], v[248:251], v[128:143]
  v_add_u32 v220, 65536, v220
  ds_read_b64_tr_b16 v[204:205], v220 offset:28672
  ds_read_b64_tr_b16 v[206:207], v220 offset:29696
  v_mfma_f32_32x32x16_bf16 v[144:159], v[212:215], v[248:251], v[144:159]
  v_add_u32 v2, 32768, v2
  ds_read_b64_tr_b16 v[208:209], v2 offset:45056
  ds_read_b64_tr_b16 v[210:211], v2 offset:46080
  s_waitcnt lgkmcnt(6)
  v_mfma_f32_32x32x16_bf16 v[128:143], v[192:195], v[252:255], v[128:143]
  v_min_u32 v222, 1, v15
  v_lshlrev_b32 v222, 7, v222
  s_lshl_b32 s56, s82, 8
  s_add_u32 s56, s56, 262144
  buffer_load_dword v223, v222, s[32:35], s56 offen sc1
  v_add_u32 v220, 32768, v220
  ds_read_b64_tr_b16 v[212:213], v220 offset:45056
  ds_read_b64_tr_b16 v[214:215], v220 offset:46080
  v_mfma_f32_32x32x16_bf16 v[144:159], v[196:199], v[252:255], v[144:159]
  s_waitcnt vmcnt(5)
  s_add_u32 s47, s100, 3072
  v_mov_b32 v12, s43
  s_mov_b64 exec, 0xff
  buffer_store_dwordx4 v[12:15], v1, s[32:35], s47 offen sc1
  s_mov_b64 exec, -1
  ds_read_b64_tr_b16 v[192:193], v2 offset:53248
  ds_read_b64_tr_b16 v[194:195], v2 offset:54272
  s_waitcnt lgkmcnt(6)
  s_waitcnt vmcnt(5)
  v_mfma_f32_32x32x16_bf16 v[128:143], v[200:203], v[16:19], v[128:143]
  buffer_load_dwordx4 v[32:35], v1, s[32:35], s90 offen offset:2048 sc1
  ds_read_b64_tr_b16 v[196:197], v220 offset:53248
  ds_read_b64_tr_b16 v[198:199], v220 offset:54272
  v_mfma_f32_32x32x16_bf16 v[144:159], v[204:207], v[16:19], v[144:159]
  ds_read_b64_tr_b16 v[200:201], v2 offset:4096
  ds_read_b64_tr_b16 v[202:203], v2 offset:5120
  s_waitcnt lgkmcnt(6)
  s_waitcnt vmcnt(5)
  v_mfma_f32_32x32x16_bf16 v[128:143], v[208:211], v[20:23], v[128:143]
  buffer_load_dwordx4 v[36:39], v1, s[32:35], s91 offen offset:2048 sc1
  v_and_b32 v11, 7, v15
  v_lshrrev_b32 v12, 4, v15
  ds_read_b64_tr_b16 v[204:205], v220 offset:4096
  ds_read_b64_tr_b16 v[206:207], v220 offset:5120
  v_mfma_f32_32x32x16_bf16 v[144:159], v[212:215], v[20:23], v[144:159]
  v_and_b32 v12, 2, v12
  ds_read_b64_tr_b16 v[208:209], v2 offset:12288
  ds_read_b64_tr_b16 v[210:211], v2 offset:13312
  s_waitcnt lgkmcnt(6)
  s_waitcnt vmcnt(5)
  v_mfma_f32_32x32x16_bf16 v[128:143], v[192:195], v[24:27], v[128:143]
  buffer_load_dwordx4 v[40:43], v1, s[32:35], s86 offen offset:3072 sc1
  v_xor_b32 v12, v12, v11
  ds_read_b64_tr_b16 v[212:213], v220 offset:12288
  ds_read_b64_tr_b16 v[214:215], v220 offset:13312
  v_mfma_f32_32x32x16_bf16 v[144:159], v[196:199], v[24:27], v[144:159]
  v_and_b32 v13, 31, v15
  v_lshlrev_b32 v13, 7, v13
  ds_read_b64_tr_b16 v[192:193], v2 offset:20480
  ds_read_b64_tr_b16 v[194:195], v2 offset:21504
  s_waitcnt lgkmcnt(6)
  s_waitcnt vmcnt(5)
  v_mfma_f32_32x32x16_bf16 v[128:143], v[200:203], v[28:31], v[128:143]
  buffer_load_dwordx4 v[44:47], v1, s[32:35], s87 offen offset:3072 sc1
  v_lshl_add_u32 v12, v12, 4, v13
  ds_read_b64_tr_b16 v[196:197], v220 offset:20480
  ds_read_b64_tr_b16 v[198:199], v220 offset:21504
  v_mfma_f32_32x32x16_bf16 v[144:159], v[204:207], v[28:31], v[144:159]
  s_bitcmp1_b32 s37, 0
  s_cselect_b32 s54, 17, 0
  s_cselect_b32 s49, 18, 11
  s_cselect_b32 s52, 13, 12
  v_add_u32 v2, 4294934528, v2
  ds_read_b64_tr_b16 v[200:201], v2 offset:30720
  ds_read_b64_tr_b16 v[202:203], v2 offset:31744
  s_waitcnt lgkmcnt(6)
  s_waitcnt vmcnt(3)
  v_mfma_f32_32x32x16_bf16 v[128:143], v[208:211], v[32:35], v[128:143]
  buffer_load_dwordx4 v[48:51], v1, s[32:35], s88 offen offset:3072 sc1
  v_cmp_ne_u32 vcc, s43, v223
  s_nop 1
  s_cbranch_vccnz L_slow_120
L_ok_119:
  v_lshl_add_u32 v240, s49, 13, v12
  v_add_u32 v220, 4294934528, v220
  ds_read_b64_tr_b16 v[204:205], v220 offset:30720
  ds_read_b64_tr_b16 v[206:207], v220 offset:31744
  v_mfma_f32_32x32x16_bf16 v[144:159], v[212:215], v[32:35], v[144:159]
  v_xor_b32 v241, 16, v240
  v_xor_b32 v242, 64, v240
  v_add_u32 v2, 32768, v2
  ds_read_b64_tr_b16 v[208:209], v2 offset:47104
  ds_read_b64_tr_b16 v[210:211], v2 offset:48128
  s_waitcnt lgkmcnt(6)
  s_waitcnt vmcnt(3)
  v_mfma_f32_32x32x16_bf16 v[128:143], v[192:195], v[36:39], v[128:143]
  s_add_u32 s80, s99, 2048
  buffer_load_dword v10, v9, s[32:35], s80 offen sc1
  buffer_load_dwordx4 v[52:55], v1, s[32:35], s89 offen offset:3072 sc1
  v_xor_b32 v243, 80, v240
  v_add_u32 v220, 32768, v220
  ds_read_b64_tr_b16 v[212:213], v220 offset:47104
  ds_read_b64_tr_b16 v[214:215], v220 offset:48128
  v_mfma_f32_32x32x16_bf16 v[144:159], v[196:199], v[36:39], v[144:159]
  v_lshrrev_b32 v12, 3, v15
  ds_read_b64_tr_b16 v[192:193], v2 offset:55296
  ds_read_b64_tr_b16 v[194:195], v2 offset:56320
  s_waitcnt lgkmcnt(6)
  s_waitcnt vmcnt(4)
  v_mfma_f32_32x32x16_bf16 v[128:143], v[200:203], v[40:43], v[128:143]
  buffer_load_dwordx4 v[56:59], v1, s[32:35], s90 offen offset:3072 sc1
  v_lshlrev_b32 v13, 4, v12
  ds_read_b64_tr_b16 v[196:197], v220 offset:55296
  ds_read_b64_tr_b16 v[198:199], v220 offset:56320
  s_waitcnt vmcnt(4) lgkmcnt(6)
  v_mfma_f32_32x32x16_bf16 v[144:159], v[204:207], v[40:43], v[144:159]
  s_barrier
  v_mfma_f32_32x32x16_bf16 v[128:143], v[208:211], v[44:47], v[128:143]
  ds_read_b64_tr_b16 v[200:201], v2 offset:6144
  ds_read_b64_tr_b16 v[202:203], v2 offset:7168
  v_xor_b32 v13, v13, v1
  v_lshl_add_u32 v244, s54, 13, v13
  buffer_load_dwordx4 v[60:63], v1, s[32:35], s91 offen offset:3072 sc1
  v_lshl_add_u32 v245, s49, 13, v13
  ds_read_b64_tr_b16 v[204:205], v220 offset:6144
  ds_read_b64_tr_b16 v[206:207], v220 offset:7168
  s_waitcnt lgkmcnt(6)
  v_mfma_f32_32x32x16_bf16 v[144:159], v[212:215], v[44:47], v[144:159]
  s_add_u32 m0, s38, 86016
  s_mov_b32 s46, 200704
  buffer_load_dwordx4 v238, s[16:19], s46 offen lds
  v_and_b32 v13, 2, v15
  ds_read_b64_tr_b16 v[208:209], v2 offset:14336
  ds_read_b64_tr_b16 v[210:211], v2 offset:15360
  s_waitcnt vmcnt(5)
  v_mfma_f32_32x32x16_bf16 v[128:143], v[192:195], v[48:51], v[128:143]
  s_waitcnt vmcnt(4)
  v_cmp_ne_u32 vcc, s43, v10
  s_nop 1
  s_cbranch_vccnz L_slow_123
L_ok_122:
  v_add_u32 v3, 4096, v1
  buffer_load_dwordx4 v[64:67], v3, s[32:35], s86 offen offset:2048 sc1
  v_lshlrev_b32 v13, 1, v13
  ds_read_b64_tr_b16 v[212:213], v220 offset:14336
  ds_read_b64_tr_b16 v[214:215], v220 offset:15360
  s_waitcnt lgkmcnt(6)
  v_mfma_f32_32x32x16_bf16 v[144:159], v[196:199], v[48:51], v[144:159]
  v_xor_b32 v13, v13, v12
  v_lshlrev_b32 v13, 4, v13
  ds_read_b64_tr_b16 v[192:193], v2 offset:22528
  ds_read_b64_tr_b16 v[194:195], v2 offset:23552
  s_waitcnt vmcnt(4)
  v_mfma_f32_32x32x16_bf16 v[128:143], v[200:203], v[52:55], v[128:143]
  buffer_load_dwordx4 v[68:71], v3, s[32:35], s87 offen offset:2048 sc1
  v_lshl_add_u32 v13, v11, 7, v13
  ds_read_b64_tr_b16 v[196:197], v220 offset:22528
  ds_read_b64_tr_b16 v[198:199], v220 offset:23552
  s_waitcnt lgkmcnt(6)
  v_mfma_f32_32x32x16_bf16 v[144:159], v[204:207], v[52:55], v[144:159]
  s_lshl_b32 s52, s52, 13
  ds_read_b64_tr_b16 v[200:201], v2 offset:61440
  ds_read_b64_tr_b16 v[202:203], v2 offset:62464
  s_waitcnt vmcnt(4)
  v_mfma_f32_32x32x16_bf16 v[128:143], v[208:211], v[56:59], v[128:143]
  buffer_load_dwordx4 v[72:75], v3, s[32:35], s88 offen offset:2048 sc1
  s_lshl1_add_u32 s57, s40, 1
  s_lshl3_add_u32 s57, s57, s58
  s_lshl_b32 s57, s57, 12
  s_add_u32 s57, s57, 2097152
  v_mov_b32 v222, 896
  buffer_load_dword v223, v222, s[32:35], s57 offen sc1
  s_add_u32 s51, s51, 14336
  s_add_u32 s3, s51, 4096
  s_add_u32 s52, s52, 6144
  v_add_u32 v247, s52, v13
  ds_read_b64_tr_b16 v[204:205], v220 offset:61440
  ds_read_b64_tr_b16 v[206:207], v220 offset:62464
  s_waitcnt lgkmcnt(6)
  v_mfma_f32_32x32x16_bf16 v[144:159], v[212:215], v[56:59], v[144:159]
  v_bfe_u32 v13, v15, 4, 1
  v_add_u32 v2, 4294868992, v2
  ds_read_b64_tr_b16 v[208:209], v2 offset:12288
  ds_read_b64_tr_b16 v[210:211], v2 offset:13312
  s_waitcnt vmcnt(5)
  v_mfma_f32_32x32x16_bf16 v[128:143], v[192:195], v[60:63], v[128:143]
  s_add_u32 s80, s99, 3072
  buffer_load_dword v10, v9, s[32:35], s80 offen sc1
  buffer_load_dwordx4 v[76:79], v3, s[32:35], s89 offen offset:2048 sc1
  v_lshlrev_b32 v246, 2, v13
  v_add_u32 v220, 4294868992, v220
  ds_read_b64_tr_b16 v[212:213], v220 offset:12288
  ds_read_b64_tr_b16 v[214:215], v220 offset:13312
  s_waitcnt lgkmcnt(6)
  v_mfma_f32_32x32x16_bf16 v[144:159], v[196:199], v[60:63], v[144:159]
  v_xor_b32 v246, v246, v11
  ds_read_b64_tr_b16 v[192:193], v2 offset:20480
  ds_read_b64_tr_b16 v[194:195], v2 offset:21504
  s_waitcnt vmcnt(5)
  v_mfma_f32_32x32x16_bf16 v[128:143], v[200:203], v[64:67], v[128:143]
  buffer_load_dwordx4 v[80:83], v3, s[32:35], s90 offen offset:2048 sc1
  v_lshlrev_b32 v246, 4, v246
  v_lshl_add_u32 v246, v13, 9, v246
  ds_read_b64_tr_b16 v[196:197], v220 offset:20480
  ds_read_b64_tr_b16 v[198:199], v220 offset:21504
  s_waitcnt lgkmcnt(6)
  v_mfma_f32_32x32x16_bf16 v[144:159], v[204:207], v[64:67], v[144:159]
  v_and_b32 v13, 1, v12
  ds_read_b64_tr_b16 v[200:201], v2 offset:28672
  ds_read_b64_tr_b16 v[202:203], v2 offset:29696
  s_waitcnt vmcnt(5)
  v_mfma_f32_32x32x16_bf16 v[128:143], v[208:211], v[68:71], v[128:143]
  buffer_load_dwordx4 v[84:87], v3, s[32:35], s91 offen offset:2048 sc1
  v_lshl_add_u32 v246, v13, 10, v246
  ds_read_b64_tr_b16 v[204:205], v220 offset:28672
  ds_read_b64_tr_b16 v[206:207], v220 offset:29696
  s_waitcnt lgkmcnt(6)
  v_mfma_f32_32x32x16_bf16 v[144:159], v[212:215], v[68:71], v[144:159]
  v_lshrrev_b32 v13, 5, v15
  ds_read_b64_tr_b16 v[208:209], v2 offset:36864
  ds_read_b64_tr_b16 v[210:211], v2 offset:37888
  s_waitcnt vmcnt(5)
  v_mfma_f32_32x32x16_bf16 v[128:143], v[192:195], v[72:75], v[128:143]
  s_waitcnt vmcnt(3)
  v_cmp_ne_u32 vcc, s43, v10
  s_nop 1
  s_cbranch_vccnz L_slow_126
L_ok_125:
  buffer_load_dwordx4 v[88:91], v3, s[32:35], s86 offen offset:3072 sc1
  v_lshl_add_u32 v246, v13, 11, v246
  v_mov_b32 v248, 0x3f80
  ds_read_b64_tr_b16 v[212:213], v220 offset:36864
  ds_read_b64_tr_b16 v[214:215], v220 offset:37888
  s_waitcnt lgkmcnt(6)
  v_mfma_f32_32x32x16_bf16 v[144:159], v[196:199], v[72:75], v[144:159]
  v_mov_b32 v249, 0
  ds_read_b64_tr_b16 v[192:193], v2 offset:45056
  ds_read_b64_tr_b16 v[194:195], v2 offset:46080
  s_waitcnt vmcnt(3)
  v_mfma_f32_32x32x16_bf16 v[128:143], v[200:203], v[76:79], v[128:143]
  buffer_load_dwordx4 v[92:95], v3, s[32:35], s87 offen offset:3072 sc1
  v_cmp_ne_u32 vcc, s43, v223
  s_nop 1
  s_cbranch_vccnz L_slow_129
L_ok_128:
  v_and_b32 v13, 0x30, v1
  ds_read_b64_tr_b16 v[196:197], v220 offset:45056
  ds_read_b64_tr_b16 v[198:199], v220 offset:46080
  s_waitcnt lgkmcnt(6)
  v_mfma_f32_32x32x16_bf16 v[144:159], v[204:207], v[76:79], v[144:159]
  v_lshlrev_b64 v[248:249], v13, v[248:249]
  v_add_u32 v2, 98304, v2
  ds_read_b64_tr_b16 v[200:201], v2 offset:63488
  ds_read_b64_tr_b16 v[202:203], v2 offset:64512
  s_waitcnt vmcnt(3)
  v_mfma_f32_32x32x16_bf16 v[128:143], v[208:211], v[80:83], v[128:143]
  buffer_load_dwordx4 v[96:99], v3, s[32:35], s88 offen offset:3072 sc1
  v_add_u32 v220, 98304, v220
  ds_read_b64_tr_b16 v[204:205], v220 offset:63488
  ds_read_b64_tr_b16 v[206:207], v220 offset:64512
  s_waitcnt vmcnt(3) lgkmcnt(6)
  v_mfma_f32_32x32x16_bf16 v[144:159], v[212:215], v[80:83], v[144:159]
  s_barrier
  v_mfma_f32_32x32x16_bf16 v[128:143], v[192:195], v[84:87], v[128:143]
  v_add_u32 v2, 4294868992, v2
  ds_read_b64_tr_b16 v[208:209], v2 offset:14336
  ds_read_b64_tr_b16 v[210:211], v2 offset:15360
  buffer_load_dwordx4 v[100:103], v3, s[32:35], s89 offen offset:3072 sc1
  v_add_u32 v220, 4294868992, v220
  ds_read_b64_tr_b16 v[212:213], v220 offset:14336
  ds_read_b64_tr_b16 v[214:215], v220 offset:15360
  s_waitcnt lgkmcnt(6)
  v_mfma_f32_32x32x16_bf16 v[144:159], v[196:199], v[84:87], v[144:159]
  ds_read_b64_tr_b16 v[192:193], v2 offset:22528
  ds_read_b64_tr_b16 v[194:195], v2 offset:23552
  s_waitcnt vmcnt(3)
  v_mfma_f32_32x32x16_bf16 v[128:143], v[200:203], v[88:91], v[128:143]
  buffer_load_dwordx4 v[104:107], v3, s[32:35], s90 offen offset:3072 sc1
  ds_read_b64_tr_b16 v[196:197], v220 offset:22528
  ds_read_b64_tr_b16 v[198:199], v220 offset:23552
  s_waitcnt lgkmcnt(6)
  v_mfma_f32_32x32x16_bf16 v[144:159], v[204:207], v[88:91], v[144:159]
  ds_read_b64_tr_b16 v[200:201], v2 offset:30720
  ds_read_b64_tr_b16 v[202:203], v2 offset:31744
  s_waitcnt vmcnt(3)
  v_mfma_f32_32x32x16_bf16 v[128:143], v[208:211], v[92:95], v[128:143]
  buffer_load_dwordx4 v[108:111], v3, s[32:35], s91 offen offset:3072 sc1
  ds_read_b64_tr_b16 v[204:205], v220 offset:30720
  ds_read_b64_tr_b16 v[206:207], v220 offset:31744
  s_waitcnt lgkmcnt(6)
  v_mfma_f32_32x32x16_bf16 v[144:159], v[212:215], v[92:95], v[144:159]
  ds_read_b64_tr_b16 v[208:209], v2 offset:38912
  ds_read_b64_tr_b16 v[210:211], v2 offset:39936
  s_waitcnt vmcnt(3)
  v_mfma_f32_32x32x16_bf16 v[128:143], v[192:195], v[96:99], v[128:143]
  buffer_load_dwordx4 v[16:19], v1, s[32:35], s51 offen offset:0 sc1
  ds_read_b64_tr_b16 v[212:213], v220 offset:38912
  ds_read_b64_tr_b16 v[214:215], v220 offset:39936
  s_waitcnt lgkmcnt(6)
  v_mfma_f32_32x32x16_bf16 v[144:159], v[196:199], v[96:99], v[144:159]
  ds_read_b64_tr_b16 v[192:193], v2 offset:47104
  ds_read_b64_tr_b16 v[194:195], v2 offset:48128
  s_waitcnt vmcnt(3)
  v_mfma_f32_32x32x16_bf16 v[128:143], v[200:203], v[100:103], v[128:143]
  buffer_load_dwordx4 v[20:23], v1, s[32:35], s51 offen offset:1024 sc1
  ds_read_b64_tr_b16 v[196:197], v220 offset:47104
  ds_read_b64_tr_b16 v[198:199], v220 offset:48128
  s_waitcnt lgkmcnt(6)
  v_mfma_f32_32x32x16_bf16 v[144:159], v[204:207], v[100:103], v[144:159]
  ds_read_b64_tr_b16 v[200:201], v2 offset:55296
  ds_read_b64_tr_b16 v[202:203], v2 offset:56320
  s_waitcnt vmcnt(3)
  v_mfma_f32_32x32x16_bf16 v[128:143], v[208:211], v[104:107], v[128:143]
  buffer_load_dwordx4 v[24:27], v1, s[32:35], s51 offen offset:2048 sc1
  ds_read_b64_tr_b16 v[204:205], v220 offset:55296
  ds_read_b64_tr_b16 v[206:207], v220 offset:56320
  s_waitcnt lgkmcnt(6)
  v_mfma_f32_32x32x16_bf16 v[144:159], v[212:215], v[104:107], v[144:159]
  ds_read_b64_tr_b16 v[208:209], v2 offset:63488
  ds_read_b64_tr_b16 v[210:211], v2 offset:64512
  s_waitcnt vmcnt(3)
  v_mfma_f32_32x32x16_bf16 v[128:143], v[192:195], v[108:111], v[128:143]
  buffer_load_dwordx4 v[28:31], v1, s[32:35], s51 offen offset:3072 sc1
  ds_read_b64_tr_b16 v[212:213], v220 offset:63488
  ds_read_b64_tr_b16 v[214:215], v220 offset:64512
  s_waitcnt lgkmcnt(6)
  v_mfma_f32_32x32x16_bf16 v[144:159], v[196:199], v[108:111], v[144:159]
  s_and_b32 s55, s37, 1
  s_add_u32 s55, s55, 28
  v_lshl_add_u32 v13, s55, 12, v1
  s_lshl_b32 s55, s81, 13
  s_add_u32 s55, s55, 4196352
  s_nop 1
  v_cvt_pk_bf16_f32 v48, v128, v129
  v_cvt_pk_bf16_f32 v49, v130, v131
  v_cvt_pk_bf16_f32 v50, v132, v133
  v_cvt_pk_bf16_f32 v51, v134, v135
  ds_write_b128 v13, v[48:51] offset:2048
  v_cvt_pk_bf16_f32 v52, v136, v137
  v_cvt_pk_bf16_f32 v53, v138, v139
  v_cvt_pk_bf16_f32 v54, v140, v141
  v_cvt_pk_bf16_f32 v55, v142, v143
  ds_write_b128 v13, v[52:55] offset:3072
  s_waitcnt lgkmcnt(0)
  s_barrier
  ds_read_b128 v[56:59], v13 offset:0
  ds_read_b128 v[60:63], v13 offset:1024
  s_waitcnt lgkmcnt(1)
  v_mfma_f32_4x4x4_16b_bf16 v[144:147], v[248:249], v[56:57], v[144:147]
  v_mfma_f32_4x4x4_16b_bf16 v[148:151], v[248:249], v[58:59], v[148:151]
  s_waitcnt lgkmcnt(0)
  v_mfma_f32_4x4x4_16b_bf16 v[152:155], v[248:249], v[60:61], v[152:155]
  v_mfma_f32_4x4x4_16b_bf16 v[156:159], v[248:249], v[62:63], v[156:159]
  s_nop 1
  v_cvt_pk_bf16_f32 v48, v144, v145
  v_cvt_pk_bf16_f32 v49, v146, v147
  v_cvt_pk_bf16_f32 v50, v148, v149
  v_cvt_pk_bf16_f32 v51, v150, v151
  buffer_store_dwordx4 v[48:51], v1, s[32:35], s55 offen offset:0 sc1
  v_cvt_pk_bf16_f32 v52, v152, v153
  v_cvt_pk_bf16_f32 v53, v154, v155
  v_cvt_pk_bf16_f32 v54, v156, v157
  v_cvt_pk_bf16_f32 v55, v158, v159
  buffer_store_dwordx4 v[52:55], v1, s[32:35], s55 offen offset:1024 sc1
  s_waitcnt vmcnt(5)
  v_max3_u32 v14, v16, v17, v18
  v_max_u32 v14, v14, v19
  v_cmp_eq_u32 vcc, -1, v14
  s_cbranch_vccnz L_vslow_132
L_vok_131:
  v_add_u32 v2, 98304, v2
  ds_read_b64_tr_b16 v[192:193], v2 offset:30720
  ds_read_b64_tr_b16 v[194:195], v2 offset:31744
  v_mfma_f32_32x32x16_bf16 v[160:175], v[200:203], v[16:19], 0
  buffer_load_dwordx4 v[32:35], v1, s[32:35], s3 offen offset:0 sc1
  v_add_u32 v220, 98304, v220
  ds_read_b64_tr_b16 v[196:197], v220 offset:30720
  ds_read_b64_tr_b16 v[198:199], v220 offset:31744
  v_mfma_f32_32x32x16_bf16 v[176:191], v[204:207], v[16:19], 0
  s_waitcnt vmcnt(5)
  v_max3_u32 v14, v20, v21, v22
  v_max_u32 v14, v14, v23
  v_cmp_eq_u32 vcc, -1, v14
  s_cbranch_vccnz L_vslow_135
L_vok_134:
  ds_read_b64_tr_b16 v[200:201], v2 offset:38912
  ds_read_b64_tr_b16 v[202:203], v2 offset:39936
  v_mfma_f32_32x32x16_bf16 v[160:175], v[208:211], v[20:23], v[160:175]
  buffer_load_dwordx4 v[36:39], v1, s[32:35], s3 offen offset:1024 sc1
  ds_read_b64_tr_b16 v[204:205], v220 offset:38912
  ds_read_b64_tr_b16 v[206:207], v220 offset:39936
  v_mfma_f32_32x32x16_bf16 v[176:191], v[212:215], v[20:23], v[176:191]
  s_waitcnt vmcnt(5)
  v_max3_u32 v14, v24, v25, v26
  v_max_u32 v14, v14, v27
  v_cmp_eq_u32 vcc, -1, v14
  s_cbranch_vccnz L_vslow_138
L_vok_137:
  v_add_u32 v2, 4294934528, v2
  ds_read_b64_tr_b16 v[208:209], v2 offset:6144
  ds_read_b64_tr_b16 v[210:211], v2 offset:7168
  s_waitcnt lgkmcnt(6)
  v_mfma_f32_32x32x16_bf16 v[160:175], v[192:195], v[24:27], v[160:175]
  buffer_load_dwordx4 v[40:43], v1, s[32:35], s3 offen offset:2048 sc1
  v_add_u32 v220, 4294934528, v220
  ds_read_b64_tr_b16 v[212:213], v220 offset:6144
  ds_read_b64_tr_b16 v[214:215], v220 offset:7168
  v_mfma_f32_32x32x16_bf16 v[176:191], v[196:199], v[24:27], v[176:191]
  s_waitcnt vmcnt(5)
  v_max3_u32 v14, v28, v29, v30
  v_max_u32 v14, v14, v31
  v_cmp_eq_u32 vcc, -1, v14
  s_cbranch_vccnz L_vslow_141
L_vok_140:
  ds_read_b64_tr_b16 v[192:193], v2 offset:14336
  ds_read_b64_tr_b16 v[194:195], v2 offset:15360
  s_waitcnt lgkmcnt(6)
  v_mfma_f32_32x32x16_bf16 v[160:175], v[200:203], v[28:31], v[160:175]
  ds_read_b64_tr_b16 v[196:197], v220 offset:14336
  ds_read_b64_tr_b16 v[198:199], v220 offset:15360
  v_mfma_f32_32x32x16_bf16 v[176:191], v[204:207], v[28:31], v[176:191]
  s_waitcnt vmcnt(2)
  v_max3_u32 v14, v32, v33, v34
  v_max_u32 v14, v14, v35
  v_cmp_eq_u32 vcc, -1, v14
  s_cbranch_vccnz L_vslow_144
L_vok_143:
  ds_read_b64_tr_b16 v[200:201], v2 offset:22528
  ds_read_b64_tr_b16 v[202:203], v2 offset:23552
  s_waitcnt lgkmcnt(6)
  v_mfma_f32_32x32x16_bf16 v[160:175], v[208:211], v[32:35], v[160:175]
  ds_read_b64_tr_b16 v[204:205], v220 offset:22528
  ds_read_b64_tr_b16 v[206:207], v220 offset:23552
  v_mfma_f32_32x32x16_bf16 v[176:191], v[212:215], v[32:35], v[176:191]
  s_waitcnt vmcnt(1)
  v_max3_u32 v14, v36, v37, v38
  v_max_u32 v14, v14, v39
  v_cmp_eq_u32 vcc, -1, v14
  s_cbranch_vccnz L_vslow_147
L_vok_146:
  s_waitcnt lgkmcnt(4)
  v_mfma_f32_32x32x16_bf16 v[160:175], v[192:195], v[36:39], v[160:175]
  v_mfma_f32_32x32x16_bf16 v[176:191], v[196:199], v[36:39], v[176:191]
  s_waitcnt vmcnt(0)
  v_max3_u32 v14, v40, v41, v42
  v_max_u32 v14, v14, v43
  v_cmp_eq_u32 vcc, -1, v14
  s_cbranch_vccnz L_vslow_150
L_vok_149:
  s_waitcnt lgkmcnt(0)
  v_mfma_f32_32x32x16_bf16 v[160:175], v[200:203], v[40:43], v[160:175]
  v_mfma_f32_32x32x16_bf16 v[176:191], v[204:207], v[40:43], v[176:191]
  v_mfma_f32_4x4x4_16b_bf16 v[64:67], v[248:249], v[224:225], 0
  v_mfma_f32_4x4x4_16b_bf16 v[68:71], v[248:249], v[226:227], 0
  s_nop 8
  v_cvt_pk_bf16_f32 v16, v160, v161
  v_cvt_pk_bf16_f32 v17, v162, v163
  v_cvt_pk_bf16_f32 v18, v164, v165
  v_cvt_pk_bf16_f32 v19, v166, v167
  ds_write_b128 v240, v[16:19] offset:4096
  v_cvt_pk_bf16_f32 v20, v168, v169
  v_cvt_pk_bf16_f32 v21, v170, v171
  v_cvt_pk_bf16_f32 v22, v172, v173
  v_cvt_pk_bf16_f32 v23, v174, v175
  ds_write_b128 v241, v[20:23] offset:4096
  v_cvt_pk_bf16_f32 v24, v176, v177
  v_cvt_pk_bf16_f32 v25, v178, v179
  v_cvt_pk_bf16_f32 v26, v180, v181
  v_cvt_pk_bf16_f32 v27, v182, v183
  ds_write_b128 v242, v[24:27] offset:4096
  v_cvt_pk_bf16_f32 v28, v184, v185
  v_cvt_pk_bf16_f32 v29, v186, v187
  v_cvt_pk_bf16_f32 v30, v188, v189
  v_cvt_pk_bf16_f32 v31, v190, v191
  ds_write_b128 v243, v[28:31] offset:4096
  s_mov_b32 m0, s52
  s_lshl_b32 s56, s82, 13
  s_add_u32 s56, s56, 4194688
  buffer_load_dwordx4 v246, s[32:35], s56 offen sc1 lds
  s_waitcnt lgkmcnt(0)
  s_barrier
  ds_read_b128 v[72:75], v244 offset:3072
  ds_read_b128 v[76:79], v244 offset:7168
  ds_read_b128 v[80:83], v245 offset:3072
  ds_read_b128 v[84:87], v245 offset:7168
  s_waitcnt lgkmcnt(3)
  v_mfma_f32_4x4x4_16b_bf16 v[64:67], v[248:249], v[72:73], v[64:67]
  v_mfma_f32_4x4x4_16b_bf16 v[68:71], v[248:249], v[74:75], v[68:71]
  s_waitcnt lgkmcnt(2)
  v_mfma_f32_4x4x4_16b_bf16 v[64:67], v[248:249], v[76:77], v[64:67]
  v_mfma_f32_4x4x4_16b_bf16 v[68:71], v[248:249], v[78:79], v[68:71]
  s_waitcnt lgkmcnt(1)
  v_mfma_f32_4x4x4_16b_bf16 v[64:67], v[248:249], v[80:81], v[64:67]
  v_mfma_f32_4x4x4_16b_bf16 v[68:71], v[248:249], v[82:83], v[68:71]
  s_waitcnt lgkmcnt(0)
  v_mfma_f32_4x4x4_16b_bf16 v[64:67], v[248:249], v[84:85], v[64:67]
  v_mfma_f32_4x4x4_16b_bf16 v[68:71], v[248:249], v[86:87], v[68:71]
  s_waitcnt vmcnt(0)
  ds_read_b128 v[88:91], v247
  s_waitcnt lgkmcnt(0)
  v_max3_u32 v11, v88, v89, v90
  v_max_u32 v11, v11, v91
  v_cmp_eq_u32 vcc, -1, v11
  s_nop 1
  s_cbranch_vccnz L_xslow_153
L_xok_152:
  v_mfma_f32_4x4x4_16b_bf16 v[64:67], v[248:249], v[88:89], v[64:67]
  v_mfma_f32_4x4x4_16b_bf16 v[68:71], v[248:249], v[90:91], v[68:71]
  s_nop 4
  v_cvt_pk_bf16_f32 v64, v64, v65
  v_cvt_pk_bf16_f32 v65, v66, v67
  v_cvt_pk_bf16_f32 v66, v68, v69
  v_cvt_pk_bf16_f32 v67, v70, v71
  buffer_store_dwordx4 v[64:67], v221, s[28:31], s101 offen sc1
  s_endpgm
.p2align 3
L_Q:
  s_cmp_ge_u32 s36, 4
  s_cbranch_scc1 L_Q1
  buffer_load_dwordx4 v[132:135], v252, s[4:7], s89 offen offset:0
  buffer_load_dwordx4 v[136:139], v252, s[4:7], s89 offen offset:128
  buffer_load_dwordx4 v[140:143], v252, s[4:7], s90 offen offset:0
  buffer_load_dwordx4 v[144:147], v252, s[4:7], s90 offen offset:128
  buffer_load_dwordx4 v[148:151], v252, s[4:7], s91 offen offset:0
  buffer_load_dwordx4 v[152:155], v252, s[4:7], s91 offen offset:128
  s_and_b32 s37, s36, 3
  v_and_b32 v15, 63, v0
  s_lshl_b32 s38, s37, 10
  s_and_b32 s39, s2, 1
  s_lshl3_add_u32 s42, s39, s41
  s_mul_i32 s54, s42, 56
  s_and_b32 s57, s54, 15
  s_sub_u32 s54, s54, s57
  s_add_u32 s54, s54, 896
  s_add_u32 s62, s61, 1
  v_mov_b32 v208, 0x3f803f80
  v_mov_b32 v209, 0x3f803f80
  s_add_u32 s64, s63, 1
  v_mov_b32 v210, 0x3b124925
  v_bfe_u32 v240, v15, 4, 1
  s_add_u32 s66, s65, 1
  v_and_b32 v241, 3, v15
  v_bfe_u32 v242, v15, 2, 2
  s_mul_i32 s60, s60, 172032
  v_lshrrev_b32 v243, 5, v15
  v_mov_b32 v212, 0xffff
  s_mul_i32 s61, s61, 172032
  v_mov_b32 v213, 0
  v_lshlrev_b32 v11, 4, v241
  s_mul_i32 s62, s62, 172032
  v_lshlrev_b64 v[212:213], v11, v[212:213]
  v_lshlrev_b32 v1, 4, v15
  s_mul_i32 s63, s63, 172032
  v_xor_b32 v14, v248, v250
  v_lshlrev_b32 v224, 4, v14
  s_mul_i32 s64, s64, 172032
  v_lshrrev_b32 v14, 1, v250
  v_lshl_add_u32 v224, v14, 12, v224
  s_mul_i32 s65, s65, 172032
  v_and_b32 v14, 1, v250
  v_lshl_add_u32 v224, v14, 9, v224
  s_mul_i32 s66, s66, 172032
  v_lshl_add_u32 v224, s55, 10, v224
  v_add_u32 v225, 0x10000, v224
  s_mov_b64 s[84:85], s[14:15]
  v_xor_b32 v226, 2048, v224
  s_mov_b64 s[86:87], s[16:17]
  v_xor_b32 v227, 2048, v225
  v_xor_b32 v249, v242, v240
  s_mov_b64 s[24:25], s[18:19]
  v_and_b32 v249, 1, v249
  v_mul_u32_u24 v2, 2688, v248
  s_mov_b64 s[16:17], s[10:11]
  v_mul_u32_u24 v14, 896, v249
  v_add3_u32 v2, v2, v14, s54
  s_mov_b64 s[12:13], s[8:9]
  v_add_u32 v2, v11, v2
  v_xor_b32 v14, v243, v15
  s_mov_b64 s[8:9], s[82:83]
  v_lshl_add_u32 v244, v14, 4, s38
  v_xor_b32 v245, 32, v244
  s_mov_b32 s10, 1204224
  v_xor_b32 v246, 64, v244
  v_xor_b32 v247, 96, v244
  s_mov_b32 s11, 0x20000
  v_lshl_add_u32 v11, v240, 2, v241
  v_lshl_add_u32 v11, v11, 3, s57
  s_mov_b32 s34, 268435456
  v_and_b32 v11, 63, v11
  v_lshrrev_b32 v12, 1, v242
  s_mov_b32 s35, 0x20000
  v_xor_b32 v12, 0, v12
  v_lshl_add_u32 v11, v12, 6, v11
  s_mov_b32 s14, 25088
  v_lshl_add_u32 v11, v242, 7, v11
  v_lshl_add_u32 v220, v243, 10, v11
  s_mov_b32 s15, 0x20000
  v_add_u32 v220, 98304, v220
  s_mul_i32 s51, s39, 12544
  s_add_u32 s51, s51, s38
  v_lshrrev_b32 v11, 4, v15
  v_lshlrev_b32 v12, 2, v11
  v_and_b32 v13, 15, v15
  v_xor_b32 v12, v12, v13
  v_min_u32 v12, 13, v12
  v_lshl_add_u32 v11, s37, 2, v11
  v_mul_u32_u24 v3, 2688, v11
  v_lshl_add_u32 v3, v12, 4, v3
  s_mul_i32 s54, s39, 448
  v_add_u32 v3, s54, v3
  s_waitcnt lgkmcnt(0)
  s_load_dword s44, s[32:33], 0
  v_lshl_add_u32 v11, v240, 2, v241
  v_lshlrev_b32 v11, 3, v11
  v_add_u32 v11, 0, v11
  v_lshlrev_b32 v12, 6, v242
  v_xor_b32 v11, v11, v12
  v_lshl_add_u32 v11, v242, 8, v11
  v_lshl_add_u32 v6, v243, 11, v11
  v_lshl_add_u32 v11, v240, 2, v241
  v_lshlrev_b32 v11, 3, v11
  v_add_u32 v11, 112, v11
  v_lshlrev_b32 v12, 6, v242
  v_xor_b32 v11, v11, v12
  v_lshl_add_u32 v11, v242, 8, v11
  v_lshl_add_u32 v7, v243, 11, v11
  s_lshl2_add_u32 s50, s40, s37
  s_mul_i32 s50, s50, 147456
  s_add_u32 s50, s50, 8388608
  v_lshl_add_u32 v11, v243, 2, v242
  v_mul_u32_u24 v11, 56, v11
  v_lshl_add_u32 v12, v240, 2, v241
  v_lshl_add_u32 v221, v12, 3, v11
  v_lshl_add_u32 v8, v243, 18, v221
  v_and_b32 v11, 1, v15
  v_bfe_u32 v12, v15, 1, 1
  v_lshl_add_u32 v11, v12, 2, v11
  v_bfe_u32 v12, v15, 2, 1
  v_xor_b32 v12, v12, v243
  v_lshl_add_u32 v11, v12, 1, v11
  v_and_b32 v12, 31, v15
  v_lshl_add_u32 v12, s37, 5, v12
  v_lshlrev_b32 v12, 7, v12
  v_lshl_add_u32 v223, v11, 4, v12
  s_setprio 1
  s_waitcnt vmcnt(6)
  v_mfma_f32_4x4x4_16b_bf16 v[192:195], v[208:209], v[128:129], 0
  v_mfma_f32_4x4x4_16b_bf16 v[196:199], v[128:129], v[128:129], 0
  v_mfma_f32_4x4x4_16b_bf16 v[200:203], v[208:209], v[130:131], 0
  v_mfma_f32_4x4x4_16b_bf16 v[204:207], v[130:131], v[130:131], 0
  s_waitcnt vmcnt(5)
  v_mfma_f32_4x4x4_16b_bf16 v[192:195], v[208:209], v[132:133], v[192:195]
  v_mfma_f32_4x4x4_16b_bf16 v[196:199], v[132:133], v[132:133], v[196:199]
  v_mfma_f32_4x4x4_16b_bf16 v[200:203], v[208:209], v[134:135], v[200:203]
  v_mfma_f32_4x4x4_16b_bf16 v[204:207], v[134:135], v[134:135], v[204:207]
  s_waitcnt vmcnt(4)
  v_mfma_f32_4x4x4_16b_bf16 v[192:195], v[208:209], v[136:137], v[192:195]
  v_mfma_f32_4x4x4_16b_bf16 v[196:199], v[136:137], v[136:137], v[196:199]
  v_mfma_f32_4x4x4_16b_bf16 v[200:203], v[208:209], v[138:139], v[200:203]
  v_mfma_f32_4x4x4_16b_bf16 v[204:207], v[138:139], v[138:139], v[204:207]
  s_waitcnt vmcnt(3)
  v_mfma_f32_4x4x4_16b_bf16 v[192:195], v[208:209], v[140:141], v[192:195]
  v_mfma_f32_4x4x4_16b_bf16 v[196:199], v[140:141], v[140:141], v[196:199]
  v_mfma_f32_4x4x4_16b_bf16 v[200:203], v[208:209], v[142:143], v[200:203]
  v_mfma_f32_4x4x4_16b_bf16 v[204:207], v[142:143], v[142:143], v[204:207]
  s_waitcnt vmcnt(2)
  v_mfma_f32_4x4x4_16b_bf16 v[192:195], v[208:209], v[144:145], v[192:195]
  buffer_load_dwordx4 v[156:159], v254, s[4:7], s88 offen offset:0
  v_mfma_f32_4x4x4_16b_bf16 v[196:199], v[144:145], v[144:145], v[196:199]
  v_mfma_f32_4x4x4_16b_bf16 v[200:203], v[208:209], v[146:147], v[200:203]
  v_mfma_f32_4x4x4_16b_bf16 v[204:207], v[146:147], v[146:147], v[204:207]
  s_waitcnt vmcnt(2)
  v_mfma_f32_4x4x4_16b_bf16 v[192:195], v[208:209], v[148:149], v[192:195]
  buffer_load_dwordx4 v[160:163], v254, s[4:7], s89 offen offset:0
  v_mfma_f32_4x4x4_16b_bf16 v[196:199], v[148:149], v[148:149], v[196:199]
  v_mfma_f32_4x4x4_16b_bf16 v[200:203], v[208:209], v[150:151], v[200:203]
  v_mfma_f32_4x4x4_16b_bf16 v[204:207], v[150:151], v[150:151], v[204:207]
  s_waitcnt vmcnt(2)
  v_mfma_f32_4x4x4_16b_bf16 v[192:195], v[208:209], v[152:153], v[192:195]
  buffer_load_dwordx4 v[164:167], v254, s[4:7], s89 offen offset:128
  v_mfma_f32_4x4x4_16b_bf16 v[196:199], v[152:153], v[152:153], v[196:199]
  v_mfma_f32_4x4x4_16b_bf16 v[200:203], v[208:209], v[154:155], v[200:203]
  v_mfma_f32_4x4x4_16b_bf16 v[204:207], v[154:155], v[154:155], v[204:207]
  buffer_load_dwordx4 v[168:171], v254, s[4:7], s90 offen offset:0
  s_nop 3
  v_add_f32 v192, v192, v200
  v_add_f32 v196, v196, v204
  v_add_f32 v197, v197, v205
  v_add_f32 v198, v198, v206
  v_add_f32 v199, v199, v207
  v_add_f32_dpp v216, v192, v192 quad_perm:[1,0,3,2] row_mask:0xf bank_mask:0xf
  v_mov_b32_dpp v217, v196 quad_perm:[0,0,0,0] row_mask:0xf bank_mask:0xf
  v_mov_b32_dpp v218, v197 quad_perm:[1,1,1,1] row_mask:0xf bank_mask:0xf
  v_add_f32_dpp v216, v216, v216 quad_perm:[2,3,0,1] row_mask:0xf bank_mask:0xf
  v_add_f32_dpp v217, v198, v217 quad_perm:[2,2,2,2] row_mask:0xf bank_mask:0xf
  v_add_f32_dpp v218, v199, v218 quad_perm:[3,3,3,3] row_mask:0xf bank_mask:0xf
  v_add_f32_dpp v216, v216, v216 row_half_mirror row_mask:0xf bank_mask:0xf
  v_add_f32 v217, v217, v218
  v_mul_f32 v216, 0xbb124925, v216
  v_mul_f32 v218, v216, v216
  v_add_f32_dpp v217, v217, v217 row_half_mirror row_mask:0xf bank_mask:0xf
  buffer_load_dwordx4 v[172:175], v254, s[4:7], s90 offen offset:128
  v_fma_f32 v217, v217, v210, -v218
  v_max_f32 v217, 0, v217
  v_add_f32 v217, 0x3727c5ac, v217
  v_rsq_f32 v217, v217
  s_nop 0
  v_cvt_pk_bf16_f32 v218, v217, v217
  v_and_b32 v184, v212, v218
  v_and_b32 v185, v213, v218
  v_and_b32 v218, 0xffff0000, v218
  v_sub_f32 v218, v217, v218
  v_cvt_pk_bf16_f32 v218, v218, v218
  v_and_b32 v186, v212, v218
  v_and_b32 v187, v213, v218
  v_mul_f32 v188, v216, v217
  v_mul_f32 v189, v216, v217
  v_mul_f32 v190, v216, v217
  v_mul_f32 v191, v216, v217
  s_nop 1
  v_mfma_f32_4x4x4_16b_bf16 v[16:19], v[184:185], v[128:129], v[188:191]
  v_mfma_f32_4x4x4_16b_bf16 v[20:23], v[184:185], v[130:131], v[188:191]
  v_mfma_f32_4x4x4_16b_bf16 v[24:27], v[184:185], v[132:133], v[188:191]
  v_mfma_f32_4x4x4_16b_bf16 v[16:19], v[186:187], v[128:129], v[16:19]
  v_mfma_f32_4x4x4_16b_bf16 v[20:23], v[186:187], v[130:131], v[20:23]
  v_mfma_f32_4x4x4_16b_bf16 v[28:31], v[184:185], v[134:135], v[188:191]
  s_nop 3
  v_cvt_pk_bf16_f32 v128, v16, v17
  v_mfma_f32_4x4x4_16b_bf16 v[24:27], v[186:187], v[132:133], v[24:27]
  v_cvt_pk_bf16_f32 v129, v18, v19
  v_mfma_f32_4x4x4_16b_bf16 v[32:35], v[184:185], v[136:137], v[188:191]
  v_cvt_pk_bf16_f32 v130, v20, v21
  v_mfma_f32_4x4x4_16b_bf16 v[28:31], v[186:187], v[134:135], v[28:31]
  v_cvt_pk_bf16_f32 v131, v22, v23
  ds_write_b128 v224, v[128:131] offset:0
  buffer_load_dwordx4 v[176:179], v254, s[4:7], s91 offen offset:0
  v_mfma_f32_4x4x4_16b_bf16 v[36:39], v[184:185], v[138:139], v[188:191]
  v_cvt_pk_bf16_f32 v132, v24, v25
  v_mfma_f32_4x4x4_16b_bf16 v[32:35], v[186:187], v[136:137], v[32:35]
  v_cvt_pk_bf16_f32 v133, v26, v27
  v_mfma_f32_4x4x4_16b_bf16 v[40:43], v[184:185], v[140:141], v[188:191]
  v_cvt_pk_bf16_f32 v134, v28, v29
  v_mfma_f32_4x4x4_16b_bf16 v[36:39], v[186:187], v[138:139], v[36:39]
  v_cvt_pk_bf16_f32 v135, v30, v31
  ds_write_b128 v224, v[132:135] offset:16384
  buffer_load_dwordx4 v[180:183], v254, s[4:7], s91 offen offset:128
  v_mfma_f32_4x4x4_16b_bf16 v[44:47], v[184:185], v[142:143], v[188:191]
  v_cvt_pk_bf16_f32 v136, v32, v33
  v_mfma_f32_4x4x4_16b_bf16 v[40:43], v[186:187], v[140:141], v[40:43]
  v_cvt_pk_bf16_f32 v137, v34, v35
  v_mfma_f32_4x4x4_16b_bf16 v[48:51], v[184:185], v[144:145], v[188:191]
  v_cvt_pk_bf16_f32 v138, v36, v37
  v_mfma_f32_4x4x4_16b_bf16 v[44:47], v[186:187], v[142:143], v[44:47]
  v_cvt_pk_bf16_f32 v139, v38, v39
  ds_write_b128 v224, v[136:139] offset:32768
  v_mfma_f32_4x4x4_16b_bf16 v[52:55], v[184:185], v[146:147], v[188:191]
  v_cvt_pk_bf16_f32 v140, v40, v41
  v_mfma_f32_4x4x4_16b_bf16 v[48:51], v[186:187], v[144:145], v[48:51]
  v_cvt_pk_bf16_f32 v141, v42, v43
  v_mfma_f32_4x4x4_16b_bf16 v[56:59], v[184:185], v[148:149], v[188:191]
  v_cvt_pk_bf16_f32 v142, v44, v45
  v_mfma_f32_4x4x4_16b_bf16 v[52:55], v[186:187], v[146:147], v[52:55]
  v_cvt_pk_bf16_f32 v143, v46, v47
  ds_write_b128 v224, v[140:143] offset:49152
  v_mfma_f32_4x4x4_16b_bf16 v[60:63], v[184:185], v[150:151], v[188:191]
  v_cvt_pk_bf16_f32 v144, v48, v49
  v_mfma_f32_4x4x4_16b_bf16 v[56:59], v[186:187], v[148:149], v[56:59]
  v_cvt_pk_bf16_f32 v145, v50, v51
  v_mfma_f32_4x4x4_16b_bf16 v[64:67], v[184:185], v[152:153], v[188:191]
  v_cvt_pk_bf16_f32 v146, v52, v53
  v_mfma_f32_4x4x4_16b_bf16 v[60:63], v[186:187], v[150:151], v[60:63]
  v_cvt_pk_bf16_f32 v147, v54, v55
  ds_write_b128 v225, v[144:147] offset:0
  v_mfma_f32_4x4x4_16b_bf16 v[68:71], v[184:185], v[154:155], v[188:191]
  v_cvt_pk_bf16_f32 v148, v56, v57
  v_mfma_f32_4x4x4_16b_bf16 v[64:67], v[186:187], v[152:153], v[64:67]
  v_cvt_pk_bf16_f32 v149, v58, v59
  v_cvt_pk_bf16_f32 v150, v60, v61
  v_mfma_f32_4x4x4_16b_bf16 v[68:71], v[186:187], v[154:155], v[68:71]
  v_cvt_pk_bf16_f32 v151, v62, v63
  ds_write_b128 v225, v[148:151] offset:16384
  s_nop 0
  v_cvt_pk_bf16_f32 v152, v64, v65
  v_cvt_pk_bf16_f32 v153, v66, v67
  s_nop 0
  v_cvt_pk_bf16_f32 v154, v68, v69
  v_cvt_pk_bf16_f32 v155, v70, v71
  ds_write_b128 v225, v[152:155] offset:32768
  s_setprio 0
  s_waitcnt vmcnt(6)
  v_mfma_f32_4x4x4_16b_bf16 v[192:195], v[208:209], v[156:157], 0
  v_mfma_f32_4x4x4_16b_bf16 v[196:199], v[156:157], v[156:157], 0
  v_mfma_f32_4x4x4_16b_bf16 v[200:203], v[208:209], v[158:159], 0
  v_mfma_f32_4x4x4_16b_bf16 v[204:207], v[158:159], v[158:159], 0
  s_waitcnt vmcnt(5)
  v_mfma_f32_4x4x4_16b_bf16 v[192:195], v[208:209], v[160:161], v[192:195]
  s_add_u32 m0, s38, 114688
  s_add_u32 s46, s60, 0
  buffer_load_dwordx4 v2, s[8:11], s46 offen lds
  v_mfma_f32_4x4x4_16b_bf16 v[196:199], v[160:161], v[160:161], v[196:199]
  v_mfma_f32_4x4x4_16b_bf16 v[200:203], v[208:209], v[162:163], v[200:203]
  v_mfma_f32_4x4x4_16b_bf16 v[204:207], v[162:163], v[162:163], v[204:207]
  s_waitcnt vmcnt(5)
  v_mfma_f32_4x4x4_16b_bf16 v[192:195], v[208:209], v[164:165], v[192:195]
  v_mfma_f32_4x4x4_16b_bf16 v[196:199], v[164:165], v[164:165], v[196:199]
  v_mfma_f32_4x4x4_16b_bf16 v[200:203], v[208:209], v[166:167], v[200:203]
  v_mfma_f32_4x4x4_16b_bf16 v[204:207], v[166:167], v[166:167], v[204:207]
  s_waitcnt vmcnt(4)
  v_mfma_f32_4x4x4_16b_bf16 v[192:195], v[208:209], v[168:169], v[192:195]
  v_mfma_f32_4x4x4_16b_bf16 v[196:199], v[168:169], v[168:169], v[196:199]
  v_mfma_f32_4x4x4_16b_bf16 v[200:203], v[208:209], v[170:171], v[200:203]
  v_mfma_f32_4x4x4_16b_bf16 v[204:207], v[170:171], v[170:171], v[204:207]
  s_waitcnt vmcnt(3)
  v_mfma_f32_4x4x4_16b_bf16 v[192:195], v[208:209], v[172:173], v[192:195]
  v_mfma_f32_4x4x4_16b_bf16 v[196:199], v[172:173], v[172:173], v[196:199]
  v_mfma_f32_4x4x4_16b_bf16 v[200:203], v[208:209], v[174:175], v[200:203]
  v_mfma_f32_4x4x4_16b_bf16 v[204:207], v[174:175], v[174:175], v[204:207]
  s_waitcnt vmcnt(2)
  v_mfma_f32_4x4x4_16b_bf16 v[192:195], v[208:209], v[176:177], v[192:195]
  s_add_u32 m0, s38, 122880
  s_add_u32 s46, s61, 0
  buffer_load_dwordx4 v2, s[8:11], s46 offen lds
  v_mfma_f32_4x4x4_16b_bf16 v[196:199], v[176:177], v[176:177], v[196:199]
  v_mfma_f32_4x4x4_16b_bf16 v[200:203], v[208:209], v[178:179], v[200:203]
  v_mfma_f32_4x4x4_16b_bf16 v[204:207], v[178:179], v[178:179], v[204:207]
  s_waitcnt vmcnt(2)
  v_mfma_f32_4x4x4_16b_bf16 v[192:195], v[208:209], v[180:181], v[192:195]
  v_mfma_f32_4x4x4_16b_bf16 v[196:199], v[180:181], v[180:181], v[196:199]
  v_mfma_f32_4x4x4_16b_bf16 v[200:203], v[208:209], v[182:183], v[200:203]
  v_mfma_f32_4x4x4_16b_bf16 v[204:207], v[182:183], v[182:183], v[204:207]
  s_nop 4
  v_add_f32 v192, v192, v200
  v_add_f32 v196, v196, v204
  v_add_f32 v197, v197, v205
  v_add_f32 v198, v198, v206
  v_add_f32 v199, v199, v207
  v_add_f32_dpp v216, v192, v192 quad_perm:[1,0,3,2] row_mask:0xf bank_mask:0xf
  v_mov_b32_dpp v217, v196 quad_perm:[0,0,0,0] row_mask:0xf bank_mask:0xf
  v_mov_b32_dpp v218, v197 quad_perm:[1,1,1,1] row_mask:0xf bank_mask:0xf
  v_add_f32_dpp v216, v216, v216 quad_perm:[2,3,0,1] row_mask:0xf bank_mask:0xf
  v_add_f32_dpp v217, v198, v217 quad_perm:[2,2,2,2] row_mask:0xf bank_mask:0xf
  v_add_f32_dpp v218, v199, v218 quad_perm:[3,3,3,3] row_mask:0xf bank_mask:0xf
  v_add_f32_dpp v216, v216, v216 row_half_mirror row_mask:0xf bank_mask:0xf
  v_add_f32 v217, v217, v218
  v_mul_f32 v216, 0xbb124925, v216
  v_mul_f32 v218, v216, v216
  v_add_f32_dpp v217, v217, v217 row_half_mirror row_mask:0xf bank_mask:0xf
  v_fma_f32 v217, v217, v210, -v218
  v_max_f32 v217, 0, v217
  v_add_f32 v217, 0x3727c5ac, v217
  v_rsq_f32 v217, v217
  s_nop 0
  v_cvt_pk_bf16_f32 v218, v217, v217
  v_and_b32 v184, v212, v218
  v_and_b32 v185, v213, v218
  v_and_b32 v218, 0xffff0000, v218
  v_sub_f32 v218, v217, v218
  v_cvt_pk_bf16_f32 v218, v218, v218
  v_and_b32 v186, v212, v218
  v_and_b32 v187, v213, v218
  v_mul_f32 v188, v216, v217
  v_mul_f32 v189, v216, v217
  v_mul_f32 v190, v216, v217
  v_mul_f32 v191, v216, v217
  s_nop 1
  v_mfma_f32_4x4x4_16b_bf16 v[72:75], v[184:185], v[156:157], v[188:191]
  v_mfma_f32_4x4x4_16b_bf16 v[76:79], v[184:185], v[158:159], v[188:191]
  v_mfma_f32_4x4x4_16b_bf16 v[80:83], v[184:185], v[160:161], v[188:191]
  v_mfma_f32_4x4x4_16b_bf16 v[72:75], v[186:187], v[156:157], v[72:75]
  v_mfma_f32_4x4x4_16b_bf16 v[76:79], v[186:187], v[158:159], v[76:79]
  v_mfma_f32_4x4x4_16b_bf16 v[84:87], v[184:185], v[162:163], v[188:191]
  s_nop 3
  v_cvt_pk_bf16_f32 v156, v72, v73
  v_mfma_f32_4x4x4_16b_bf16 v[80:83], v[186:187], v[160:161], v[80:83]
  v_cvt_pk_bf16_f32 v157, v74, v75
  v_mfma_f32_4x4x4_16b_bf16 v[88:91], v[184:185], v[164:165], v[188:191]
  v_cvt_pk_bf16_f32 v158, v76, v77
  v_mfma_f32_4x4x4_16b_bf16 v[84:87], v[186:187], v[162:163], v[84:87]
  v_cvt_pk_bf16_f32 v159, v78, v79
  ds_write_b128 v226, v[156:159] offset:0
  v_mfma_f32_4x4x4_16b_bf16 v[92:95], v[184:185], v[166:167], v[188:191]
  v_cvt_pk_bf16_f32 v160, v80, v81
  v_mfma_f32_4x4x4_16b_bf16 v[88:91], v[186:187], v[164:165], v[88:91]
  v_cvt_pk_bf16_f32 v161, v82, v83
  v_mfma_f32_4x4x4_16b_bf16 v[96:99], v[184:185], v[168:169], v[188:191]
  v_cvt_pk_bf16_f32 v162, v84, v85
  v_mfma_f32_4x4x4_16b_bf16 v[92:95], v[186:187], v[166:167], v[92:95]
  v_cvt_pk_bf16_f32 v163, v86, v87
  ds_write_b128 v226, v[160:163] offset:16384
  s_add_u32 m0, s38, 131072
  s_add_u32 s46, s62, 0
  buffer_load_dwordx4 v2, s[8:11], s46 offen lds
  v_mfma_f32_4x4x4_16b_bf16 v[100:103], v[184:185], v[170:171], v[188:191]
  v_cvt_pk_bf16_f32 v164, v88, v89
  v_mfma_f32_4x4x4_16b_bf16 v[96:99], v[186:187], v[168:169], v[96:99]
  v_cvt_pk_bf16_f32 v165, v90, v91
  v_mfma_f32_4x4x4_16b_bf16 v[104:107], v[184:185], v[172:173], v[188:191]
  v_cvt_pk_bf16_f32 v166, v92, v93
  v_mfma_f32_4x4x4_16b_bf16 v[100:103], v[186:187], v[170:171], v[100:103]
  v_cvt_pk_bf16_f32 v167, v94, v95
  ds_write_b128 v226, v[164:167] offset:32768
  v_mfma_f32_4x4x4_16b_bf16 v[108:111], v[184:185], v[174:175], v[188:191]
  v_cvt_pk_bf16_f32 v168, v96, v97
  v_mfma_f32_4x4x4_16b_bf16 v[104:107], v[186:187], v[172:173], v[104:107]
  v_cvt_pk_bf16_f32 v169, v98, v99
  v_mfma_f32_4x4x4_16b_bf16 v[112:115], v[184:185], v[176:177], v[188:191]
  v_cvt_pk_bf16_f32 v170, v100, v101
  v_mfma_f32_4x4x4_16b_bf16 v[108:111], v[186:187], v[174:175], v[108:111]
  v_cvt_pk_bf16_f32 v171, v102, v103
  ds_write_b128 v226, v[168:171] offset:49152
  v_mfma_f32_4x4x4_16b_bf16 v[116:119], v[184:185], v[178:179], v[188:191]
  v_cvt_pk_bf16_f32 v172, v104, v105
  v_mfma_f32_4x4x4_16b_bf16 v[112:115], v[186:187], v[176:177], v[112:115]
  v_cvt_pk_bf16_f32 v173, v106, v107
  v_mfma_f32_4x4x4_16b_bf16 v[120:123], v[184:185], v[180:181], v[188:191]
  v_cvt_pk_bf16_f32 v174, v108, v109
  v_mfma_f32_4x4x4_16b_bf16 v[116:119], v[186:187], v[178:179], v[116:119]
  v_cvt_pk_bf16_f32 v175, v110, v111
  ds_write_b128 v227, v[172:175] offset:0
  s_add_u32 m0, s38, 135168
  s_add_u32 s46, s62, 86016
  buffer_load_dwordx4 v2, s[8:11], s46 offen lds
  v_mfma_f32_4x4x4_16b_bf16 v[124:127], v[184:185], v[182:183], v[188:191]
  v_cvt_pk_bf16_f32 v176, v112, v113
  v_mfma_f32_4x4x4_16b_bf16 v[120:123], v[186:187], v[180:181], v[120:123]
  v_cvt_pk_bf16_f32 v177, v114, v115
  v_cvt_pk_bf16_f32 v178, v116, v117
  v_mfma_f32_4x4x4_16b_bf16 v[124:127], v[186:187], v[182:183], v[124:127]
  v_cvt_pk_bf16_f32 v179, v118, v119
  ds_write_b128 v227, v[176:179] offset:16384
  s_nop 0
  v_cvt_pk_bf16_f32 v180, v120, v121
  v_cvt_pk_bf16_f32 v181, v122, v123
  s_nop 0
  v_cvt_pk_bf16_f32 v182, v124, v125
  v_cvt_pk_bf16_f32 v183, v126, v127
  ds_write_b128 v227, v[180:183] offset:32768
  s_add_u32 m0, s38, 139264
  s_add_u32 s46, s63, 0
  buffer_load_dwordx4 v2, s[8:11], s46 offen lds
  s_add_u32 m0, s38, 143360
  s_add_u32 s46, s63, 86016
  buffer_load_dwordx4 v2, s[8:11], s46 offen lds
  s_add_u32 m0, s38, 147456
  s_add_u32 s46, s64, 0
  buffer_load_dwordx4 v2, s[8:11], s46 offen lds
  s_add_u32 m0, s38, 151552
  s_add_u32 s46, s64, 86016
  buffer_load_dwordx4 v2, s[8:11], s46 offen lds
  s_add_u32 m0, s38, 155648
  s_add_u32 s46, s65, 0
  buffer_load_dwordx4 v2, s[8:11], s46 offen lds
  s_add_u32 m0, s38, 159744
  s_add_u32 s46, s65, 86016
  buffer_load_dwordx4 v2, s[8:11], s46 offen lds
  s_waitcnt vmcnt(8) lgkmcnt(0)
  s_barrier
  ds_read_b128 v[16:19], v244 offset:0
  ds_read_b64_tr_b16 v[192:193], v220 offset:16384
  ds_read_b64_tr_b16 v[194:195], v220 offset:16896
  ds_read_b128 v[20:23], v245 offset:4096
  ds_read_b64_tr_b16 v[196:197], v220 offset:18432
  ds_read_b64_tr_b16 v[198:199], v220 offset:18944
  ds_read_b128 v[24:27], v246 offset:8192
  ds_read_b64_tr_b16 v[200:201], v220 offset:20480
  ds_read_b64_tr_b16 v[202:203], v220 offset:20992
  ds_read_b128 v[28:31], v247 offset:12288
  ds_read_b64_tr_b16 v[204:205], v220 offset:22528
  ds_read_b64_tr_b16 v[206:207], v220 offset:23040
  ds_read_b64_tr_b16 v[208:209], v220 offset:24576
  ds_read_b64_tr_b16 v[210:211], v220 offset:25088
  s_waitcnt lgkmcnt(8)
  v_mfma_f32_32x32x16_bf16 v[160:175], v[192:195], v[16:19], 0
  ds_read_b128 v[32:35], v244 offset:16384
  s_mul_i32 s43, s44, 0x9E3779B1
  s_add_u32 s43, s43, 0x7F4A7C15
  ds_read_b64_tr_b16 v[212:213], v220 offset:26624
  ds_read_b64_tr_b16 v[214:215], v220 offset:27136
  v_mfma_f32_32x32x16_bf16 v[160:175], v[196:199], v[20:23], v[160:175]
  ds_read_b128 v[36:39], v245 offset:20480
  s_and_b32 s45, s44, 0xfff
  s_add_u32 s45, s45, 1
  ds_read_b64_tr_b16 v[192:193], v220 offset:28672
  ds_read_b64_tr_b16 v[194:195], v220 offset:29184
  s_waitcnt lgkmcnt(8)
  v_mfma_f32_32x32x16_bf16 v[160:175], v[200:203], v[24:27], v[160:175]
  ds_read_b128 v[40:43], v246 offset:24576
  s_lshl_b32 s45, s45, 16
  s_add_u32 s45, s45, s44
  ds_read_b64_tr_b16 v[196:197], v220 offset:30720
  ds_read_b64_tr_b16 v[198:199], v220 offset:31232
  s_waitcnt vmcnt(4)
  s_waitcnt lgkmcnt(8)
  v_mfma_f32_32x32x16_bf16 v[160:175], v[204:207], v[28:31], v[160:175]
  s_barrier
  v_mfma_f32_32x32x16_bf16 v[160:175], v[208:211], v[32:35], v[160:175]
  ds_read_b64_tr_b16 v[200:201], v220 offset:32768
  ds_read_b64_tr_b16 v[202:203], v220 offset:33280
  ds_read_b128 v[44:47], v247 offset:28672
  s_and_b32 s45, s45, 0x1fff0000
  s_or_b32 s45, s45, 0x40000000
  ds_read_b128 v[48:51], v244 offset:32768
  s_add_u32 m0, s38, 114688
  s_add_u32 s46, s66, 0
  buffer_load_dwordx4 v2, s[8:11], s46 offen lds
  ds_read_b64_tr_b16 v[204:205], v220 offset:34816
  ds_read_b64_tr_b16 v[206:207], v220 offset:35328
  s_waitcnt lgkmcnt(9)
  v_mfma_f32_32x32x16_bf16 v[160:175], v[212:215], v[36:39], v[160:175]
  ds_read_b128 v[52:55], v245 offset:36864
  ds_read_b64_tr_b16 v[208:209], v220 offset:36864
  ds_read_b64_tr_b16 v[210:211], v220 offset:37376
  s_waitcnt lgkmcnt(11)
  v_mfma_f32_32x32x16_bf16 v[160:175], v[192:195], v[40:43], v[160:175]
  ds_read_b128 v[56:59], v246 offset:40960
  ds_read_b64_tr_b16 v[212:213], v220 offset:38912
  ds_read_b64_tr_b16 v[214:215], v220 offset:39424
  s_waitcnt lgkmcnt(10)
  s_waitcnt lgkmcnt(9)
  v_mfma_f32_32x32x16_bf16 v[160:175], v[196:199], v[44:47], v[160:175]
  ds_read_b128 v[60:63], v247 offset:45056
  s_add_u32 m0, s38, 0
  s_add_u32 s46, s51, 0
  buffer_load_dwordx4 v1, s[12:15], s46 offen lds
  ds_read_b64_tr_b16 v[192:193], v220 offset:40960
  ds_read_b64_tr_b16 v[194:195], v220 offset:41472
  s_waitcnt lgkmcnt(11)
  v_mfma_f32_32x32x16_bf16 v[160:175], v[200:203], v[48:51], v[160:175]
  ds_read_b128 v[64:67], v244 offset:49152
  ds_read_b64_tr_b16 v[196:197], v220 offset:43008
  ds_read_b64_tr_b16 v[198:199], v220 offset:43520
  s_waitcnt lgkmcnt(9)
  v_mfma_f32_32x32x16_bf16 v[160:175], v[204:207], v[52:55], v[160:175]
  ds_read_b128 v[68:71], v245 offset:53248
  s_add_u32 m0, s38, 8192
  s_add_u32 s46, s51, 8192
  buffer_load_dwordx4 v1, s[12:15], s46 offen lds
  ds_read_b64_tr_b16 v[200:201], v220 offset:45056
  ds_read_b64_tr_b16 v[202:203], v220 offset:45568
  s_waitcnt lgkmcnt(11)
  v_mfma_f32_32x32x16_bf16 v[160:175], v[208:211], v[56:59], v[160:175]
  ds_read_b128 v[72:75], v246 offset:57344
  ds_read_b64_tr_b16 v[204:205], v220 offset:47104
  ds_read_b64_tr_b16 v[206:207], v220 offset:47616
  s_waitcnt vmcnt(3)
  s_waitcnt lgkmcnt(8)
  v_mfma_f32_32x32x16_bf16 v[160:175], v[212:215], v[60:63], v[160:175]
  s_barrier
  v_mfma_f32_32x32x16_bf16 v[160:175], v[192:195], v[64:67], v[160:175]
  ds_read_b64_tr_b16 v[208:209], v220 offset:49152
  ds_read_b64_tr_b16 v[210:211], v220 offset:49664
  ds_read_b128 v[76:79], v247 offset:61440
  v_add_u32 v244, 65536, v244
  ds_read_b128 v[80:83], v244 offset:0
  s_add_u32 m0, s38, 16384
  s_add_u32 s46, s60, 0
  buffer_load_dwordx4 v3, s[8:11], s46 offen lds
  ds_read_b64_tr_b16 v[212:213], v220 offset:51200
  ds_read_b64_tr_b16 v[214:215], v220 offset:51712
  s_waitcnt lgkmcnt(9)
  v_mfma_f32_32x32x16_bf16 v[160:175], v[196:199], v[68:71], v[160:175]
  v_add_u32 v245, 65536, v245
  ds_read_b128 v[84:87], v245 offset:4096
  ds_read_b64_tr_b16 v[192:193], v220 offset:53248
  ds_read_b64_tr_b16 v[194:195], v220 offset:53760
  s_waitcnt lgkmcnt(11)
  v_mfma_f32_32x32x16_bf16 v[160:175], v[200:203], v[72:75], v[160:175]
  v_add_u32 v246, 65536, v246
  ds_read_b128 v[88:91], v246 offset:8192
  s_add_u32 m0, s38, 24576
  s_add_u32 s46, s60, 86016
  buffer_load_dwordx4 v3, s[8:11], s46 offen lds
  ds_read_b64_tr_b16 v[196:197], v220 offset:55296
  ds_read_b64_tr_b16 v[198:199], v220 offset:55808
  s_waitcnt lgkmcnt(10)
  s_waitcnt lgkmcnt(9)
  v_mfma_f32_32x32x16_bf16 v[160:175], v[204:207], v[76:79], v[160:175]
  v_add_u32 v247, 65536, v247
  ds_read_b128 v[92:95], v247 offset:12288
  ds_read_b64_tr_b16 v[200:201], v220 offset:57344
  ds_read_b64_tr_b16 v[202:203], v220 offset:57856
  s_waitcnt lgkmcnt(11)
  v_mfma_f32_32x32x16_bf16 v[160:175], v[208:211], v[80:83], v[160:175]
  ds_read_b128 v[96:99], v244 offset:16384
  s_add_u32 m0, s38, 122880
  s_add_u32 s46, s61, 0
  buffer_load_dwordx4 v3, s[8:11], s46 offen lds
  ds_read_b64_tr_b16 v[204:205], v220 offset:59392
  ds_read_b64_tr_b16 v[206:207], v220 offset:59904
  s_waitcnt lgkmcnt(9)
  v_mfma_f32_32x32x16_bf16 v[160:175], v[212:215], v[84:87], v[160:175]
  ds_read_b128 v[100:103], v245 offset:20480
  ds_read_b64_tr_b16 v[208:209], v220 offset:61440
  ds_read_b64_tr_b16 v[210:211], v220 offset:61952
  s_waitcnt lgkmcnt(11)
  v_mfma_f32_32x32x16_bf16 v[160:175], v[192:195], v[88:91], v[160:175]
  ds_read_b128 v[104:107], v246 offset:24576
  s_add_u32 m0, s38, 131072
  s_add_u32 s46, s61, 86016
  buffer_load_dwordx4 v3, s[8:11], s46 offen lds
  ds_read_b64_tr_b16 v[212:213], v220 offset:63488
  ds_read_b64_tr_b16 v[214:215], v220 offset:64000
  s_waitcnt vmcnt(3)
  s_waitcnt lgkmcnt(8)
  v_mfma_f32_32x32x16_bf16 v[160:175], v[196:199], v[92:95], v[160:175]
  s_barrier
  v_mfma_f32_32x32x16_bf16 v[160:175], v[200:203], v[96:99], v[160:175]
  ds_read_b64_tr_b16 v[192:193], v220 offset:16384
  ds_read_b64_tr_b16 v[194:195], v220 offset:16896
  ds_read_b128 v[108:111], v247 offset:28672
  ds_read_b128 v[112:115], v244 offset:32768
  s_add_u32 m0, s38, 57344
  s_add_u32 s46, s62, 0
  buffer_load_dwordx4 v3, s[8:11], s46 offen lds
  ds_read_b64_tr_b16 v[196:197], v220 offset:18432
  ds_read_b64_tr_b16 v[198:199], v220 offset:18944
  s_waitcnt lgkmcnt(9)
  v_mfma_f32_32x32x16_bf16 v[160:175], v[204:207], v[100:103], v[160:175]
  ds_read_b128 v[116:119], v245 offset:36864
  ds_read_b64_tr_b16 v[200:201], v220 offset:20480
  ds_read_b64_tr_b16 v[202:203], v220 offset:20992
  s_waitcnt lgkmcnt(11)
  v_mfma_f32_32x32x16_bf16 v[160:175], v[208:211], v[104:107], v[160:175]
  ds_read_b128 v[120:123], v246 offset:40960
  s_add_u32 m0, s38, 65536
  s_add_u32 s46, s62, 86016
  buffer_load_dwordx4 v3, s[8:11], s46 offen lds
  ds_read_b64_tr_b16 v[224:225], v221 offset:10976
  ds_read_b64_tr_b16 v[226:227], v221 offset:11424
  ds_read_b64_tr_b16 v[228:229], v221 offset:11872
  ds_read_b64_tr_b16 v[230:231], v8 offset:12320
  v_lshl_add_u32 v14, s37, 11, v1
  ds_read_b64_tr_b16 v[204:205], v220 offset:22528
  ds_read_b64_tr_b16 v[206:207], v220 offset:23040
  s_waitcnt lgkmcnt(14)
  s_waitcnt lgkmcnt(13)
  v_mfma_f32_32x32x16_bf16 v[160:175], v[212:215], v[108:111], v[160:175]
  ds_read_b128 v[124:127], v247 offset:45056
  ds_read_b64_tr_b16 v[208:209], v6 offset:16384
  ds_read_b64_tr_b16 v[210:211], v6 offset:17408
  s_waitcnt vmcnt(3)
  s_waitcnt lgkmcnt(12)
  v_mfma_f32_32x32x16_bf16 v[160:175], v[192:195], v[112:115], v[160:175]
  s_barrier
  v_mfma_f32_32x32x16_bf16 v[160:175], v[196:199], v[116:119], v[160:175]
  ds_read_b64_tr_b16 v[212:213], v6 offset:20480
  ds_read_b64_tr_b16 v[214:215], v6 offset:21504
  s_add_u32 m0, s38, 73728
  s_add_u32 s46, s63, 0
  buffer_load_dwordx4 v3, s[8:11], s46 offen lds
  s_waitcnt lgkmcnt(10)
  v_mov_b32_dpp v224, v224 row_shr:2 row_mask:0xa bank_mask:0x8
  v_mov_b32_dpp v225, v225 row_shr:2 row_mask:0xa bank_mask:0x8
  s_waitcnt lgkmcnt(9)
  v_mov_b32_dpp v226, v226 row_shr:2 row_mask:0xa bank_mask:0x8
  v_mov_b32_dpp v227, v227 row_shr:2 row_mask:0xa bank_mask:0x8
  ds_read_b64_tr_b16 v[192:193], v6 offset:24576
  ds_read_b64_tr_b16 v[194:195], v6 offset:25600
  v_mfma_f32_32x32x16_bf16 v[160:175], v[200:203], v[120:123], v[160:175]
  s_add_u32 m0, s38, 139264
  s_add_u32 s46, s63, 86016
  buffer_load_dwordx4 v3, s[8:11], s46 offen lds
  s_waitcnt lgkmcnt(10)
  v_mov_b32_dpp v228, v228 row_shr:2 row_mask:0xa bank_mask:0x8
  v_mov_b32_dpp v229, v229 row_shr:2 row_mask:0xa bank_mask:0x8
  ds_read_b64_tr_b16 v[196:197], v6 offset:28672
  ds_read_b64_tr_b16 v[198:199], v6 offset:29696
  s_waitcnt lgkmcnt(6)
  v_mfma_f32_32x32x16_bf16 v[160:175], v[204:207], v[124:127], v[160:175]
  v_mov_b32_dpp v230, v230 row_shr:2 row_mask:0xa bank_mask:0x8
  v_mov_b32_dpp v231, v231 row_shr:2 row_mask:0xa bank_mask:0x8
  v_add_u32 v6, 98304, v6
  ds_read_b64_tr_b16 v[200:201], v6 offset:24576
  ds_read_b64_tr_b16 v[202:203], v6 offset:25600
  v_mfma_f32_32x32x16_bf16 v[128:143], v[208:211], v[16:19], 0
  s_add_u32 m0, s38, 147456
  s_add_u32 s46, s64, 0
  buffer_load_dwordx4 v3, s[8:11], s46 offen lds
  ds_read_b64_tr_b16 v[204:205], v6 offset:28672
  ds_read_b64_tr_b16 v[206:207], v6 offset:29696
  s_waitcnt vmcnt(3)
  s_waitcnt lgkmcnt(6)
  v_mfma_f32_32x32x16_bf16 v[128:143], v[212:215], v[20:23], v[128:143]
  s_barrier
  v_mfma_f32_32x32x16_bf16 v[128:143], v[192:195], v[24:27], v[128:143]
  ds_read_b64_tr_b16 v[208:209], v6 offset:32768
  ds_read_b64_tr_b16 v[210:211], v6 offset:33792
  v_cvt_pk_bf16_f32 v232, v160, v161
  v_cvt_pk_bf16_f32 v233, v162, v163
  v_cvt_pk_bf16_f32 v234, v164, v165
  v_cvt_pk_bf16_f32 v235, v166, v167
  v_cvt_pk_bf16_f32 v236, v168, v169
  v_cvt_pk_bf16_f32 v237, v170, v171
  v_cvt_pk_bf16_f32 v238, v172, v173
  v_cvt_pk_bf16_f32 v239, v174, v175
  v_mfma_f32_32x32x16_bf16 v[176:191], v[224:227], v[232:235], 0
  s_nop 0
  v_mfma_f32_32x32x16_bf16 v[176:191], v[228:231], v[236:239], v[176:191]
  s_nop 11
  v_max3_f32 v216, v176, v177, v178
  v_min3_f32 v217, v176, v177, v178
  v_max3_f32 v216, v216, v179, v180
  v_min3_f32 v217, v217, v179, v180
  v_max3_f32 v216, v216, v181, v182
  v_min3_f32 v217, v217, v181, v182
  v_max3_f32 v216, v216, v183, v184
  v_min3_f32 v217, v217, v183, v184
  v_max3_f32 v216, v216, v185, v186
  v_min3_f32 v217, v217, v185, v186
  v_max3_f32 v216, v216, v187, v188
  v_min3_f32 v217, v217, v187, v188
  v_max_f32 v216, v216, v189
  ds_read_b64_tr_b16 v[212:213], v6 offset:36864
  ds_read_b64_tr_b16 v[214:215], v6 offset:37888
  s_waitcnt lgkmcnt(6)
  v_mfma_f32_32x32x16_bf16 v[128:143], v[196:199], v[28:31], v[128:143]
  v_min_f32 v217, v217, v189
  v_mov_b32 v218, v216
  v_mov_b32 v219, v217
  s_nop 0
  v_permlane32_swap_b32 v216, v218
  v_permlane32_swap_b32 v217, v219
  v_max_f32 v216, v216, v218
  v_min_f32 v217, v217, v219
  v_mul_f32 v216, 0xbfb8aa3b, v216
  v_mul_f32 v217, 0x3fb8aa3b, v217
  v_fmamk_f32 v160, v176, 0x3fb8aa3b, v216
  v_fmamk_f32 v176, v176, 0xbfb8aa3b, v217
  v_exp_f32 v160, v160
  v_add_u32 v6, 4294901760, v6
  ds_read_b64_tr_b16 v[192:193], v6 offset:24576
  ds_read_b64_tr_b16 v[194:195], v6 offset:25600
  v_mfma_f32_32x32x16_bf16 v[128:143], v[200:203], v[32:35], v[128:143]
  v_exp_f32 v176, v176
  v_fmamk_f32 v161, v177, 0x3fb8aa3b, v216
  v_fmamk_f32 v177, v177, 0xbfb8aa3b, v217
  v_exp_f32 v161, v161
  v_exp_f32 v177, v177
  v_fmamk_f32 v162, v178, 0x3fb8aa3b, v216
  v_fmamk_f32 v178, v178, 0xbfb8aa3b, v217
  v_exp_f32 v162, v162
  v_exp_f32 v178, v178
  ds_read_b64_tr_b16 v[196:197], v6 offset:28672
  ds_read_b64_tr_b16 v[198:199], v6 offset:29696
  s_waitcnt lgkmcnt(6)
  v_mfma_f32_32x32x16_bf16 v[128:143], v[204:207], v[36:39], v[128:143]
  s_add_u32 m0, s38, 81920
  s_add_u32 s46, s64, 86016
  buffer_load_dwordx4 v3, s[8:11], s46 offen lds
  v_fmamk_f32 v163, v179, 0x3fb8aa3b, v216
  v_fmamk_f32 v179, v179, 0xbfb8aa3b, v217
  v_exp_f32 v163, v163
  v_exp_f32 v179, v179
  v_fmamk_f32 v164, v180, 0x3fb8aa3b, v216
  v_fmamk_f32 v180, v180, 0xbfb8aa3b, v217
  v_exp_f32 v164, v164
  v_exp_f32 v180, v180
  ds_read_b64_tr_b16 v[200:201], v6 offset:32768
  ds_read_b64_tr_b16 v[202:203], v6 offset:33792
  v_mfma_f32_32x32x16_bf16 v[128:143], v[208:211], v[40:43], v[128:143]
  v_fmamk_f32 v165, v181, 0x3fb8aa3b, v216
  v_fmamk_f32 v181, v181, 0xbfb8aa3b, v217
  v_exp_f32 v165, v165
  v_exp_f32 v181, v181
  v_fmamk_f32 v166, v182, 0x3fb8aa3b, v216
  v_fmamk_f32 v182, v182, 0xbfb8aa3b, v217
  v_exp_f32 v166, v166
  v_exp_f32 v182, v182
  v_fmamk_f32 v167, v183, 0x3fb8aa3b, v216
  ds_read_b64_tr_b16 v[204:205], v6 offset:36864
  ds_read_b64_tr_b16 v[206:207], v6 offset:37888
  s_waitcnt vmcnt(1)
  s_waitcnt lgkmcnt(6)
  v_mfma_f32_32x32x16_bf16 v[128:143], v[212:215], v[44:47], v[128:143]
  s_barrier
  v_mfma_f32_32x32x16_bf16 v[128:143], v[192:195], v[48:51], v[128:143]
  ds_read_b64_tr_b16 v[208:209], v6 offset:40960
  ds_read_b64_tr_b16 v[210:211], v6 offset:41984
  v_fmamk_f32 v183, v183, 0xbfb8aa3b, v217
  v_exp_f32 v167, v167
  v_exp_f32 v183, v183
  v_fmamk_f32 v168, v184, 0x3fb8aa3b, v216
  v_fmamk_f32 v184, v184, 0xbfb8aa3b, v217
  v_exp_f32 v168, v168
  v_exp_f32 v184, v184
  v_fmamk_f32 v169, v185, 0x3fb8aa3b, v216
  v_fmamk_f32 v185, v185, 0xbfb8aa3b, v217
  s_add_u32 m0, s38, 90112
  s_add_u32 s46, s65, 0
  buffer_load_dwordx4 v3, s[8:11], s46 offen lds
  v_exp_f32 v169, v169
  v_exp_f32 v185, v185
  v_fmamk_f32 v170, v186, 0x3fb8aa3b, v216
  v_fmamk_f32 v186, v186, 0xbfb8aa3b, v217
  v_exp_f32 v170, v170
  v_exp_f32 v186, v186
  v_fmamk_f32 v171, v187, 0x3fb8aa3b, v216
  v_fmamk_f32 v187, v187, 0xbfb8aa3b, v217
  v_exp_f32 v171, v171
  ds_read_b64_tr_b16 v[212:213], v7 offset:16384
  ds_read_b64_tr_b16 v[214:215], v7 offset:17408
  s_waitcnt lgkmcnt(6)
  v_mfma_f32_32x32x16_bf16 v[128:143], v[196:199], v[52:55], v[128:143]
  v_exp_f32 v187, v187
  v_fmamk_f32 v172, v188, 0x3fb8aa3b, v216
  v_fmamk_f32 v188, v188, 0xbfb8aa3b, v217
  v_exp_f32 v172, v172
  v_exp_f32 v188, v188
  v_fmamk_f32 v173, v189, 0x3fb8aa3b, v216
  v_fmamk_f32 v189, v189, 0xbfb8aa3b, v217
  v_exp_f32 v173, v173
  ds_read_b64_tr_b16 v[192:193], v6 offset:45056
  ds_read_b64_tr_b16 v[194:195], v6 offset:46080
  v_mfma_f32_32x32x16_bf16 v[128:143], v[200:203], v[56:59], v[128:143]
  v_exp_f32 v189, v189
  v_add_f32 v216, v160, v161
  v_add_f32 v217, v176, v177
  v_add_f32 v216, v216, v162
  v_add_f32 v217, v217, v178
  v_add_f32 v216, v216, v163
  v_add_f32 v217, v217, v179
  v_add_f32 v216, v216, v164
  v_add_f32 v217, v217, v180
  v_add_f32 v216, v216, v165
  v_add_f32 v217, v217, v181
  v_add_f32 v216, v216, v166
  v_add_f32 v217, v217, v182
  v_add_f32 v216, v216, v167
  ds_read_b64_tr_b16 v[196:197], v7 offset:20480
  ds_read_b64_tr_b16 v[198:199], v7 offset:21504
  s_waitcnt lgkmcnt(6)
  v_mfma_f32_32x32x16_bf16 v[128:143], v[204:207], v[60:63], v[128:143]
  v_add_f32 v217, v217, v183
  v_add_f32 v216, v216, v168
  v_add_f32 v217, v217, v184
  v_add_f32 v216, v216, v169
  v_add_f32 v217, v217, v185
  v_add_f32 v216, v216, v170
  v_add_f32 v217, v217, v186
  v_add_f32 v216, v216, v171
  v_add_f32 v217, v217, v187
  v_add_f32 v216, v216, v172
  v_add_f32 v217, v217, v188
  v_add_f32 v216, v216, v173
  v_add_f32 v217, v217, v189
  v_mov_b32 v218, v216
  v_mov_b32 v219, v217
  s_nop 0
  v_permlane32_swap_b32 v216, v218
  v_add_u32 v6, 65536, v6
  ds_read_b64_tr_b16 v[200:201], v6 offset:40960
  ds_read_b64_tr_b16 v[202:203], v6 offset:41984
  v_mfma_f32_32x32x16_bf16 v[128:143], v[208:211], v[64:67], v[128:143]
  s_add_u32 m0, s38, 155648
  s_add_u32 s46, s65, 86016
  buffer_load_dwordx4 v3, s[8:11], s46 offen lds
  v_permlane32_swap_b32 v217, v219
  v_add_f32 v216, v216, v218
  v_add_f32 v217, v217, v219
  v_rcp_f32 v216, v216
  v_rcp_f32 v217, v217
  v_xor_b32 v11, 16, v223
  v_xor_b32 v12, 64, v223
  v_xor_b32 v13, 80, v223
  v_mov_b32 v239, 0
  v_mov_b32 v231, 0
  v_mul_f32 v160, v160, v216
  ds_read_b64_tr_b16 v[204:205], v7 offset:24576
  ds_read_b64_tr_b16 v[206:207], v7 offset:25600
  s_waitcnt lgkmcnt(6)
  v_mfma_f32_32x32x16_bf16 v[144:159], v[212:215], v[16:19], 0
  v_mul_f32 v161, v161, v216
  v_mul_f32 v162, v162, v216
  v_mul_f32 v163, v163, v216
  v_mul_f32 v164, v164, v216
  v_mul_f32 v165, v165, v216
  v_mul_f32 v166, v166, v216
  v_mul_f32 v167, v167, v216
  v_cvt_pk_bf16_f32 v232, v160, v161
  v_cvt_pk_bf16_f32 v233, v162, v163
  v_cvt_pk_bf16_f32 v234, v164, v165
  v_cvt_pk_bf16_f32 v235, v166, v167
  ds_write_b128 v223, v[232:235] offset:32768
  v_mul_f32 v168, v168, v216
  v_mul_f32 v169, v169, v216
  v_mul_f32 v170, v170, v216
  ds_read_b64_tr_b16 v[208:209], v6 offset:45056
  ds_read_b64_tr_b16 v[210:211], v6 offset:46080
  v_mfma_f32_32x32x16_bf16 v[128:143], v[192:195], v[68:71], v[128:143]
  v_mul_f32 v171, v171, v216
  v_mul_f32 v172, v172, v216
  v_mul_f32 v173, v173, v216
  v_cvt_pk_bf16_f32 v236, v168, v169
  v_cvt_pk_bf16_f32 v237, v170, v171
  v_cvt_pk_bf16_f32 v238, v172, v173
  ds_write_b128 v11, v[236:239] offset:32768
  v_mul_f32 v176, v176, v217
  v_mul_f32 v177, v177, v217
  v_mul_f32 v178, v178, v217
  v_mul_f32 v179, v179, v217
  v_mul_f32 v180, v180, v217
  v_mul_f32 v181, v181, v217
  v_mul_f32 v182, v182, v217
  v_mul_f32 v183, v183, v217
  v_cvt_pk_bf16_f32 v224, v176, v177
  ds_read_b64_tr_b16 v[212:213], v7 offset:28672
  ds_read_b64_tr_b16 v[214:215], v7 offset:29696
  s_waitcnt lgkmcnt(8)
  v_mfma_f32_32x32x16_bf16 v[144:159], v[196:199], v[20:23], v[144:159]
  s_add_u32 m0, s38, 98304
  s_add_u32 s46, s66, 0
  buffer_load_dwordx4 v3, s[8:11], s46 offen lds
  v_cvt_pk_bf16_f32 v225, v178, v179
  v_cvt_pk_bf16_f32 v226, v180, v181
  v_cvt_pk_bf16_f32 v227, v182, v183
  ds_write_b128 v12, v[224:227] offset:32768
  v_mul_f32 v184, v184, v217
  v_mul_f32 v185, v185, v217
  v_mul_f32 v186, v186, v217
  v_mul_f32 v187, v187, v217
  v_mul_f32 v188, v188, v217
  v_mul_f32 v189, v189, v217
  v_cvt_pk_bf16_f32 v228, v184, v185
  v_cvt_pk_bf16_f32 v229, v186, v187
  v_cvt_pk_bf16_f32 v230, v188, v189
  ds_write_b128 v13, v[228:231] offset:32768
  ds_read_b64_tr_b16 v[192:193], v6 offset:49152
  ds_read_b64_tr_b16 v[194:195], v6 offset:50176
  v_mfma_f32_32x32x16_bf16 v[128:143], v[200:203], v[72:75], v[128:143]
  v_add_u32 v7, 98304, v7
  ds_read_b64_tr_b16 v[196:197], v7 offset:24576
  ds_read_b64_tr_b16 v[198:199], v7 offset:25600
  s_waitcnt vmcnt(2) lgkmcnt(4)
  v_mfma_f32_32x32x16_bf16 v[144:159], v[204:207], v[24:27], v[144:159]
  s_barrier
  v_mfma_f32_32x32x16_bf16 v[128:143], v[208:211], v[76:79], v[128:143]
  ds_read_b64_tr_b16 v[200:201], v6 offset:53248
  ds_read_b64_tr_b16 v[202:203], v6 offset:54272
  s_add_u32 m0, s38, 106496
  s_add_u32 s46, s66, 86016
  buffer_load_dwordx4 v3, s[8:11], s46 offen lds
  ds_read_b64_tr_b16 v[204:205], v7 offset:28672
  ds_read_b64_tr_b16 v[206:207], v7 offset:29696
  v_mfma_f32_32x32x16_bf16 v[144:159], v[212:215], v[28:31], v[144:159]
  v_add_u32 v6, 4294934528, v6
  ds_read_b64_tr_b16 v[208:209], v6 offset:16384
  ds_read_b64_tr_b16 v[210:211], v6 offset:17408
  s_waitcnt lgkmcnt(6)
  v_mfma_f32_32x32x16_bf16 v[128:143], v[192:195], v[80:83], v[128:143]
  s_add_u32 m0, s38, 114688
  s_add_u32 s46, s60, 224
  buffer_load_dwordx4 v3, s[8:11], s46 offen lds
  ds_read_b64_tr_b16 v[212:213], v7 offset:32768
  ds_read_b64_tr_b16 v[214:215], v7 offset:33792
  v_mfma_f32_32x32x16_bf16 v[144:159], v[196:199], v[32:35], v[144:159]
  ds_read_b64_tr_b16 v[192:193], v6 offset:20480
  ds_read_b64_tr_b16 v[194:195], v6 offset:21504
  s_waitcnt lgkmcnt(6)
  v_mfma_f32_32x32x16_bf16 v[128:143], v[200:203], v[84:87], v[128:143]
  ds_read_b64_tr_b16 v[196:197], v7 offset:36864
  ds_read_b64_tr_b16 v[198:199], v7 offset:37888
  v_mfma_f32_32x32x16_bf16 v[144:159], v[204:207], v[36:39], v[144:159]
  s_add_u32 m0, s38, 16384
  s_add_u32 s46, s60, 86240
  buffer_load_dwordx4 v3, s[8:11], s46 offen lds
  ds_read_b64_tr_b16 v[200:201], v6 offset:24576
  ds_read_b64_tr_b16 v[202:203], v6 offset:25600
  s_waitcnt vmcnt(3)
  s_waitcnt lgkmcnt(6)
  v_mfma_f32_32x32x16_bf16 v[128:143], v[208:211], v[88:91], v[128:143]
  s_barrier
  v_mfma_f32_32x32x16_bf16 v[144:159], v[212:215], v[40:43], v[144:159]
  v_add_u32 v7, 4294901760, v7
  ds_read_b64_tr_b16 v[204:205], v7 offset:24576
  ds_read_b64_tr_b16 v[206:207], v7 offset:25600
  s_lshl1_add_u32 s81, s40, s39
  ds_read_b64_tr_b16 v[208:209], v6 offset:28672
  ds_read_b64_tr_b16 v[210:211], v6 offset:29696
  s_waitcnt lgkmcnt(6)
  v_mfma_f32_32x32x16_bf16 v[128:143], v[192:195], v[92:95], v[128:143]
  s_add_u32 m0, s38, 24576
  s_add_u32 s46, s61, 224
  buffer_load_dwordx4 v3, s[8:11], s46 offen lds
  v_lshrrev_b32 v222, 4, v15
  ds_read_b64_tr_b16 v[212:213], v7 offset:28672
  ds_read_b64_tr_b16 v[214:215], v7 offset:29696
  v_mfma_f32_32x32x16_bf16 v[144:159], v[196:199], v[44:47], v[144:159]
  v_add_u32 v6, 32768, v6
  ds_read_b64_tr_b16 v[192:193], v6 offset:57344
  ds_read_b64_tr_b16 v[194:195], v6 offset:58368
  s_waitcnt lgkmcnt(6)
  v_mfma_f32_32x32x16_bf16 v[128:143], v[200:203], v[96:99], v[128:143]
  s_add_u32 m0, s38, 32768
  s_add_u32 s46, s61, 86240
  buffer_load_dwordx4 v3, s[8:11], s46 offen lds
  s_lshl_b32 s82, s81, 15
  ds_read_b64_tr_b16 v[196:197], v7 offset:32768
  ds_read_b64_tr_b16 v[198:199], v7 offset:33792
  v_mfma_f32_32x32x16_bf16 v[144:159], v[204:207], v[48:51], v[144:159]
  ds_read_b64_tr_b16 v[200:201], v6 offset:61440
  ds_read_b64_tr_b16 v[202:203], v6 offset:62464
  s_waitcnt lgkmcnt(6)
  v_mfma_f32_32x32x16_bf16 v[128:143], v[208:211], v[100:103], v[128:143]
  v_lshlrev_b32 v222, 11, v222
  ds_read_b64_tr_b16 v[204:205], v7 offset:36864
  ds_read_b64_tr_b16 v[206:207], v7 offset:37888
  v_mfma_f32_32x32x16_bf16 v[144:159], v[212:215], v[52:55], v[144:159]
  s_add_u32 m0, s38, 40960
  s_add_u32 s46, s62, 224
  buffer_load_dwordx4 v3, s[8:11], s46 offen lds
  ds_read_b64_tr_b16 v[208:209], v6 offset:0
  ds_read_b64_tr_b16 v[210:211], v6 offset:1024
  s_waitcnt vmcnt(5)
  s_waitcnt lgkmcnt(6)
  v_mfma_f32_32x32x16_bf16 v[128:143], v[192:195], v[104:107], v[128:143]
  s_barrier
  v_mfma_f32_32x32x16_bf16 v[144:159], v[196:199], v[56:59], v[144:159]
  ds_read_b64_tr_b16 v[212:213], v7 offset:40960
  ds_read_b64_tr_b16 v[214:215], v7 offset:41984
  s_lshl_b32 s54, s36, 8
  v_and_b32 v223, 0xf0, v1
  ds_read_b64_tr_b16 v[192:193], v6 offset:4096
  ds_read_b64_tr_b16 v[194:195], v6 offset:5120
  s_waitcnt lgkmcnt(6)
  v_mfma_f32_32x32x16_bf16 v[128:143], v[200:203], v[108:111], v[128:143]
  s_add_u32 m0, s38, 49152
  s_add_u32 s46, s62, 86240
  buffer_load_dwordx4 v3, s[8:11], s46 offen lds
  ds_read_b64_tr_b16 v[196:197], v7 offset:45056
  ds_read_b64_tr_b16 v[198:199], v7 offset:46080
  v_mfma_f32_32x32x16_bf16 v[144:159], v[204:207], v[60:63], v[144:159]
  s_add_u32 s82, s82, s54
  ds_read_b64_tr_b16 v[200:201], v6 offset:8192
  ds_read_b64_tr_b16 v[202:203], v6 offset:9216
  s_waitcnt lgkmcnt(6)
  v_mfma_f32_32x32x16_bf16 v[128:143], v[208:211], v[112:115], v[128:143]
  s_add_u32 m0, s38, 122880
  s_add_u32 s46, s63, 224
  buffer_load_dwordx4 v3, s[8:11], s46 offen lds
  v_add_u32 v7, 65536, v7
  ds_read_b64_tr_b16 v[204:205], v7 offset:40960
  ds_read_b64_tr_b16 v[206:207], v7 offset:41984
  v_mfma_f32_32x32x16_bf16 v[144:159], v[212:215], v[64:67], v[144:159]
  v_add_u32 v222, v222, v223
  ds_read_b64_tr_b16 v[208:209], v6 offset:12288
  ds_read_b64_tr_b16 v[210:211], v6 offset:13312
  s_waitcnt lgkmcnt(6)
  v_mfma_f32_32x32x16_bf16 v[128:143], v[192:195], v[116:119], v[128:143]
  ds_read_b64_tr_b16 v[212:213], v7 offset:45056
  ds_read_b64_tr_b16 v[214:215], v7 offset:46080
  v_mfma_f32_32x32x16_bf16 v[144:159], v[196:199], v[68:71], v[144:159]
  s_add_u32 m0, s38, 57344
  s_add_u32 s46, s63, 86240
  buffer_load_dwordx4 v3, s[8:11], s46 offen lds
  s_add_u32 s88, s82, 1048576
  ds_read_b64_tr_b16 v[192:193], v7 offset:49152
  ds_read_b64_tr_b16 v[194:195], v7 offset:50176
  s_waitcnt lgkmcnt(6)
  v_mfma_f32_32x32x16_bf16 v[128:143], v[200:203], v[120:123], v[128:143]
  s_barrier
  v_mfma_f32_32x32x16_bf16 v[144:159], v[204:207], v[72:75], v[144:159]
  ds_read_b64_tr_b16 v[196:197], v7 offset:53248
  ds_read_b64_tr_b16 v[198:199], v7 offset:54272
  s_add_u32 s89, s82, 1056768
  v_add_u32 v7, 4294934528, v7
  ds_read_b64_tr_b16 v[200:201], v7 offset:16384
  ds_read_b64_tr_b16 v[202:203], v7 offset:17408
  s_waitcnt lgkmcnt(6)
  v_mfma_f32_32x32x16_bf16 v[128:143], v[208:211], v[124:127], v[128:143]
  s_add_u32 m0, s38, 131072
  s_add_u32 s46, s64, 224
  buffer_load_dwordx4 v3, s[8:11], s46 offen lds
  s_add_u32 s90, s82, 1064960
  ds_read_b64_tr_b16 v[204:205], v7 offset:20480
  ds_read_b64_tr_b16 v[206:207], v7 offset:21504
  v_mfma_f32_32x32x16_bf16 v[144:159], v[212:215], v[76:79], v[144:159]
  ds_read_b64_tr_b16 v[208:209], v7 offset:24576
  ds_read_b64_tr_b16 v[210:211], v7 offset:25600
  s_waitcnt lgkmcnt(6)
  v_mfma_f32_32x32x16_bf16 v[144:159], v[192:195], v[80:83], v[144:159]
  s_add_u32 m0, s38, 65536
  s_add_u32 s46, s64, 86240
  buffer_load_dwordx4 v3, s[8:11], s46 offen lds
  ds_read_b64_tr_b16 v[224:225], v221 offset:0
  ds_read_b64_tr_b16 v[226:227], v221 offset:448
  ds_read_b64_tr_b16 v[228:229], v221 offset:896
  ds_read_b64_tr_b16 v[230:231], v8 offset:1344
  v_cvt_pk_bf16_f32 v232, v128, v129
  v_cvt_pk_bf16_f32 v233, v130, v131
  v_cvt_pk_bf16_f32 v234, v132, v133
  v_cvt_pk_bf16_f32 v235, v134, v135
  v_cvt_pk_bf16_f32 v236, v136, v137
  v_cvt_pk_bf16_f32 v237, v138, v139
  v_cvt_pk_bf16_f32 v238, v140, v141
  v_cvt_pk_bf16_f32 v239, v142, v143
  s_waitcnt lgkmcnt(3)
  v_mov_b32_dpp v224, v224 row_shr:2 row_mask:0xa bank_mask:0x8
  s_add_u32 s91, s82, 1073152
  ds_read_b64_tr_b16 v[212:213], v7 offset:28672
  ds_read_b64_tr_b16 v[214:215], v7 offset:29696
  v_mfma_f32_32x32x16_bf16 v[144:159], v[196:199], v[84:87], v[144:159]
  v_mov_b32_dpp v225, v225 row_shr:2 row_mask:0xa bank_mask:0x8
  s_waitcnt lgkmcnt(4)
  v_mov_b32_dpp v226, v226 row_shr:2 row_mask:0xa bank_mask:0x8
  v_mov_b32_dpp v227, v227 row_shr:2 row_mask:0xa bank_mask:0x8
  s_waitcnt lgkmcnt(3)
  v_mov_b32_dpp v228, v228 row_shr:2 row_mask:0xa bank_mask:0x8
  v_mov_b32_dpp v229, v229 row_shr:2 row_mask:0xa bank_mask:0x8
  s_waitcnt lgkmcnt(2)
  v_mov_b32_dpp v230, v230 row_shr:2 row_mask:0xa bank_mask:0x8
  v_mov_b32_dpp v231, v231 row_shr:2 row_mask:0xa bank_mask:0x8
  v_mfma_f32_32x32x16_bf16 v[128:143], v[224:227], v[232:235], 0
  s_nop 0
  v_mfma_f32_32x32x16_bf16 v[128:143], v[228:231], v[236:239], v[128:143]
  v_add_u32 v7, 32768, v7
  ds_read_b64_tr_b16 v[192:193], v7 offset:57344
  ds_read_b64_tr_b16 v[194:195], v7 offset:58368
  v_mfma_f32_32x32x16_bf16 v[144:159], v[200:203], v[88:91], v[144:159]
  s_nop 7
  v_max3_f32 v216, v128, v129, v130
  v_min3_f32 v217, v128, v129, v130
  v_max3_f32 v216, v216, v131, v132
  v_min3_f32 v217, v217, v131, v132
  v_max3_f32 v216, v216, v133, v134
  v_min3_f32 v217, v217, v133, v134
  v_mov_b32 v176, 0x3f80
  v_mov_b32 v177, 0
  v_and_b32 v180, 0x30, v1
  v_lshlrev_b64 v[176:177], v180, v[176:177]
  v_and_b32 v180, 12, v15
  v_cmp_eq_u32 vcc, 4, v180
  v_cmp_eq_u32 s[58:59], 0, v180
  v_lshrrev_b32 v181, 1, v15
  v_cndmask_b32 v178, 0, v176, vcc
  v_and_b32 v181, 0x18, v181
  v_cndmask_b32 v179, 0, v177, vcc
  v_cndmask_b32 v176, 0, v176, s[58:59]
  v_cndmask_b32 v177, 0, v177, s[58:59]
  v_add_u32 v223, v223, v181
  v_and_b32 v181, 32, v15
  v_lshl_add_u32 v223, v181, 24, v223
  ds_read_b64_tr_b16 v[196:197], v7 offset:61440
  ds_read_b64_tr_b16 v[198:199], v7 offset:62464
  v_mfma_f32_32x32x16_bf16 v[144:159], v[204:207], v[92:95], v[144:159]
  s_add_u32 m0, s38, 73728
  s_add_u32 s46, s65, 224
  buffer_load_dwordx4 v3, s[8:11], s46 offen lds
  v_max3_f32 v216, v216, v135, v136
  v_min3_f32 v217, v217, v135, v136
  v_max3_f32 v216, v216, v137, v138
  v_min3_f32 v217, v217, v137, v138
  v_max3_f32 v216, v216, v139, v140
  v_min3_f32 v217, v217, v139, v140
  v_max_f32 v216, v216, v141
  v_min_f32 v217, v217, v141
  v_mov_b32 v218, v216
  v_mov_b32 v219, v217
  ds_read_b64_tr_b16 v[200:201], v7 offset:0
  ds_read_b64_tr_b16 v[202:203], v7 offset:1024
  v_mfma_f32_32x32x16_bf16 v[144:159], v[208:211], v[96:99], v[144:159]
  v_permlane32_swap_b32 v216, v218
  v_permlane32_swap_b32 v217, v219
  v_max_f32 v216, v216, v218
  v_min_f32 v217, v217, v219
  v_mul_f32 v216, 0xbfb8aa3b, v216
  v_mul_f32 v217, 0x3fb8aa3b, v217
  v_fmamk_f32 v224, v128, 0x3fb8aa3b, v216
  v_fmamk_f32 v128, v128, 0xbfb8aa3b, v217
  v_exp_f32 v224, v224
  buffer_load_dwordx4 v[240:243], v222, s[32:35], s88 offen sc1
  buffer_load_dwordx4 v[244:247], v222, s[32:35], s89 offen sc1
  ds_read_b64_tr_b16 v[204:205], v7 offset:4096
  ds_read_b64_tr_b16 v[206:207], v7 offset:5120
  s_waitcnt lgkmcnt(6)
  v_mfma_f32_32x32x16_bf16 v[144:159], v[212:215], v[100:103], v[144:159]
  v_exp_f32 v128, v128
  v_fmamk_f32 v225, v129, 0x3fb8aa3b, v216
  v_fmamk_f32 v129, v129, 0xbfb8aa3b, v217
  v_exp_f32 v225, v225
  v_exp_f32 v129, v129
  v_fmamk_f32 v226, v130, 0x3fb8aa3b, v216
  buffer_load_dwordx4 v[248:251], v222, s[32:35], s90 offen sc1
  buffer_load_dwordx4 v[252:255], v222, s[32:35], s91 offen sc1
  ds_read_b64_tr_b16 v[208:209], v7 offset:8192
  ds_read_b64_tr_b16 v[210:211], v7 offset:9216
  v_mfma_f32_32x32x16_bf16 v[144:159], v[192:195], v[104:107], v[144:159]
  v_fmamk_f32 v130, v130, 0xbfb8aa3b, v217
  v_exp_f32 v226, v226
  v_exp_f32 v130, v130
  v_fmamk_f32 v227, v131, 0x3fb8aa3b, v216
  v_fmamk_f32 v131, v131, 0xbfb8aa3b, v217
  v_exp_f32 v227, v227
  ds_read_b64_tr_b16 v[212:213], v7 offset:12288
  ds_read_b64_tr_b16 v[214:215], v7 offset:13312
  s_waitcnt vmcnt(9)
  s_waitcnt lgkmcnt(6)
  v_mfma_f32_32x32x16_bf16 v[144:159], v[196:199], v[108:111], v[144:159]
  s_barrier
  v_mfma_f32_32x32x16_bf16 v[144:159], v[200:203], v[112:115], v[144:159]
  ds_read_b64_tr_b16 v[192:193], v6 offset:16384
  ds_read_b64_tr_b16 v[194:195], v6 offset:17408
  v_exp_f32 v131, v131
  v_fmamk_f32 v228, v132, 0x3fb8aa3b, v216
  v_fmamk_f32 v132, v132, 0xbfb8aa3b, v217
  v_exp_f32 v228, v228
  v_exp_f32 v132, v132
  v_fmamk_f32 v229, v133, 0x3fb8aa3b, v216
  v_fmamk_f32 v133, v133, 0xbfb8aa3b, v217
  s_add_u32 m0, s38, 81920
  s_add_u32 s46, s65, 86240
  buffer_load_dwordx4 v3, s[8:11], s46 offen lds
  v_exp_f32 v229, v229
  v_exp_f32 v133, v133
  v_fmamk_f32 v230, v134, 0x3fb8aa3b, v216
  v_fmamk_f32 v134, v134, 0xbfb8aa3b, v217
  v_exp_f32 v230, v230
  v_exp_f32 v134, v134
  ds_read_b64_tr_b16 v[196:197], v6 offset:20480
  ds_read_b64_tr_b16 v[198:199], v6 offset:21504
  s_waitcnt lgkmcnt(6)
  v_mfma_f32_32x32x16_bf16 v[144:159], v[204:207], v[116:119], v[144:159]
  v_fmamk_f32 v231, v135, 0x3fb8aa3b, v216
  v_fmamk_f32 v135, v135, 0xbfb8aa3b, v217
  v_exp_f32 v231, v231
  v_exp_f32 v135, v135
  v_fmamk_f32 v232, v136, 0x3fb8aa3b, v216
  v_fmamk_f32 v136, v136, 0xbfb8aa3b, v217
  v_exp_f32 v232, v232
  v_add_u32 v6, 4294868992, v6
  ds_read_b64_tr_b16 v[200:201], v6 offset:16384
  ds_read_b64_tr_b16 v[202:203], v6 offset:17408
  v_mfma_f32_32x32x16_bf16 v[144:159], v[208:211], v[120:123], v[144:159]
  s_add_u32 m0, s38, 90112
  s_add_u32 s46, s66, 224
  buffer_load_dwordx4 v3, s[8:11], s46 offen lds
  v_exp_f32 v136, v136
  v_fmamk_f32 v233, v137, 0x3fb8aa3b, v216
  v_fmamk_f32 v137, v137, 0xbfb8aa3b, v217
  v_exp_f32 v233, v233
  v_exp_f32 v137, v137
  v_fmamk_f32 v234, v138, 0x3fb8aa3b, v216
  ds_read_b64_tr_b16 v[204:205], v6 offset:20480
  ds_read_b64_tr_b16 v[206:207], v6 offset:21504
  s_waitcnt lgkmcnt(6)
  v_mfma_f32_32x32x16_bf16 v[144:159], v[212:215], v[124:127], v[144:159]
  v_fmamk_f32 v138, v138, 0xbfb8aa3b, v217
  v_exp_f32 v234, v234
  v_exp_f32 v138, v138
  v_fmamk_f32 v235, v139, 0x3fb8aa3b, v216
  v_fmamk_f32 v139, v139, 0xbfb8aa3b, v217
  v_exp_f32 v235, v235
  v_exp_f32 v139, v139
  ds_read_b64_tr_b16 v[208:209], v6 offset:24576
  ds_read_b64_tr_b16 v[210:211], v6 offset:25600
  v_mfma_f32_32x32x16_bf16 v[160:175], v[192:195], v[16:19], 0
  s_add_u32 m0, s38, 139264
  s_add_u32 s46, s66, 86240
  buffer_load_dwordx4 v3, s[8:11], s46 offen lds
  v_fmamk_f32 v236, v140, 0x3fb8aa3b, v216
  v_fmamk_f32 v140, v140, 0xbfb8aa3b, v217
  v_exp_f32 v236, v236
  v_exp_f32 v140, v140
  v_fmamk_f32 v237, v141, 0x3fb8aa3b, v216
  v_fmamk_f32 v141, v141, 0xbfb8aa3b, v217
  v_exp_f32 v237, v237
  ds_read_b64_tr_b16 v[212:213], v6 offset:28672
  ds_read_b64_tr_b16 v[214:215], v6 offset:29696
  s_waitcnt lgkmcnt(6)
  v_mfma_f32_32x32x16_bf16 v[160:175], v[196:199], v[20:23], v[160:175]
  v_exp_f32 v141, v141
  v_cvt_pk_bf16_f32 v128, v128, v129
  v_cvt_pk_bf16_f32 v129, v130, v131
  v_cvt_pk_bf16_f32 v130, v132, v133
  v_cvt_pk_bf16_f32 v131, v134, 0
  v_cvt_pk_bf16_f32 v132, v135, v136
  v_cvt_pk_bf16_f32 v133, v137, v138
  v_cvt_pk_bf16_f32 v134, v139, v140
  ds_read_b64_tr_b16 v[192:193], v6 offset:32768
  ds_read_b64_tr_b16 v[194:195], v6 offset:33792
  v_mfma_f32_32x32x16_bf16 v[160:175], v[200:203], v[24:27], v[160:175]
  v_cvt_pk_bf16_f32 v135, v141, 0
  v_cvt_pk_bf16_f32 v136, v224, v225
  v_cvt_pk_bf16_f32 v137, v226, v227
  v_cvt_pk_bf16_f32 v138, v228, v229
  v_cvt_pk_bf16_f32 v139, v230, 0
  v_cvt_pk_bf16_f32 v140, v231, v232
  v_cvt_pk_bf16_f32 v141, v233, v234
  v_cvt_pk_bf16_f32 v142, v235, v236
  v_cvt_pk_bf16_f32 v143, v237, 0
  ds_read_b64_tr_b16 v[196:197], v6 offset:36864
  ds_read_b64_tr_b16 v[198:199], v6 offset:37888
  s_waitcnt lgkmcnt(6)
  v_mfma_f32_32x32x16_bf16 v[160:175], v[204:207], v[28:31], v[160:175]
  ds_read_b64_tr_b16 v[224:225], v221 offset:3136
  ds_read_b64_tr_b16 v[226:227], v221 offset:3584
  ds_read_b64_tr_b16 v[228:229], v221 offset:4032
  ds_read_b64_tr_b16 v[230:231], v8 offset:4480
  v_cvt_pk_bf16_f32 v232, v144, v145
  v_cvt_pk_bf16_f32 v233, v146, v147
  v_cvt_pk_bf16_f32 v234, v148, v149
  v_cvt_pk_bf16_f32 v235, v150, v151
  v_cvt_pk_bf16_f32 v236, v152, v153
  ds_read_b64_tr_b16 v[200:201], v6 offset:40960
  ds_read_b64_tr_b16 v[202:203], v6 offset:41984
  v_mfma_f32_32x32x16_bf16 v[160:175], v[208:211], v[32:35], v[160:175]
  v_cvt_pk_bf16_f32 v237, v154, v155
  v_cvt_pk_bf16_f32 v238, v156, v157
  v_cvt_pk_bf16_f32 v239, v158, v159
  s_waitcnt lgkmcnt(5)
  v_mov_b32_dpp v224, v224 row_shr:2 row_mask:0xa bank_mask:0x8
  v_mov_b32_dpp v225, v225 row_shr:2 row_mask:0xa bank_mask:0x8
  s_waitcnt vmcnt(6)
  v_xor_b32 v9, s45, v243
  s_waitcnt vmcnt(5)
  v_bitop3_b32 v9, v247, s45, v9 bitop3:0xbe
  s_waitcnt vmcnt(4)
  v_bitop3_b32 v9, v251, s45, v9 bitop3:0xbe
  s_waitcnt vmcnt(3)
  v_bitop3_b32 v9, v255, s45, v9 bitop3:0xbe
  v_cmp_lt_u32 vcc, 0xffff, v9
  s_cbranch_vccnz L_tslow_156
L_tok_155:
  v_mfma_f32_16x16x32_bf16 v[180:183], v[176:179], v[240:243], 0
  v_mfma_f32_16x16x32_bf16 v[180:183], v[176:179], v[244:247], v[180:183]
  ds_read_b64_tr_b16 v[204:205], v6 offset:45056
  ds_read_b64_tr_b16 v[206:207], v6 offset:46080
  v_mfma_f32_32x32x16_bf16 v[160:175], v[212:215], v[36:39], v[160:175]
  s_waitcnt lgkmcnt(6)
  v_mov_b32_dpp v226, v226 row_shr:2 row_mask:0xa bank_mask:0x8
  v_mov_b32_dpp v227, v227 row_shr:2 row_mask:0xa bank_mask:0x8
  s_waitcnt lgkmcnt(5)
  v_mov_b32_dpp v228, v228 row_shr:2 row_mask:0xa bank_mask:0x8
  v_mov_b32_dpp v229, v229 row_shr:2 row_mask:0xa bank_mask:0x8
  s_waitcnt lgkmcnt(4)
  v_mov_b32_dpp v230, v230 row_shr:2 row_mask:0xa bank_mask:0x8
  v_mfma_f32_16x16x32_bf16 v[180:183], v[176:179], v[248:251], v[180:183]
  v_mfma_f32_16x16x32_bf16 v[180:183], v[176:179], v[252:255], v[180:183]
  s_lshl_b32 s82, s81, 11
  s_lshl_b32 s54, s36, 8
  s_add_u32 s82, s82, s54
  s_add_u32 s82, s82, 3145728
  v_and_b32 v176, 11, v15
  v_lshl_add_u32 v176, s37, 4, v176
  v_and_b32 v176, 27, v176
  v_cmp_ne_u32 vcc, 27, v176
  v_mov_b32 v177, 0x3f803f80
  v_mov_b32 v178, s45
  v_cvt_pk_bf16_f32 v4, v180, v181
  v_cndmask_b32 v183, 1.0, v183, vcc
  s_lshl_b32 s56, s39, 15
  v_cndmask_b32 v182, 1.0, v182, vcc
  s_add_u32 s56, s56, s38
  v_cndmask_b32 v4, v177, v4, vcc
  v_mov_b32_dpp v183, v178 quad_perm:[0,1,2,3] row_mask:0x2 bank_mask:0xf
  s_add_u32 s56, s56, 3145728
  v_cvt_pk_bf16_f32 v5, v182, v183
  buffer_store_dwordx2 v[4:5], v223, s[32:35], s82 offen sc1
  v_mov_b32 v13, v1
  ds_read_b64_tr_b16 v[208:209], v6 offset:49152
  ds_read_b64_tr_b16 v[210:211], v6 offset:50176
  v_mfma_f32_32x32x16_bf16 v[160:175], v[192:195], v[40:43], v[160:175]
  v_mov_b32_dpp v231, v231 row_shr:2 row_mask:0xa bank_mask:0x8
  v_mfma_f32_32x32x16_bf16 v[144:159], v[224:227], v[232:235], 0
  s_nop 0
  v_mfma_f32_32x32x16_bf16 v[144:159], v[228:231], v[236:239], v[144:159]
  ds_read_b64_tr_b16 v[212:213], v6 offset:53248
  ds_read_b64_tr_b16 v[214:215], v6 offset:54272
  s_waitcnt vmcnt(1)
  s_waitcnt lgkmcnt(6)
  v_mfma_f32_32x32x16_bf16 v[160:175], v[196:199], v[44:47], v[160:175]
  s_barrier
  v_mfma_f32_32x32x16_bf16 v[160:175], v[200:203], v[48:51], v[160:175]
  v_add_u32 v6, 98304, v6
  ds_read_b64_tr_b16 v[192:193], v6 offset:24576
  ds_read_b64_tr_b16 v[194:195], v6 offset:25600
  s_nop 1
  v_max3_f32 v216, v144, v145, v146
  v_min3_f32 v217, v144, v145, v146
  v_max3_f32 v216, v216, v147, v148
  v_min3_f32 v217, v217, v147, v148
  v_max3_f32 v216, v216, v149, v150
  v_min3_f32 v217, v217, v149, v150
  v_max3_f32 v216, v216, v151, v152
  ds_read_b64_tr_b16 v[196:197], v6 offset:28672
  ds_read_b64_tr_b16 v[198:199], v6 offset:29696
  s_waitcnt lgkmcnt(6)
  v_mfma_f32_32x32x16_bf16 v[160:175], v[204:207], v[52:55], v[160:175]
  v_min3_f32 v217, v217, v151, v152
  v_max3_f32 v216, v216, v153, v154
  v_min3_f32 v217, v217, v153, v154
  v_max3_f32 v216, v216, v155, v156
  v_min3_f32 v217, v217, v155, v156
  v_add_u32 v6, 4294901760, v6
  ds_read_b64_tr_b16 v[200:201], v6 offset:24576
  ds_read_b64_tr_b16 v[202:203], v6 offset:25600
  v_mfma_f32_32x32x16_bf16 v[160:175], v[208:211], v[56:59], v[160:175]
  v_max_f32 v216, v216, v157
  v_min_f32 v217, v217, v157
  v_mov_b32 v218, v216
  v_mov_b32 v219, v217
  s_nop 0
  v_permlane32_swap_b32 v216, v218
  ds_read_b64_tr_b16 v[204:205], v6 offset:28672
  ds_read_b64_tr_b16 v[206:207], v6 offset:29696
  s_waitcnt lgkmcnt(6)
  v_mfma_f32_32x32x16_bf16 v[160:175], v[212:215], v[60:63], v[160:175]
  v_permlane32_swap_b32 v217, v219
  v_max_f32 v216, v216, v218
  v_min_f32 v217, v217, v219
  v_mul_f32 v216, 0xbfb8aa3b, v216
  v_add_u32 v6, 65536, v6
  ds_read_b64_tr_b16 v[208:209], v6 offset:32768
  ds_read_b64_tr_b16 v[210:211], v6 offset:33792
  v_mfma_f32_32x32x16_bf16 v[160:175], v[192:195], v[64:67], v[160:175]
  v_mul_f32 v217, 0x3fb8aa3b, v217
  v_fmamk_f32 v224, v144, 0x3fb8aa3b, v216
  v_fmamk_f32 v144, v144, 0xbfb8aa3b, v217
  v_exp_f32 v224, v224
  v_exp_f32 v144, v144
  ds_read_b64_tr_b16 v[212:213], v6 offset:36864
  ds_read_b64_tr_b16 v[214:215], v6 offset:37888
  s_waitcnt lgkmcnt(6)
  v_mfma_f32_32x32x16_bf16 v[160:175], v[196:199], v[68:71], v[160:175]
  v_fmamk_f32 v225, v145, 0x3fb8aa3b, v216
  v_fmamk_f32 v145, v145, 0xbfb8aa3b, v217
  v_exp_f32 v225, v225
  v_add_u32 v6, 4294934528, v6
  ds_read_b64_tr_b16 v[192:193], v6 offset:0
  ds_read_b64_tr_b16 v[194:195], v6 offset:1024
  v_mfma_f32_32x32x16_bf16 v[160:175], v[200:203], v[72:75], v[160:175]
  v_exp_f32 v145, v145
  v_fmamk_f32 v226, v146, 0x3fb8aa3b, v216
  v_fmamk_f32 v146, v146, 0xbfb8aa3b, v217
  v_exp_f32 v226, v226
  ds_read_b64_tr_b16 v[196:197], v6 offset:4096
  ds_read_b64_tr_b16 v[198:199], v6 offset:5120
  s_waitcnt lgkmcnt(6)
  v_mfma_f32_32x32x16_bf16 v[160:175], v[204:207], v[76:79], v[160:175]
  v_exp_f32 v146, v146
  v_fmamk_f32 v227, v147, 0x3fb8aa3b, v216
  v_fmamk_f32 v147, v147, 0xbfb8aa3b, v217
  ds_read_b64_tr_b16 v[200:201], v6 offset:8192
  ds_read_b64_tr_b16 v[202:203], v6 offset:9216
  v_mfma_f32_32x32x16_bf16 v[160:175], v[208:211], v[80:83], v[160:175]
  v_exp_f32 v227, v227
  v_exp_f32 v147, v147
  v_fmamk_f32 v228, v148, 0x3fb8aa3b, v216
  v_mov_b32 v252, -1
  v_mov_b32 v253, -1
  v_mov_b32 v254, -1
  v_mov_b32 v255, -1
  s_mul_i32 s47, s39, 14336
  s_add_u32 s50, s47, s50
  s_add_u32 s50, s50, 114688
  s_add_u32 s3, s50, 4096
  ds_read_b64_tr_b16 v[204:205], v6 offset:12288
  ds_read_b64_tr_b16 v[206:207], v6 offset:13312
  s_waitcnt lgkmcnt(6)
  v_mfma_f32_32x32x16_bf16 v[160:175], v[212:215], v[84:87], v[160:175]
  v_fmamk_f32 v148, v148, 0xbfb8aa3b, v217
  v_exp_f32 v228, v228
  v_exp_f32 v148, v148
  buffer_store_dwordx4 v[252:255], v1, s[32:35], s50 offen offset:0 sc1
  ds_read_b64_tr_b16 v[208:209], v6 offset:16384
  ds_read_b64_tr_b16 v[210:211], v6 offset:17408
  v_mfma_f32_32x32x16_bf16 v[160:175], v[192:195], v[88:91], v[160:175]
  v_fmamk_f32 v229, v149, 0x3fb8aa3b, v216
  v_fmamk_f32 v149, v149, 0xbfb8aa3b, v217
  v_exp_f32 v229, v229
  v_exp_f32 v149, v149
  ds_read_b64_tr_b16 v[212:213], v6 offset:20480
  ds_read_b64_tr_b16 v[214:215], v6 offset:21504
  s_waitcnt lgkmcnt(6)
  v_mfma_f32_32x32x16_bf16 v[160:175], v[196:199], v[92:95], v[160:175]
  v_fmamk_f32 v230, v150, 0x3fb8aa3b, v216
  v_fmamk_f32 v150, v150, 0xbfb8aa3b, v217
  v_exp_f32 v230, v230
  buffer_store_dwordx4 v[252:255], v1, s[32:35], s50 offen offset:1024 sc1
  ds_read_b64_tr_b16 v[192:193], v6 offset:24576
  ds_read_b64_tr_b16 v[194:195], v6 offset:25600
  v_mfma_f32_32x32x16_bf16 v[160:175], v[200:203], v[96:99], v[160:175]
  v_exp_f32 v150, v150
  v_fmamk_f32 v231, v151, 0x3fb8aa3b, v216
  v_fmamk_f32 v151, v151, 0xbfb8aa3b, v217
  v_exp_f32 v231, v231
  ds_read_b64_tr_b16 v[196:197], v7 offset:16384
  ds_read_b64_tr_b16 v[198:199], v7 offset:17408
  s_waitcnt lgkmcnt(6)
  v_mfma_f32_32x32x16_bf16 v[160:175], v[204:207], v[100:103], v[160:175]
  v_exp_f32 v151, v151
  v_fmamk_f32 v232, v152, 0x3fb8aa3b, v216
  v_fmamk_f32 v152, v152, 0xbfb8aa3b, v217
  buffer_store_dwordx4 v[252:255], v1, s[32:35], s50 offen offset:2048 sc1
  ds_read_b64_tr_b16 v[200:201], v6 offset:28672
  ds_read_b64_tr_b16 v[202:203], v6 offset:29696
  v_mfma_f32_32x32x16_bf16 v[160:175], v[208:211], v[104:107], v[160:175]
  v_exp_f32 v232, v232
  v_exp_f32 v152, v152
  v_fmamk_f32 v233, v153, 0x3fb8aa3b, v216
  ds_read_b64_tr_b16 v[204:205], v7 offset:20480
  ds_read_b64_tr_b16 v[206:207], v7 offset:21504
  s_waitcnt lgkmcnt(6)
  v_mfma_f32_32x32x16_bf16 v[160:175], v[212:215], v[108:111], v[160:175]
  v_fmamk_f32 v153, v153, 0xbfb8aa3b, v217
  v_exp_f32 v233, v233
  v_exp_f32 v153, v153
  buffer_store_dwordx4 v[252:255], v1, s[32:35], s50 offen offset:3072 sc1
  v_add_u32 v6, 32768, v6
  ds_read_b64_tr_b16 v[208:209], v6 offset:40960
  ds_read_b64_tr_b16 v[210:211], v6 offset:41984
  v_mfma_f32_32x32x16_bf16 v[160:175], v[192:195], v[112:115], v[160:175]
  v_fmamk_f32 v234, v154, 0x3fb8aa3b, v216
  v_fmamk_f32 v154, v154, 0xbfb8aa3b, v217
  v_exp_f32 v234, v234
  v_exp_f32 v154, v154
  buffer_store_dwordx4 v[252:255], v1, s[32:35], s3 offen offset:0 sc1
  v_add_u32 v7, 4294868992, v7
  ds_read_b64_tr_b16 v[212:213], v7 offset:16384
  ds_read_b64_tr_b16 v[214:215], v7 offset:17408
  s_waitcnt lgkmcnt(6)
  v_mfma_f32_32x32x16_bf16 v[176:191], v[196:199], v[16:19], 0
  v_fmamk_f32 v235, v155, 0x3fb8aa3b, v216
  v_fmamk_f32 v155, v155, 0xbfb8aa3b, v217
  v_exp_f32 v235, v235
  ds_read_b64_tr_b16 v[192:193], v6 offset:45056
  ds_read_b64_tr_b16 v[194:195], v6 offset:46080
  v_mfma_f32_32x32x16_bf16 v[160:175], v[200:203], v[116:119], v[160:175]
  v_exp_f32 v155, v155
  v_fmamk_f32 v236, v156, 0x3fb8aa3b, v216
  v_fmamk_f32 v156, v156, 0xbfb8aa3b, v217
  v_exp_f32 v236, v236
  buffer_store_dwordx4 v[252:255], v1, s[32:35], s3 offen offset:1024 sc1
  ds_read_b64_tr_b16 v[196:197], v7 offset:20480
  ds_read_b64_tr_b16 v[198:199], v7 offset:21504
  s_waitcnt lgkmcnt(6)
  v_mfma_f32_32x32x16_bf16 v[176:191], v[204:207], v[20:23], v[176:191]
  s_barrier
  v_mfma_f32_32x32x16_bf16 v[160:175], v[208:211], v[120:123], v[160:175]
  ds_read_b64_tr_b16 v[200:201], v7 offset:24576
  ds_read_b64_tr_b16 v[202:203], v7 offset:25600
  v_exp_f32 v156, v156
  v_fmamk_f32 v237, v157, 0x3fb8aa3b, v216
  v_fmamk_f32 v157, v157, 0xbfb8aa3b, v217
  v_exp_f32 v237, v237
  v_exp_f32 v157, v157
  v_cvt_pk_bf16_f32 v144, v144, v145
  buffer_store_dwordx4 v[252:255], v1, s[32:35], s3 offen offset:2048 sc1
  ds_read_b64_tr_b16 v[204:205], v7 offset:28672
  ds_read_b64_tr_b16 v[206:207], v7 offset:29696
  s_waitcnt lgkmcnt(6)
  v_mfma_f32_32x32x16_bf16 v[176:191], v[212:215], v[24:27], v[176:191]
  v_cvt_pk_bf16_f32 v145, v146, v147
  v_cvt_pk_bf16_f32 v146, v148, v149
  v_cvt_pk_bf16_f32 v147, v150, 0
  v_cvt_pk_bf16_f32 v148, v151, v152
  v_cvt_pk_bf16_f32 v149, v153, v154
  ds_read_b64_tr_b16 v[208:209], v7 offset:32768
  ds_read_b64_tr_b16 v[210:211], v7 offset:33792
  v_mfma_f32_32x32x16_bf16 v[160:175], v[192:195], v[124:127], v[160:175]
  v_cvt_pk_bf16_f32 v150, v155, v156
  v_cvt_pk_bf16_f32 v151, v157, 0
  v_cvt_pk_bf16_f32 v152, v224, v225
  v_cvt_pk_bf16_f32 v153, v226, v227
  v_cvt_pk_bf16_f32 v154, v228, v229
  s_add_u32 m0, s38, 147456
  s_add_u32 s46, s56, 0
  buffer_load_dwordx4 v1, s[32:35], s46 offen sc1 lds
  s_add_u32 m0, s38, 155648
  s_add_u32 s46, s56, 8192
  buffer_load_dwordx4 v1, s[32:35], s46 offen sc1 lds
  ds_read_b64_tr_b16 v[212:213], v7 offset:36864
  ds_read_b64_tr_b16 v[214:215], v7 offset:37888
  s_waitcnt lgkmcnt(6)
  v_mfma_f32_32x32x16_bf16 v[176:191], v[196:199], v[28:31], v[176:191]
  v_cvt_pk_bf16_f32 v155, v230, 0
  v_cvt_pk_bf16_f32 v156, v231, v232
  v_cvt_pk_bf16_f32 v157, v233, v234
  v_cvt_pk_bf16_f32 v158, v235, v236
  v_cvt_pk_bf16_f32 v159, v237, 0
  s_add_u32 m0, s38, 98304
  s_add_u32 s46, s56, 16384
  buffer_load_dwordx4 v1, s[32:35], s46 offen sc1 lds
  s_add_u32 m0, s38, 106496
  s_add_u32 s46, s56, 24576
  buffer_load_dwordx4 v1, s[32:35], s46 offen sc1 lds
  ds_read_b64_tr_b16 v[192:193], v7 offset:40960
  ds_read_b64_tr_b16 v[194:195], v7 offset:41984
  v_mfma_f32_32x32x16_bf16 v[176:191], v[200:203], v[32:35], v[176:191]
  ds_read_b64_tr_b16 v[224:225], v221 offset:6272
  ds_read_b64_tr_b16 v[226:227], v221 offset:6720
  ds_read_b64_tr_b16 v[228:229], v221 offset:7168
  ds_read_b64_tr_b16 v[230:231], v8 offset:7616
  v_cvt_pk_bf16_f32 v232, v160, v161
  v_cvt_pk_bf16_f32 v233, v162, v163
  v_cvt_pk_bf16_f32 v234, v164, v165
  v_cvt_pk_bf16_f32 v235, v166, v167
  v_cvt_pk_bf16_f32 v236, v168, v169
  v_cvt_pk_bf16_f32 v237, v170, v171
  s_add_u32 s54, s38, 147468
  v_add_u32 v9, s54, v1
  s_add_u32 s54, s38, 155660
  v_add_u32 v220, s54, v1
  ds_read_b64_tr_b16 v[196:197], v7 offset:45056
  ds_read_b64_tr_b16 v[198:199], v7 offset:46080
  s_waitcnt lgkmcnt(10)
  v_mfma_f32_32x32x16_bf16 v[176:191], v[204:207], v[36:39], v[176:191]
  v_cvt_pk_bf16_f32 v238, v172, v173
  v_cvt_pk_bf16_f32 v239, v174, v175
  s_waitcnt lgkmcnt(5)
  v_mov_b32_dpp v224, v224 row_shr:2 row_mask:0xa bank_mask:0x8
  v_mov_b32_dpp v225, v225 row_shr:2 row_mask:0xa bank_mask:0x8
  s_waitcnt lgkmcnt(4)
  v_mov_b32_dpp v226, v226 row_shr:2 row_mask:0xa bank_mask:0x8
  v_mov_b32_dpp v227, v227 row_shr:2 row_mask:0xa bank_mask:0x8
  s_add_u32 s54, s38, 98316
  v_add_u32 v222, s54, v1
  s_add_u32 s54, s38, 106508
  v_add_u32 v223, s54, v1
  ds_read_b64_tr_b16 v[200:201], v7 offset:49152
  ds_read_b64_tr_b16 v[202:203], v7 offset:50176
  v_mfma_f32_32x32x16_bf16 v[176:191], v[208:211], v[40:43], v[176:191]
  s_waitcnt lgkmcnt(5)
  v_mov_b32_dpp v228, v228 row_shr:2 row_mask:0xa bank_mask:0x8
  v_mov_b32_dpp v229, v229 row_shr:2 row_mask:0xa bank_mask:0x8
  s_waitcnt lgkmcnt(4)
  v_mov_b32_dpp v230, v230 row_shr:2 row_mask:0xa bank_mask:0x8
  v_mov_b32_dpp v231, v231 row_shr:2 row_mask:0xa bank_mask:0x8
  v_mfma_f32_32x32x16_bf16 v[160:175], v[224:227], v[232:235], 0
  s_nop 0
  v_mfma_f32_32x32x16_bf16 v[160:175], v[228:231], v[236:239], v[160:175]
  ds_read_b64_tr_b16 v[204:205], v7 offset:53248
  ds_read_b64_tr_b16 v[206:207], v7 offset:54272
  v_mfma_f32_32x32x16_bf16 v[176:191], v[212:215], v[44:47], v[176:191]
  s_nop 8
  v_max3_f32 v216, v160, v161, v162
  v_add_u32 v7, 98304, v7
  ds_read_b64_tr_b16 v[208:209], v7 offset:24576
  ds_read_b64_tr_b16 v[210:211], v7 offset:25600
  v_mfma_f32_32x32x16_bf16 v[176:191], v[192:195], v[48:51], v[176:191]
  v_min3_f32 v217, v160, v161, v162
  v_max3_f32 v216, v216, v163, v164
  v_min3_f32 v217, v217, v163, v164
  v_max3_f32 v216, v216, v165, v166
  v_min3_f32 v217, v217, v165, v166
  v_max3_f32 v216, v216, v167, v168
  ds_read_b64_tr_b16 v[240:241], v221 offset:9408
  ds_read_b64_tr_b16 v[242:243], v221 offset:9856
  ds_read_b64_tr_b16 v[244:245], v221 offset:10304
  ds_read_b64_tr_b16 v[246:247], v8 offset:10752
  ds_read_b64_tr_b16 v[212:213], v7 offset:28672
  ds_read_b64_tr_b16 v[214:215], v7 offset:29696
  s_waitcnt lgkmcnt(10)
  v_mfma_f32_32x32x16_bf16 v[176:191], v[196:199], v[52:55], v[176:191]
  v_min3_f32 v217, v217, v167, v168
  v_max3_f32 v216, v216, v169, v170
  v_min3_f32 v217, v217, v169, v170
  v_max3_f32 v216, v216, v171, v172
  v_min3_f32 v217, v217, v171, v172
  v_max_f32 v216, v216, v173
  v_add_u32 v7, 4294901760, v7
  ds_read_b64_tr_b16 v[192:193], v7 offset:24576
  ds_read_b64_tr_b16 v[194:195], v7 offset:25600
  v_mfma_f32_32x32x16_bf16 v[176:191], v[200:203], v[56:59], v[176:191]
  v_min_f32 v217, v217, v173
  v_mov_b32 v218, v216
  v_mov_b32 v219, v217
  s_nop 0
  v_permlane32_swap_b32 v216, v218
  v_permlane32_swap_b32 v217, v219
  s_waitcnt lgkmcnt(7)
  v_mov_b32_dpp v240, v240 row_shr:2 row_mask:0xa bank_mask:0x8
  v_mov_b32_dpp v241, v241 row_shr:2 row_mask:0xa bank_mask:0x8
  ds_read_b64_tr_b16 v[196:197], v7 offset:28672
  ds_read_b64_tr_b16 v[198:199], v7 offset:29696
  v_mfma_f32_32x32x16_bf16 v[176:191], v[204:207], v[60:63], v[176:191]
  v_max_f32 v216, v216, v218
  v_min_f32 v217, v217, v219
  v_mul_f32 v216, 0xbfb8aa3b, v216
  v_mul_f32 v217, 0x3fb8aa3b, v217
  v_fmamk_f32 v224, v160, 0x3fb8aa3b, v216
  v_fmamk_f32 v160, v160, 0xbfb8aa3b, v217
  v_exp_f32 v224, v224
  s_waitcnt lgkmcnt(8)
  v_mov_b32_dpp v242, v242 row_shr:2 row_mask:0xa bank_mask:0x8
  v_mov_b32_dpp v243, v243 row_shr:2 row_mask:0xa bank_mask:0x8
  v_add_u32 v7, 65536, v7
  ds_read_b64_tr_b16 v[200:201], v7 offset:32768
  ds_read_b64_tr_b16 v[202:203], v7 offset:33792
  v_mfma_f32_32x32x16_bf16 v[176:191], v[208:211], v[64:67], v[176:191]
  v_exp_f32 v160, v160
  v_fmamk_f32 v225, v161, 0x3fb8aa3b, v216
  v_fmamk_f32 v161, v161, 0xbfb8aa3b, v217
  v_exp_f32 v225, v225
  s_lshl1_add_u32 s49, s40, s39
  s_lshl3_add_u32 s49, s49, s36
  s_lshl_b32 s49, s49, 12
  s_add_u32 s49, s49, 2097152
  s_add_u32 s49, s49, 896
  s_waitcnt vmcnt(4)
  v_mov_b32 v10, s43
  s_mov_b64 exec, 0xff
  buffer_store_dwordx4 v[10:13], v1, s[32:35], s49 offen sc1
  s_mov_b64 exec, -1
  s_waitcnt lgkmcnt(9)
  v_mov_b32_dpp v244, v244 row_shr:2 row_mask:0xa bank_mask:0x8
  v_mov_b32_dpp v245, v245 row_shr:2 row_mask:0xa bank_mask:0x8
  ds_read_b64_tr_b16 v[204:205], v7 offset:36864
  ds_read_b64_tr_b16 v[206:207], v7 offset:37888
  s_waitcnt lgkmcnt(6)
  v_mfma_f32_32x32x16_bf16 v[176:191], v[212:215], v[68:71], v[176:191]
  v_exp_f32 v161, v161
  v_fmamk_f32 v226, v162, 0x3fb8aa3b, v216
  v_fmamk_f32 v162, v162, 0xbfb8aa3b, v217
  v_exp_f32 v226, v226
  v_mov_b32_dpp v246, v246 row_shr:2 row_mask:0xa bank_mask:0x8
  v_mov_b32_dpp v247, v247 row_shr:2 row_mask:0xa bank_mask:0x8
  v_add_u32 v7, 4294934528, v7
  ds_read_b64_tr_b16 v[208:209], v7 offset:0
  ds_read_b64_tr_b16 v[210:211], v7 offset:1024
  s_waitcnt lgkmcnt(6)
  v_mfma_f32_32x32x16_bf16 v[176:191], v[192:195], v[72:75], v[176:191]
  s_barrier
  v_mfma_f32_32x32x16_bf16 v[176:191], v[196:199], v[76:79], v[176:191]
  ds_read_b64_tr_b16 v[212:213], v7 offset:4096
  ds_read_b64_tr_b16 v[214:215], v7 offset:5120
  v_exp_f32 v162, v162
  v_fmamk_f32 v227, v163, 0x3fb8aa3b, v216
  v_fmamk_f32 v163, v163, 0xbfb8aa3b, v217
  v_exp_f32 v227, v227
  v_mov_b32 v248, 0x3fb8aa3b
  v_mov_b32 v249, 0xbfb8aa3b
  v_exp_f32 v163, v163
  v_fmamk_f32 v228, v164, 0x3fb8aa3b, v216
  v_fmamk_f32 v164, v164, 0xbfb8aa3b, v217
  v_exp_f32 v228, v228
  ds_read_b64_tr_b16 v[192:193], v7 offset:8192
  ds_read_b64_tr_b16 v[194:195], v7 offset:9216
  s_waitcnt lgkmcnt(6)
  v_mfma_f32_32x32x16_bf16 v[176:191], v[200:203], v[80:83], v[176:191]
  v_exp_f32 v164, v164
  v_fmamk_f32 v229, v165, 0x3fb8aa3b, v216
  v_fmamk_f32 v165, v165, 0xbfb8aa3b, v217
  v_exp_f32 v229, v229
  ds_read_b64_tr_b16 v[196:197], v7 offset:12288
  ds_read_b64_tr_b16 v[198:199], v7 offset:13312
  v_mfma_f32_32x32x16_bf16 v[176:191], v[204:207], v[84:87], v[176:191]
  v_exp_f32 v165, v165
  v_fmamk_f32 v230, v166, 0x3fb8aa3b, v216
  v_fmamk_f32 v166, v166, 0xbfb8aa3b, v217
  v_exp_f32 v230, v230
  ds_read_b64_tr_b16 v[200:201], v7 offset:16384
  ds_read_b64_tr_b16 v[202:203], v7 offset:17408
  s_waitcnt lgkmcnt(6)
  v_mfma_f32_32x32x16_bf16 v[176:191], v[208:211], v[88:91], v[176:191]
  v_exp_f32 v166, v166
  v_fmamk_f32 v231, v167, 0x3fb8aa3b, v216
  v_fmamk_f32 v167, v167, 0xbfb8aa3b, v217
  v_exp_f32 v231, v231
  ds_read_b64_tr_b16 v[204:205], v7 offset:20480
  ds_read_b64_tr_b16 v[206:207], v7 offset:21504
  v_mfma_f32_32x32x16_bf16 v[176:191], v[212:215], v[92:95], v[176:191]
  v_exp_f32 v167, v167
  v_fmamk_f32 v232, v168, 0x3fb8aa3b, v216
  v_fmamk_f32 v168, v168, 0xbfb8aa3b, v217
  v_exp_f32 v232, v232
  ds_read_b64_tr_b16 v[208:209], v7 offset:24576
  ds_read_b64_tr_b16 v[210:211], v7 offset:25600
  s_waitcnt lgkmcnt(6)
  v_mfma_f32_32x32x16_bf16 v[176:191], v[192:195], v[96:99], v[176:191]
  v_exp_f32 v168, v168
  v_fmamk_f32 v233, v169, 0x3fb8aa3b, v216
  v_fmamk_f32 v169, v169, 0xbfb8aa3b, v217
  v_exp_f32 v233, v233
  ds_read_b64_tr_b16 v[212:213], v7 offset:28672
  ds_read_b64_tr_b16 v[214:215], v7 offset:29696
  v_mfma_f32_32x32x16_bf16 v[176:191], v[196:199], v[100:103], v[176:191]
  v_exp_f32 v169, v169
  v_fmamk_f32 v234, v170, 0x3fb8aa3b, v216
  v_fmamk_f32 v170, v170, 0xbfb8aa3b, v217
  v_exp_f32 v234, v234
  v_add_u32 v7, 32768, v7
  ds_read_b64_tr_b16 v[192:193], v7 offset:40960
  ds_read_b64_tr_b16 v[194:195], v7 offset:41984
  s_waitcnt lgkmcnt(6)
  v_mfma_f32_32x32x16_bf16 v[176:191], v[200:203], v[104:107], v[176:191]
  v_exp_f32 v170, v170
  v_fmamk_f32 v235, v171, 0x3fb8aa3b, v216
  v_fmamk_f32 v171, v171, 0xbfb8aa3b, v217
  v_exp_f32 v235, v235
  ds_read_b64_tr_b16 v[196:197], v7 offset:45056
  ds_read_b64_tr_b16 v[198:199], v7 offset:46080
  v_mfma_f32_32x32x16_bf16 v[176:191], v[204:207], v[108:111], v[176:191]
  v_exp_f32 v171, v171
  v_fmamk_f32 v236, v172, 0x3fb8aa3b, v216
  v_fmamk_f32 v172, v172, 0xbfb8aa3b, v217
  v_exp_f32 v236, v236
  s_waitcnt lgkmcnt(4)
  v_mfma_f32_32x32x16_bf16 v[176:191], v[208:211], v[112:115], v[176:191]
  v_exp_f32 v172, v172
  v_fmamk_f32 v237, v173, 0x3fb8aa3b, v216
  v_fmamk_f32 v173, v173, 0xbfb8aa3b, v217
  v_exp_f32 v237, v237
  v_mfma_f32_32x32x16_bf16 v[176:191], v[212:215], v[116:119], v[176:191]
  v_exp_f32 v173, v173
  v_cvt_pk_bf16_f32 v160, v160, v161
  v_cvt_pk_bf16_f32 v161, v162, v163
  v_cvt_pk_bf16_f32 v162, v164, v165
  v_cvt_pk_bf16_f32 v163, v166, 0
  s_waitcnt lgkmcnt(0)
  v_mfma_f32_32x32x16_bf16 v[176:191], v[192:195], v[120:123], v[176:191]
  v_cvt_pk_bf16_f32 v164, v167, v168
  v_cvt_pk_bf16_f32 v165, v169, v170
  v_cvt_pk_bf16_f32 v166, v171, v172
  v_cvt_pk_bf16_f32 v167, v173, 0
  v_cvt_pk_bf16_f32 v168, v224, v225
  v_cvt_pk_bf16_f32 v169, v226, v227
  v_mfma_f32_32x32x16_bf16 v[176:191], v[196:199], v[124:127], v[176:191]
  v_cvt_pk_bf16_f32 v170, v228, v229
  v_cvt_pk_bf16_f32 v171, v230, 0
  v_cvt_pk_bf16_f32 v172, v231, v232
  v_cvt_pk_bf16_f32 v173, v233, v234
  v_cvt_pk_bf16_f32 v174, v235, v236
  v_cvt_pk_bf16_f32 v175, v237, 0
  s_nop 5
  v_cvt_pk_bf16_f32 v232, v176, v177
  v_cvt_pk_bf16_f32 v233, v178, v179
  v_cvt_pk_bf16_f32 v234, v180, v181
  v_cvt_pk_bf16_f32 v235, v182, v183
  v_cvt_pk_bf16_f32 v236, v184, v185
  v_cvt_pk_bf16_f32 v237, v186, v187
  v_cvt_pk_bf16_f32 v238, v188, v189
  v_cvt_pk_bf16_f32 v239, v190, v191
  v_mfma_f32_32x32x16_bf16 v[176:191], v[240:243], v[232:235], 0
  s_nop 0
  v_mfma_f32_32x32x16_bf16 v[176:191], v[244:247], v[236:239], v[176:191]
  s_nop 11
  v_max3_f32 v216, v176, v177, v178
  v_min3_f32 v217, v176, v177, v178
  v_max3_f32 v216, v216, v179, v180
  v_min3_f32 v217, v217, v179, v180
  v_max3_f32 v216, v216, v181, v182
  v_min3_f32 v217, v217, v181, v182
  v_max3_f32 v216, v216, v183, v184
  v_min3_f32 v217, v217, v183, v184
  v_max3_f32 v216, v216, v185, v186
  v_min3_f32 v217, v217, v185, v186
  v_max3_f32 v216, v216, v187, v188
  s_waitcnt vmcnt(1)
  ds_read_b32 v112, v9
  ds_read_b32 v113, v220
  ds_read_b32 v114, v222
  ds_read_b32 v115, v223
  s_waitcnt lgkmcnt(3)
  v_xor_b32 v116, s45, v112
  s_waitcnt lgkmcnt(2)
  v_bitop3_b32 v116, v113, s45, v116 bitop3:0xbe
  s_waitcnt lgkmcnt(1)
  v_bitop3_b32 v116, v114, s45, v116 bitop3:0xbe
  s_waitcnt lgkmcnt(0)
  v_bitop3_b32 v116, v115, s45, v116 bitop3:0xbe
  v_cmp_lt_u32 vcc, 0xffff, v116
  s_cbranch_vccnz L_tslow_159
L_tok_158:
  s_barrier
  v_add_u32 v13, 98304, v13
  ds_read_b128 v[16:19], v13 offset:49152
  ds_read_b128 v[20:23], v13 offset:50176
  ds_read_b128 v[24:27], v13 offset:51200
  ds_read_b128 v[28:31], v13 offset:52224
  ds_read_b128 v[32:35], v13 offset:57344
  ds_read_b128 v[36:39], v13 offset:58368
  ds_read_b128 v[40:43], v13 offset:59392
  ds_read_b128 v[44:47], v13 offset:60416
  s_waitcnt lgkmcnt(7)
  v_mfma_f32_32x32x16_bf16 v[48:63], v[16:19], v[136:139], 0
  v_min3_f32 v217, v217, v187, v188
  v_max_f32 v216, v216, v189
  v_min_f32 v217, v217, v189
  s_waitcnt lgkmcnt(6)
  v_mfma_f32_32x32x16_bf16 v[48:63], v[20:23], v[140:143], v[48:63]
  v_mov_b32 v218, v216
  v_mov_b32 v219, v217
  s_nop 0
  v_permlane32_swap_b32 v216, v218
  s_waitcnt lgkmcnt(5)
  v_mfma_f32_32x32x16_bf16 v[64:79], v[24:27], v[128:131], 0
  v_permlane32_swap_b32 v217, v219
  v_max_f32 v216, v216, v218
  v_min_f32 v217, v217, v219
  s_waitcnt lgkmcnt(4)
  v_mfma_f32_32x32x16_bf16 v[64:79], v[28:31], v[132:135], v[64:79]
  v_mul_f32 v216, 0xbfb8aa3b, v216
  v_mul_f32 v217, 0x3fb8aa3b, v217
  v_pk_fma_f32 v[224:225], v[176:177], v[248:249], v[216:217] op_sel_hi:[1,0,0]
  s_waitcnt lgkmcnt(3)
  v_mfma_f32_32x32x16_bf16 v[80:95], v[32:35], v[152:155], 0
  v_pk_fma_f32 v[176:177], v[176:177], v[248:249], v[216:217] op_sel:[0,1,1]
  v_exp_f32 v224, v224
  v_exp_f32 v225, v225
  v_exp_f32 v176, v176
  s_waitcnt lgkmcnt(2)
  v_mfma_f32_32x32x16_bf16 v[80:95], v[36:39], v[156:159], v[80:95]
  v_exp_f32 v177, v177
  v_pk_fma_f32 v[226:227], v[178:179], v[248:249], v[216:217] op_sel_hi:[1,0,0]
  v_pk_fma_f32 v[178:179], v[178:179], v[248:249], v[216:217] op_sel:[0,1,1]
  v_exp_f32 v226, v226
  s_waitcnt lgkmcnt(1)
  v_mfma_f32_32x32x16_bf16 v[96:111], v[40:43], v[144:147], 0
  v_exp_f32 v227, v227
  v_exp_f32 v178, v178
  v_exp_f32 v179, v179
  s_waitcnt lgkmcnt(0)
  v_mfma_f32_32x32x16_bf16 v[96:111], v[44:47], v[148:151], v[96:111]
  v_pk_fma_f32 v[228:229], v[180:181], v[248:249], v[216:217] op_sel_hi:[1,0,0]
  v_pk_fma_f32 v[180:181], v[180:181], v[248:249], v[216:217] op_sel:[0,1,1]
  v_exp_f32 v228, v228
  v_exp_f32 v229, v229
  v_exp_f32 v180, v180
  v_exp_f32 v181, v181
  v_pk_fma_f32 v[230:231], v[182:183], v[248:249], v[216:217] op_sel_hi:[1,0,0]
  ds_read_b128 v[16:19], v13 offset:0
  ds_read_b128 v[20:23], v13 offset:1024
  ds_read_b128 v[24:27], v13 offset:2048
  ds_read_b128 v[28:31], v13 offset:3072
  v_rcp_f32 v4, v63
  v_rcp_f32 v5, v79
  v_fmaak_f32 v2, v62, v4, 0x358637bd
  v_fmac_f32 v2, v78, v5
  v_rcp_f32 v2, v2
  s_nop 0
  v_mul_f32 v4, v4, v2
  v_mul_f32 v5, v5, v2
  v_pk_mul_f32 v[48:49], v[48:49], v[4:5] op_sel_hi:[1,0]
  v_pk_mul_f32 v[50:51], v[50:51], v[4:5] op_sel_hi:[1,0]
  v_pk_mul_f32 v[52:53], v[52:53], v[4:5] op_sel_hi:[1,0]
  v_pk_mul_f32 v[54:55], v[54:55], v[4:5] op_sel_hi:[1,0]
  v_pk_fma_f32 v[48:49], v[64:65], v[4:5], v[48:49] op_sel:[0,1,0]
  v_pk_fma_f32 v[50:51], v[66:67], v[4:5], v[50:51] op_sel:[0,1,0]
  v_pk_fma_f32 v[52:53], v[68:69], v[4:5], v[52:53] op_sel:[0,1,0]
  v_pk_fma_f32 v[54:55], v[70:71], v[4:5], v[54:55] op_sel:[0,1,0]
  v_cvt_pk_bf16_f32 v112, v48, v49
  v_cvt_pk_bf16_f32 v113, v50, v51
  v_cvt_pk_bf16_f32 v114, v52, v53
  v_cvt_pk_bf16_f32 v115, v54, v55
  buffer_store_dwordx4 v[112:115], v1, s[32:35], s50 offen offset:0 sc1
  v_pk_mul_f32 v[56:57], v[56:57], v[4:5] op_sel_hi:[1,0]
  v_pk_mul_f32 v[58:59], v[58:59], v[4:5] op_sel_hi:[1,0]
  v_pk_mul_f32 v[60:61], v[60:61], v[4:5] op_sel_hi:[1,0]
  v_pk_fma_f32 v[56:57], v[72:73], v[4:5], v[56:57] op_sel:[0,1,0]
  v_pk_fma_f32 v[58:59], v[74:75], v[4:5], v[58:59] op_sel:[0,1,0]
  v_pk_fma_f32 v[60:61], v[76:77], v[4:5], v[60:61] op_sel:[0,1,0]
  v_cvt_pk_bf16_f32 v116, v56, v57
  v_cvt_pk_bf16_f32 v117, v58, v59
  v_cvt_pk_bf16_f32 v118, v60, v61
  s_setprio 1
  s_waitcnt lgkmcnt(3)
  v_mfma_f32_32x32x16_bf16 v[48:63], v[16:19], v[168:171], 0
  v_pk_fma_f32 v[182:183], v[182:183], v[248:249], v[216:217] op_sel:[0,1,1]
  v_exp_f32 v230, v230
  v_exp_f32 v231, v231
  v_exp_f32 v182, v182
  s_waitcnt lgkmcnt(2)
  v_mfma_f32_32x32x16_bf16 v[48:63], v[20:23], v[172:175], v[48:63]
  v_exp_f32 v183, v183
  v_pk_fma_f32 v[232:233], v[184:185], v[248:249], v[216:217] op_sel_hi:[1,0,0]
  v_pk_fma_f32 v[184:185], v[184:185], v[248:249], v[216:217] op_sel:[0,1,1]
  v_exp_f32 v232, v232
  s_waitcnt lgkmcnt(1)
  v_mfma_f32_32x32x16_bf16 v[64:79], v[24:27], v[160:163], 0
  v_exp_f32 v233, v233
  v_exp_f32 v184, v184
  v_exp_f32 v185, v185
  s_waitcnt lgkmcnt(0)
  v_mfma_f32_32x32x16_bf16 v[64:79], v[28:31], v[164:167], v[64:79]
  v_pk_fma_f32 v[234:235], v[186:187], v[248:249], v[216:217] op_sel_hi:[1,0,0]
  v_pk_fma_f32 v[186:187], v[186:187], v[248:249], v[216:217] op_sel:[0,1,1]
  v_exp_f32 v234, v234
  v_exp_f32 v235, v235
  v_exp_f32 v186, v186
  v_exp_f32 v187, v187
  v_pk_fma_f32 v[236:237], v[188:189], v[248:249], v[216:217] op_sel_hi:[1,0,0]
  ds_read_b128 v[32:35], v13 offset:8192
  ds_read_b128 v[36:39], v13 offset:9216
  ds_read_b128 v[40:43], v13 offset:10240
  ds_read_b128 v[44:47], v13 offset:11264
  v_rcp_f32 v4, v95
  v_rcp_f32 v5, v111
  v_fmaak_f32 v2, v94, v4, 0x358637bd
  v_fmac_f32 v2, v110, v5
  v_rcp_f32 v2, v2
  s_nop 0
  v_mul_f32 v4, v4, v2
  v_mul_f32 v5, v5, v2
  v_pk_mul_f32 v[80:81], v[80:81], v[4:5] op_sel_hi:[1,0]
  v_pk_mul_f32 v[82:83], v[82:83], v[4:5] op_sel_hi:[1,0]
  v_pk_mul_f32 v[84:85], v[84:85], v[4:5] op_sel_hi:[1,0]
  v_pk_mul_f32 v[86:87], v[86:87], v[4:5] op_sel_hi:[1,0]
  v_pk_fma_f32 v[80:81], v[96:97], v[4:5], v[80:81] op_sel:[0,1,0]
  v_pk_fma_f32 v[82:83], v[98:99], v[4:5], v[82:83] op_sel:[0,1,0]
  v_pk_fma_f32 v[84:85], v[100:101], v[4:5], v[84:85] op_sel:[0,1,0]
  v_pk_fma_f32 v[86:87], v[102:103], v[4:5], v[86:87] op_sel:[0,1,0]
  v_cvt_pk_bf16_f32 v119, v80, v81
  buffer_store_dwordx4 v[116:119], v1, s[32:35], s50 offen offset:1024 sc1
  v_cvt_pk_bf16_f32 v120, v82, v83
  v_cvt_pk_bf16_f32 v121, v84, v85
  v_cvt_pk_bf16_f32 v122, v86, v87
  v_pk_mul_f32 v[88:89], v[88:89], v[4:5] op_sel_hi:[1,0]
  v_pk_mul_f32 v[90:91], v[90:91], v[4:5] op_sel_hi:[1,0]
  v_pk_mul_f32 v[92:93], v[92:93], v[4:5] op_sel_hi:[1,0]
  v_pk_fma_f32 v[88:89], v[104:105], v[4:5], v[88:89] op_sel:[0,1,0]
  v_pk_fma_f32 v[90:91], v[106:107], v[4:5], v[90:91] op_sel:[0,1,0]
  v_pk_fma_f32 v[92:93], v[108:109], v[4:5], v[92:93] op_sel:[0,1,0]
  v_cvt_pk_bf16_f32 v123, v88, v89
  buffer_store_dwordx4 v[120:123], v1, s[32:35], s50 offen offset:2048 sc1
  v_cvt_pk_bf16_f32 v124, v90, v91
  v_cvt_pk_bf16_f32 v125, v92, v93
  s_setprio 0
  v_pk_fma_f32 v[188:189], v[188:189], v[248:249], v[216:217] op_sel:[0,1,1]
  v_exp_f32 v236, v236
  v_exp_f32 v237, v237
  v_exp_f32 v188, v188
  v_exp_f32 v189, v189
  v_cvt_pk_bf16_f32 v176, v176, v177
  v_cvt_pk_bf16_f32 v177, v178, v179
  v_cvt_pk_bf16_f32 v178, v180, v181
  v_cvt_pk_bf16_f32 v179, v182, 0
  v_cvt_pk_bf16_f32 v180, v183, v184
  v_cvt_pk_bf16_f32 v181, v185, v186
  v_cvt_pk_bf16_f32 v182, v187, v188
  v_cvt_pk_bf16_f32 v183, v189, 0
  v_cvt_pk_bf16_f32 v184, v224, v225
  v_cvt_pk_bf16_f32 v185, v226, v227
  v_cvt_pk_bf16_f32 v186, v228, v229
  v_cvt_pk_bf16_f32 v187, v230, 0
  v_cvt_pk_bf16_f32 v188, v231, v232
  v_cvt_pk_bf16_f32 v189, v233, v234
  v_cvt_pk_bf16_f32 v190, v235, v236
  v_cvt_pk_bf16_f32 v191, v237, 0
  s_waitcnt lgkmcnt(3)
  v_mfma_f32_32x32x16_bf16 v[80:95], v[32:35], v[184:187], 0
  v_rcp_f32 v4, v63
  v_rcp_f32 v5, v79
  v_fmaak_f32 v2, v62, v4, 0x358637bd
  v_fmac_f32 v2, v78, v5
  v_rcp_f32 v2, v2
  s_waitcnt lgkmcnt(2)
  v_mfma_f32_32x32x16_bf16 v[80:95], v[36:39], v[188:191], v[80:95]
  v_mul_f32 v4, v4, v2
  v_mul_f32 v5, v5, v2
  v_pk_mul_f32 v[48:49], v[48:49], v[4:5] op_sel_hi:[1,0]
  v_pk_mul_f32 v[50:51], v[50:51], v[4:5] op_sel_hi:[1,0]
  s_waitcnt lgkmcnt(1)
  v_mfma_f32_32x32x16_bf16 v[96:111], v[40:43], v[176:179], 0
  v_pk_mul_f32 v[52:53], v[52:53], v[4:5] op_sel_hi:[1,0]
  v_pk_mul_f32 v[54:55], v[54:55], v[4:5] op_sel_hi:[1,0]
  v_pk_fma_f32 v[48:49], v[64:65], v[4:5], v[48:49] op_sel:[0,1,0]
  v_pk_fma_f32 v[50:51], v[66:67], v[4:5], v[50:51] op_sel:[0,1,0]
  v_pk_fma_f32 v[52:53], v[68:69], v[4:5], v[52:53] op_sel:[0,1,0]
  s_waitcnt lgkmcnt(0)
  v_mfma_f32_32x32x16_bf16 v[96:111], v[44:47], v[180:183], v[96:111]
  v_pk_fma_f32 v[54:55], v[70:71], v[4:5], v[54:55] op_sel:[0,1,0]
  v_cvt_pk_bf16_f32 v126, v48, v49
  v_cvt_pk_bf16_f32 v127, v50, v51
  buffer_store_dwordx4 v[124:127], v1, s[32:35], s50 offen offset:3072 sc1
  v_cvt_pk_bf16_f32 v128, v52, v53
  v_cvt_pk_bf16_f32 v129, v54, v55
  v_pk_mul_f32 v[56:57], v[56:57], v[4:5] op_sel_hi:[1,0]
  v_pk_mul_f32 v[58:59], v[58:59], v[4:5] op_sel_hi:[1,0]
  v_pk_mul_f32 v[60:61], v[60:61], v[4:5] op_sel_hi:[1,0]
  v_pk_fma_f32 v[56:57], v[72:73], v[4:5], v[56:57] op_sel:[0,1,0]
  v_pk_fma_f32 v[58:59], v[74:75], v[4:5], v[58:59] op_sel:[0,1,0]
  v_pk_fma_f32 v[60:61], v[76:77], v[4:5], v[60:61] op_sel:[0,1,0]
  v_cvt_pk_bf16_f32 v130, v56, v57
  v_cvt_pk_bf16_f32 v131, v58, v59
  s_add_u32 s50, s50, 4096
  buffer_store_dwordx4 v[128:131], v1, s[32:35], s50 offen offset:0 sc1
  v_cvt_pk_bf16_f32 v132, v60, v61
  s_setprio 1
  v_rcp_f32 v4, v95
  v_rcp_f32 v5, v111
  v_fmaak_f32 v2, v94, v4, 0x358637bd
  v_fmac_f32 v2, v110, v5
  v_rcp_f32 v2, v2
  s_nop 0
  v_mul_f32 v4, v4, v2
  v_mul_f32 v5, v5, v2
  v_pk_mul_f32 v[80:81], v[80:81], v[4:5] op_sel_hi:[1,0]
  v_pk_mul_f32 v[82:83], v[82:83], v[4:5] op_sel_hi:[1,0]
  v_pk_mul_f32 v[84:85], v[84:85], v[4:5] op_sel_hi:[1,0]
  v_pk_mul_f32 v[86:87], v[86:87], v[4:5] op_sel_hi:[1,0]
  v_pk_fma_f32 v[80:81], v[96:97], v[4:5], v[80:81] op_sel:[0,1,0]
  v_pk_fma_f32 v[82:83], v[98:99], v[4:5], v[82:83] op_sel:[0,1,0]
  v_pk_fma_f32 v[84:85], v[100:101], v[4:5], v[84:85] op_sel:[0,1,0]
  v_pk_fma_f32 v[86:87], v[102:103], v[4:5], v[86:87] op_sel:[0,1,0]
  v_cvt_pk_bf16_f32 v133, v80, v81
  v_cvt_pk_bf16_f32 v134, v82, v83
  v_cvt_pk_bf16_f32 v135, v84, v85
  buffer_store_dwordx4 v[132:135], v1, s[32:35], s50 offen offset:1024 sc1
  v_cvt_pk_bf16_f32 v136, v86, v87
  v_pk_mul_f32 v[88:89], v[88:89], v[4:5] op_sel_hi:[1,0]
  v_pk_mul_f32 v[90:91], v[90:91], v[4:5] op_sel_hi:[1,0]
  v_pk_mul_f32 v[92:93], v[92:93], v[4:5] op_sel_hi:[1,0]
  v_pk_fma_f32 v[88:89], v[104:105], v[4:5], v[88:89] op_sel:[0,1,0]
  v_pk_fma_f32 v[90:91], v[106:107], v[4:5], v[90:91] op_sel:[0,1,0]
  v_pk_fma_f32 v[92:93], v[108:109], v[4:5], v[92:93] op_sel:[0,1,0]
  v_cvt_pk_bf16_f32 v137, v88, v89
  v_cvt_pk_bf16_f32 v138, v90, v91
  v_cvt_pk_bf16_f32 v139, v92, v93
  buffer_store_dwordx4 v[136:139], v1, s[32:35], s50 offen offset:2048 sc1
  s_endpgm
.p2align 3
L_Q1:
  s_and_b32 s37, s36, 3
  v_and_b32 v15, 63, v0
  s_lshl_b32 s38, s37, 10
  s_and_b32 s39, s2, 1
  s_lshl3_add_u32 s42, s39, s41
  s_mul_i32 s54, s42, 56
  s_and_b32 s57, s54, 15
  s_sub_u32 s54, s54, s57
  s_add_u32 s54, s54, 896
  s_add_u32 s62, s61, 1
  v_mov_b32 v208, 0x3f803f80
  v_mov_b32 v209, 0x3f803f80
  s_add_u32 s64, s63, 1
  v_mov_b32 v210, 0x3b124925
  v_bfe_u32 v240, v15, 4, 1
  s_add_u32 s66, s65, 1
  v_and_b32 v241, 3, v15
  v_bfe_u32 v242, v15, 2, 2
  s_mul_i32 s60, s60, 172032
  v_lshrrev_b32 v243, 5, v15
  v_mov_b32 v212, 0xffff
  s_mul_i32 s61, s61, 172032
  v_mov_b32 v213, 0
  v_lshlrev_b32 v11, 4, v241
  s_mul_i32 s62, s62, 172032
  v_lshlrev_b64 v[212:213], v11, v[212:213]
  v_lshlrev_b32 v1, 4, v15
  s_mul_i32 s63, s63, 172032
  v_xor_b32 v14, v248, v250
  v_lshlrev_b32 v224, 4, v14
  s_mul_i32 s64, s64, 172032
  v_lshrrev_b32 v14, 1, v250
  v_lshl_add_u32 v224, v14, 12, v224
  s_mul_i32 s65, s65, 172032
  v_and_b32 v14, 1, v250
  v_lshl_add_u32 v224, v14, 9, v224
  s_mul_i32 s66, s66, 172032
  v_lshl_add_u32 v224, s55, 10, v224
  v_add_u32 v225, 0x10000, v224
  s_mov_b64 s[84:85], s[14:15]
  v_xor_b32 v226, 2048, v224
  s_mov_b64 s[86:87], s[16:17]
  v_xor_b32 v227, 2048, v225
  v_xor_b32 v249, v242, v240
  s_mov_b64 s[24:25], s[18:19]
  v_and_b32 v249, 1, v249
  v_mul_u32_u24 v2, 2688, v248
  s_mov_b64 s[16:17], s[10:11]
  v_mul_u32_u24 v14, 896, v249
  v_add3_u32 v2, v2, v14, s54
  s_mov_b64 s[12:13], s[8:9]
  v_add_u32 v2, v11, v2
  v_xor_b32 v14, v243, v15
  s_mov_b64 s[8:9], s[82:83]
  v_lshl_add_u32 v244, v14, 4, s38
  v_xor_b32 v245, 32, v244
  s_mov_b32 s10, 1204224
  v_xor_b32 v246, 64, v244
  v_xor_b32 v247, 96, v244
  s_mov_b32 s11, 0x20000
  v_lshl_add_u32 v11, v240, 2, v241
  v_lshl_add_u32 v11, v11, 3, s57
  s_mov_b32 s34, 268435456
  v_and_b32 v11, 63, v11
  v_lshrrev_b32 v12, 1, v242
  s_mov_b32 s35, 0x20000
  v_xor_b32 v12, 1, v12
  v_lshl_add_u32 v11, v12, 6, v11
  s_mov_b32 s14, 25088
  v_lshl_add_u32 v11, v242, 7, v11
  v_lshl_add_u32 v220, v243, 10, v11
  s_mov_b32 s15, 0x20000
  v_add_u32 v220, 98304, v220
  s_mul_i32 s51, s39, 12544
  s_add_u32 s51, s51, s38
  v_lshrrev_b32 v11, 4, v15
  v_lshlrev_b32 v12, 2, v11
  v_and_b32 v13, 15, v15
  v_xor_b32 v12, v12, v13
  v_min_u32 v12, 13, v12
  v_lshl_add_u32 v11, s37, 2, v11
  v_mul_u32_u24 v3, 2688, v11
  v_lshl_add_u32 v3, v12, 4, v3
  s_mul_i32 s54, s39, 448
  v_add_u32 v3, s54, v3
  s_waitcnt lgkmcnt(0)
  s_load_dword s44, s[32:33], 0
  v_lshl_add_u32 v11, v240, 2, v241
  v_lshlrev_b32 v11, 3, v11
  v_add_u32 v11, 56, v11
  v_lshlrev_b32 v12, 6, v242
  v_xor_b32 v11, v11, v12
  v_lshl_add_u32 v11, v242, 8, v11
  v_lshl_add_u32 v6, v243, 11, v11
  v_lshl_add_u32 v11, v240, 2, v241
  v_lshlrev_b32 v11, 3, v11
  v_add_u32 v11, 168, v11
  v_lshlrev_b32 v12, 6, v242
  v_xor_b32 v11, v11, v12
  v_lshl_add_u32 v11, v242, 8, v11
  v_lshl_add_u32 v7, v243, 11, v11
  s_lshl2_add_u32 s50, s40, s37
  s_mul_i32 s50, s50, 147456
  s_add_u32 s50, s50, 8388608
  v_lshl_add_u32 v11, v243, 2, v242
  buffer_load_dwordx4 v[132:135], v252, s[4:7], s89 offen offset:0
  buffer_load_dwordx4 v[136:139], v252, s[4:7], s89 offen offset:128
  buffer_load_dwordx4 v[140:143], v252, s[4:7], s90 offen offset:0
  buffer_load_dwordx4 v[144:147], v252, s[4:7], s90 offen offset:128
  buffer_load_dwordx4 v[148:151], v252, s[4:7], s91 offen offset:0
  buffer_load_dwordx4 v[152:155], v252, s[4:7], s91 offen offset:128
  s_setprio 1
  s_waitcnt vmcnt(6)
  v_mfma_f32_4x4x4_16b_bf16 v[192:195], v[208:209], v[128:129], 0
  v_mfma_f32_4x4x4_16b_bf16 v[196:199], v[128:129], v[128:129], 0
  v_mfma_f32_4x4x4_16b_bf16 v[200:203], v[208:209], v[130:131], 0
  v_mfma_f32_4x4x4_16b_bf16 v[204:207], v[130:131], v[130:131], 0
  s_waitcnt vmcnt(5)
  v_mfma_f32_4x4x4_16b_bf16 v[192:195], v[208:209], v[132:133], v[192:195]
  v_mfma_f32_4x4x4_16b_bf16 v[196:199], v[132:133], v[132:133], v[196:199]
  v_mfma_f32_4x4x4_16b_bf16 v[200:203], v[208:209], v[134:135], v[200:203]
  v_mfma_f32_4x4x4_16b_bf16 v[204:207], v[134:135], v[134:135], v[204:207]
  s_waitcnt vmcnt(4)
  v_mfma_f32_4x4x4_16b_bf16 v[192:195], v[208:209], v[136:137], v[192:195]
  buffer_load_dwordx4 v[156:159], v254, s[4:7], s88 offen offset:0
  v_mfma_f32_4x4x4_16b_bf16 v[196:199], v[136:137], v[136:137], v[196:199]
  v_mfma_f32_4x4x4_16b_bf16 v[200:203], v[208:209], v[138:139], v[200:203]
  v_mfma_f32_4x4x4_16b_bf16 v[204:207], v[138:139], v[138:139], v[204:207]
  s_waitcnt vmcnt(4)
  v_mfma_f32_4x4x4_16b_bf16 v[192:195], v[208:209], v[140:141], v[192:195]
  buffer_load_dwordx4 v[160:163], v254, s[4:7], s89 offen offset:0
  v_mfma_f32_4x4x4_16b_bf16 v[196:199], v[140:141], v[140:141], v[196:199]
  v_mfma_f32_4x4x4_16b_bf16 v[200:203], v[208:209], v[142:143], v[200:203]
  v_mfma_f32_4x4x4_16b_bf16 v[204:207], v[142:143], v[142:143], v[204:207]
  s_waitcnt vmcnt(4)
  v_mfma_f32_4x4x4_16b_bf16 v[192:195], v[208:209], v[144:145], v[192:195]
  buffer_load_dwordx4 v[164:167], v254, s[4:7], s89 offen offset:128
  v_mfma_f32_4x4x4_16b_bf16 v[196:199], v[144:145], v[144:145], v[196:199]
  v_mfma_f32_4x4x4_16b_bf16 v[200:203], v[208:209], v[146:147], v[200:203]
  v_mfma_f32_4x4x4_16b_bf16 v[204:207], v[146:147], v[146:147], v[204:207]
  s_waitcnt vmcnt(4)
  v_mfma_f32_4x4x4_16b_bf16 v[192:195], v[208:209], v[148:149], v[192:195]
  buffer_load_dwordx4 v[168:171], v254, s[4:7], s90 offen offset:0
  v_mfma_f32_4x4x4_16b_bf16 v[196:199], v[148:149], v[148:149], v[196:199]
  v_mfma_f32_4x4x4_16b_bf16 v[200:203], v[208:209], v[150:151], v[200:203]
  v_mfma_f32_4x4x4_16b_bf16 v[204:207], v[150:151], v[150:151], v[204:207]
  s_waitcnt vmcnt(4)
  v_mfma_f32_4x4x4_16b_bf16 v[192:195], v[208:209], v[152:153], v[192:195]
  buffer_load_dwordx4 v[172:175], v254, s[4:7], s90 offen offset:128
  v_mfma_f32_4x4x4_16b_bf16 v[196:199], v[152:153], v[152:153], v[196:199]
  v_mfma_f32_4x4x4_16b_bf16 v[200:203], v[208:209], v[154:155], v[200:203]
  v_mfma_f32_4x4x4_16b_bf16 v[204:207], v[154:155], v[154:155], v[204:207]
  buffer_load_dwordx4 v[176:179], v254, s[4:7], s91 offen offset:0
  s_nop 3
  v_add_f32 v192, v192, v200
  v_add_f32 v196, v196, v204
  v_add_f32 v197, v197, v205
  v_add_f32 v198, v198, v206
  v_add_f32 v199, v199, v207
  v_add_f32_dpp v216, v192, v192 quad_perm:[1,0,3,2] row_mask:0xf bank_mask:0xf
  v_mov_b32_dpp v217, v196 quad_perm:[0,0,0,0] row_mask:0xf bank_mask:0xf
  v_mov_b32_dpp v218, v197 quad_perm:[1,1,1,1] row_mask:0xf bank_mask:0xf
  v_add_f32_dpp v216, v216, v216 quad_perm:[2,3,0,1] row_mask:0xf bank_mask:0xf
  v_add_f32_dpp v217, v198, v217 quad_perm:[2,2,2,2] row_mask:0xf bank_mask:0xf
  v_add_f32_dpp v218, v199, v218 quad_perm:[3,3,3,3] row_mask:0xf bank_mask:0xf
  v_add_f32_dpp v216, v216, v216 row_half_mirror row_mask:0xf bank_mask:0xf
  v_add_f32 v217, v217, v218
  v_mul_f32 v216, 0xbb124925, v216
  v_mul_f32 v218, v216, v216
  v_add_f32_dpp v217, v217, v217 row_half_mirror row_mask:0xf bank_mask:0xf
  buffer_load_dwordx4 v[180:183], v254, s[4:7], s91 offen offset:128
  v_fma_f32 v217, v217, v210, -v218
  v_max_f32 v217, 0, v217
  v_add_f32 v217, 0x3727c5ac, v217
  v_rsq_f32 v217, v217
  s_nop 0
  v_cvt_pk_bf16_f32 v218, v217, v217
  v_and_b32 v184, v212, v218
  v_and_b32 v185, v213, v218
  v_and_b32 v218, 0xffff0000, v218
  v_sub_f32 v218, v217, v218
  v_cvt_pk_bf16_f32 v218, v218, v218
  v_and_b32 v186, v212, v218
  v_and_b32 v187, v213, v218
  v_mul_f32 v188, v216, v217
  v_mul_f32 v189, v216, v217
  v_mul_f32 v190, v216, v217
  v_mul_f32 v191, v216, v217
  s_nop 1
  v_mfma_f32_4x4x4_16b_bf16 v[16:19], v[184:185], v[128:129], v[188:191]
  v_mfma_f32_4x4x4_16b_bf16 v[20:23], v[184:185], v[130:131], v[188:191]
  v_mfma_f32_4x4x4_16b_bf16 v[24:27], v[184:185], v[132:133], v[188:191]
  v_mfma_f32_4x4x4_16b_bf16 v[16:19], v[186:187], v[128:129], v[16:19]
  v_mfma_f32_4x4x4_16b_bf16 v[20:23], v[186:187], v[130:131], v[20:23]
  v_mfma_f32_4x4x4_16b_bf16 v[28:31], v[184:185], v[134:135], v[188:191]
  s_nop 3
  v_cvt_pk_bf16_f32 v128, v16, v17
  v_mfma_f32_4x4x4_16b_bf16 v[24:27], v[186:187], v[132:133], v[24:27]
  v_cvt_pk_bf16_f32 v129, v18, v19
  v_mfma_f32_4x4x4_16b_bf16 v[32:35], v[184:185], v[136:137], v[188:191]
  v_cvt_pk_bf16_f32 v130, v20, v21
  v_mfma_f32_4x4x4_16b_bf16 v[28:31], v[186:187], v[134:135], v[28:31]
  v_cvt_pk_bf16_f32 v131, v22, v23
  ds_write_b128 v224, v[128:131] offset:0
  v_mfma_f32_4x4x4_16b_bf16 v[36:39], v[184:185], v[138:139], v[188:191]
  v_cvt_pk_bf16_f32 v132, v24, v25
  v_mfma_f32_4x4x4_16b_bf16 v[32:35], v[186:187], v[136:137], v[32:35]
  v_cvt_pk_bf16_f32 v133, v26, v27
  v_mfma_f32_4x4x4_16b_bf16 v[40:43], v[184:185], v[140:141], v[188:191]
  v_cvt_pk_bf16_f32 v134, v28, v29
  v_mfma_f32_4x4x4_16b_bf16 v[36:39], v[186:187], v[138:139], v[36:39]
  v_cvt_pk_bf16_f32 v135, v30, v31
  ds_write_b128 v224, v[132:135] offset:16384
  v_mfma_f32_4x4x4_16b_bf16 v[44:47], v[184:185], v[142:143], v[188:191]
  v_cvt_pk_bf16_f32 v136, v32, v33
  v_mfma_f32_4x4x4_16b_bf16 v[40:43], v[186:187], v[140:141], v[40:43]
  v_cvt_pk_bf16_f32 v137, v34, v35
  v_mfma_f32_4x4x4_16b_bf16 v[48:51], v[184:185], v[144:145], v[188:191]
  v_cvt_pk_bf16_f32 v138, v36, v37
  v_mfma_f32_4x4x4_16b_bf16 v[44:47], v[186:187], v[142:143], v[44:47]
  v_cvt_pk_bf16_f32 v139, v38, v39
  ds_write_b128 v224, v[136:139] offset:32768
  s_add_u32 m0, s38, 118784
  s_add_u32 s46, s60, 86016
  buffer_load_dwordx4 v2, s[8:11], s46 offen lds
  v_mfma_f32_4x4x4_16b_bf16 v[52:55], v[184:185], v[146:147], v[188:191]
  v_cvt_pk_bf16_f32 v140, v40, v41
  v_mfma_f32_4x4x4_16b_bf16 v[48:51], v[186:187], v[144:145], v[48:51]
  v_cvt_pk_bf16_f32 v141, v42, v43
  v_mfma_f32_4x4x4_16b_bf16 v[56:59], v[184:185], v[148:149], v[188:191]
  v_cvt_pk_bf16_f32 v142, v44, v45
  v_mfma_f32_4x4x4_16b_bf16 v[52:55], v[186:187], v[146:147], v[52:55]
  v_cvt_pk_bf16_f32 v143, v46, v47
  ds_write_b128 v224, v[140:143] offset:49152
  v_mfma_f32_4x4x4_16b_bf16 v[60:63], v[184:185], v[150:151], v[188:191]
  v_cvt_pk_bf16_f32 v144, v48, v49
  v_mfma_f32_4x4x4_16b_bf16 v[56:59], v[186:187], v[148:149], v[56:59]
  v_cvt_pk_bf16_f32 v145, v50, v51
  v_mfma_f32_4x4x4_16b_bf16 v[64:67], v[184:185], v[152:153], v[188:191]
  v_cvt_pk_bf16_f32 v146, v52, v53
  v_mfma_f32_4x4x4_16b_bf16 v[60:63], v[186:187], v[150:151], v[60:63]
  v_cvt_pk_bf16_f32 v147, v54, v55
  ds_write_b128 v225, v[144:147] offset:0
  v_mfma_f32_4x4x4_16b_bf16 v[68:71], v[184:185], v[154:155], v[188:191]
  v_cvt_pk_bf16_f32 v148, v56, v57
  v_mfma_f32_4x4x4_16b_bf16 v[64:67], v[186:187], v[152:153], v[64:67]
  v_cvt_pk_bf16_f32 v149, v58, v59
  v_cvt_pk_bf16_f32 v150, v60, v61
  v_mfma_f32_4x4x4_16b_bf16 v[68:71], v[186:187], v[154:155], v[68:71]
  v_cvt_pk_bf16_f32 v151, v62, v63
  ds_write_b128 v225, v[148:151] offset:16384
  s_add_u32 m0, s38, 126976
  s_add_u32 s46, s61, 86016
  buffer_load_dwordx4 v2, s[8:11], s46 offen lds
  v_cvt_pk_bf16_f32 v152, v64, v65
  v_cvt_pk_bf16_f32 v153, v66, v67
  v_cvt_pk_bf16_f32 v154, v68, v69
  v_cvt_pk_bf16_f32 v155, v70, v71
  ds_write_b128 v225, v[152:155] offset:32768
  s_setprio 0
  s_waitcnt vmcnt(8)
  v_mfma_f32_4x4x4_16b_bf16 v[192:195], v[208:209], v[156:157], 0
  v_mfma_f32_4x4x4_16b_bf16 v[196:199], v[156:157], v[156:157], 0
  v_mfma_f32_4x4x4_16b_bf16 v[200:203], v[208:209], v[158:159], 0
  v_mfma_f32_4x4x4_16b_bf16 v[204:207], v[158:159], v[158:159], 0
  s_waitcnt vmcnt(7)
  v_mfma_f32_4x4x4_16b_bf16 v[192:195], v[208:209], v[160:161], v[192:195]
  v_mfma_f32_4x4x4_16b_bf16 v[196:199], v[160:161], v[160:161], v[196:199]
  v_mfma_f32_4x4x4_16b_bf16 v[200:203], v[208:209], v[162:163], v[200:203]
  v_mfma_f32_4x4x4_16b_bf16 v[204:207], v[162:163], v[162:163], v[204:207]
  s_waitcnt vmcnt(6)
  v_mfma_f32_4x4x4_16b_bf16 v[192:195], v[208:209], v[164:165], v[192:195]
  v_mfma_f32_4x4x4_16b_bf16 v[196:199], v[164:165], v[164:165], v[196:199]
  v_mfma_f32_4x4x4_16b_bf16 v[200:203], v[208:209], v[166:167], v[200:203]
  v_mfma_f32_4x4x4_16b_bf16 v[204:207], v[166:167], v[166:167], v[204:207]
  s_waitcnt vmcnt(5)
  v_mfma_f32_4x4x4_16b_bf16 v[192:195], v[208:209], v[168:169], v[192:195]
  v_mfma_f32_4x4x4_16b_bf16 v[196:199], v[168:169], v[168:169], v[196:199]
  v_mfma_f32_4x4x4_16b_bf16 v[200:203], v[208:209], v[170:171], v[200:203]
  v_mfma_f32_4x4x4_16b_bf16 v[204:207], v[170:171], v[170:171], v[204:207]
  s_waitcnt vmcnt(4)
  v_mfma_f32_4x4x4_16b_bf16 v[192:195], v[208:209], v[172:173], v[192:195]
  v_mfma_f32_4x4x4_16b_bf16 v[196:199], v[172:173], v[172:173], v[196:199]
  v_mfma_f32_4x4x4_16b_bf16 v[200:203], v[208:209], v[174:175], v[200:203]
  v_mfma_f32_4x4x4_16b_bf16 v[204:207], v[174:175], v[174:175], v[204:207]
  s_waitcnt vmcnt(3)
  v_mfma_f32_4x4x4_16b_bf16 v[192:195], v[208:209], v[176:177], v[192:195]
  v_mfma_f32_4x4x4_16b_bf16 v[196:199], v[176:177], v[176:177], v[196:199]
  v_mfma_f32_4x4x4_16b_bf16 v[200:203], v[208:209], v[178:179], v[200:203]
  v_mfma_f32_4x4x4_16b_bf16 v[204:207], v[178:179], v[178:179], v[204:207]
  s_waitcnt vmcnt(2)
  v_mfma_f32_4x4x4_16b_bf16 v[192:195], v[208:209], v[180:181], v[192:195]
  v_mfma_f32_4x4x4_16b_bf16 v[196:199], v[180:181], v[180:181], v[196:199]
  v_mfma_f32_4x4x4_16b_bf16 v[200:203], v[208:209], v[182:183], v[200:203]
  v_mfma_f32_4x4x4_16b_bf16 v[204:207], v[182:183], v[182:183], v[204:207]
  s_nop 4
  v_add_f32 v192, v192, v200
  v_add_f32 v196, v196, v204
  v_add_f32 v197, v197, v205
  v_add_f32 v198, v198, v206
  v_add_f32 v199, v199, v207
  v_add_f32_dpp v216, v192, v192 quad_perm:[1,0,3,2] row_mask:0xf bank_mask:0xf
  v_mov_b32_dpp v217, v196 quad_perm:[0,0,0,0] row_mask:0xf bank_mask:0xf
  v_mov_b32_dpp v218, v197 quad_perm:[1,1,1,1] row_mask:0xf bank_mask:0xf
  v_add_f32_dpp v216, v216, v216 quad_perm:[2,3,0,1] row_mask:0xf bank_mask:0xf
  v_add_f32_dpp v217, v198, v217 quad_perm:[2,2,2,2] row_mask:0xf bank_mask:0xf
  v_add_f32_dpp v218, v199, v218 quad_perm:[3,3,3,3] row_mask:0xf bank_mask:0xf
  v_add_f32_dpp v216, v216, v216 row_half_mirror row_mask:0xf bank_mask:0xf
  v_add_f32 v217, v217, v218
  v_mul_f32 v216, 0xbb124925, v216
  v_mul_f32 v218, v216, v216
  v_add_f32_dpp v217, v217, v217 row_half_mirror row_mask:0xf bank_mask:0xf
  v_fma_f32 v217, v217, v210, -v218
  v_max_f32 v217, 0, v217
  v_add_f32 v217, 0x3727c5ac, v217
  v_rsq_f32 v217, v217
  s_nop 0
  v_cvt_pk_bf16_f32 v218, v217, v217
  v_and_b32 v184, v212, v218
  v_and_b32 v185, v213, v218
  v_and_b32 v218, 0xffff0000, v218
  v_sub_f32 v218, v217, v218
  v_cvt_pk_bf16_f32 v218, v218, v218
  v_and_b32 v186, v212, v218
  v_and_b32 v187, v213, v218
  v_mul_f32 v188, v216, v217
  v_mul_f32 v189, v216, v217
  v_mul_f32 v190, v216, v217
  v_mul_f32 v191, v216, v217
  s_nop 1
  v_mfma_f32_4x4x4_16b_bf16 v[72:75], v[184:185], v[156:157], v[188:191]
  v_mfma_f32_4x4x4_16b_bf16 v[76:79], v[184:185], v[158:159], v[188:191]
  v_mfma_f32_4x4x4_16b_bf16 v[80:83], v[184:185], v[160:161], v[188:191]
  v_mfma_f32_4x4x4_16b_bf16 v[72:75], v[186:187], v[156:157], v[72:75]
  v_mfma_f32_4x4x4_16b_bf16 v[76:79], v[186:187], v[158:159], v[76:79]
  v_mfma_f32_4x4x4_16b_bf16 v[84:87], v[184:185], v[162:163], v[188:191]
  s_nop 3
  v_cvt_pk_bf16_f32 v156, v72, v73
  v_mfma_f32_4x4x4_16b_bf16 v[80:83], v[186:187], v[160:161], v[80:83]
  v_cvt_pk_bf16_f32 v157, v74, v75
  v_mfma_f32_4x4x4_16b_bf16 v[88:91], v[184:185], v[164:165], v[188:191]
  v_cvt_pk_bf16_f32 v158, v76, v77
  v_mfma_f32_4x4x4_16b_bf16 v[84:87], v[186:187], v[162:163], v[84:87]
  v_cvt_pk_bf16_f32 v159, v78, v79
  ds_write_b128 v226, v[156:159] offset:0
  v_mfma_f32_4x4x4_16b_bf16 v[92:95], v[184:185], v[166:167], v[188:191]
  v_cvt_pk_bf16_f32 v160, v80, v81
  v_mfma_f32_4x4x4_16b_bf16 v[88:91], v[186:187], v[164:165], v[88:91]
  v_cvt_pk_bf16_f32 v161, v82, v83
  v_mfma_f32_4x4x4_16b_bf16 v[96:99], v[184:185], v[168:169], v[188:191]
  v_cvt_pk_bf16_f32 v162, v84, v85
  v_mfma_f32_4x4x4_16b_bf16 v[92:95], v[186:187], v[166:167], v[92:95]
  v_cvt_pk_bf16_f32 v163, v86, v87
  ds_write_b128 v226, v[160:163] offset:16384
  v_mfma_f32_4x4x4_16b_bf16 v[100:103], v[184:185], v[170:171], v[188:191]
  v_cvt_pk_bf16_f32 v164, v88, v89
  v_mfma_f32_4x4x4_16b_bf16 v[96:99], v[186:187], v[168:169], v[96:99]
  v_cvt_pk_bf16_f32 v165, v90, v91
  v_mfma_f32_4x4x4_16b_bf16 v[104:107], v[184:185], v[172:173], v[188:191]
  v_cvt_pk_bf16_f32 v166, v92, v93
  v_mfma_f32_4x4x4_16b_bf16 v[100:103], v[186:187], v[170:171], v[100:103]
  v_cvt_pk_bf16_f32 v167, v94, v95
  ds_write_b128 v226, v[164:167] offset:32768
  v_mfma_f32_4x4x4_16b_bf16 v[108:111], v[184:185], v[174:175], v[188:191]
  v_cvt_pk_bf16_f32 v168, v96, v97
  v_mfma_f32_4x4x4_16b_bf16 v[104:107], v[186:187], v[172:173], v[104:107]
  v_cvt_pk_bf16_f32 v169, v98, v99
  v_mfma_f32_4x4x4_16b_bf16 v[112:115], v[184:185], v[176:177], v[188:191]
  v_cvt_pk_bf16_f32 v170, v100, v101
  v_mfma_f32_4x4x4_16b_bf16 v[108:111], v[186:187], v[174:175], v[108:111]
  v_cvt_pk_bf16_f32 v171, v102, v103
  ds_write_b128 v226, v[168:171] offset:49152
  v_mfma_f32_4x4x4_16b_bf16 v[116:119], v[184:185], v[178:179], v[188:191]
  v_cvt_pk_bf16_f32 v172, v104, v105
  v_mfma_f32_4x4x4_16b_bf16 v[112:115], v[186:187], v[176:177], v[112:115]
  v_cvt_pk_bf16_f32 v173, v106, v107
  v_mfma_f32_4x4x4_16b_bf16 v[120:123], v[184:185], v[180:181], v[188:191]
  v_cvt_pk_bf16_f32 v174, v108, v109
  v_mfma_f32_4x4x4_16b_bf16 v[116:119], v[186:187], v[178:179], v[116:119]
  v_cvt_pk_bf16_f32 v175, v110, v111
  ds_write_b128 v227, v[172:175] offset:0
  v_mfma_f32_4x4x4_16b_bf16 v[124:127], v[184:185], v[182:183], v[188:191]
  v_cvt_pk_bf16_f32 v176, v112, v113
  v_mfma_f32_4x4x4_16b_bf16 v[120:123], v[186:187], v[180:181], v[120:123]
  v_cvt_pk_bf16_f32 v177, v114, v115
  v_cvt_pk_bf16_f32 v178, v116, v117
  v_mfma_f32_4x4x4_16b_bf16 v[124:127], v[186:187], v[182:183], v[124:127]
  v_cvt_pk_bf16_f32 v179, v118, v119
  ds_write_b128 v227, v[176:179] offset:16384
  s_nop 0
  v_cvt_pk_bf16_f32 v180, v120, v121
  v_cvt_pk_bf16_f32 v181, v122, v123
  s_nop 0
  v_cvt_pk_bf16_f32 v182, v124, v125
  v_cvt_pk_bf16_f32 v183, v126, v127
  ds_write_b128 v227, v[180:183] offset:32768
  s_waitcnt vmcnt(0) lgkmcnt(0)
  s_barrier
  ds_read_b128 v[16:19], v244 offset:0
  ds_read_b64_tr_b16 v[192:193], v220 offset:16384
  ds_read_b64_tr_b16 v[194:195], v220 offset:16896
  ds_read_b128 v[20:23], v245 offset:4096
  ds_read_b64_tr_b16 v[196:197], v220 offset:18432
  ds_read_b64_tr_b16 v[198:199], v220 offset:18944
  ds_read_b128 v[24:27], v246 offset:8192
  ds_read_b64_tr_b16 v[200:201], v220 offset:20480
  ds_read_b64_tr_b16 v[202:203], v220 offset:20992
  ds_read_b128 v[28:31], v247 offset:12288
  ds_read_b64_tr_b16 v[204:205], v220 offset:22528
  ds_read_b64_tr_b16 v[206:207], v220 offset:23040
  ds_read_b64_tr_b16 v[208:209], v220 offset:24576
  ds_read_b64_tr_b16 v[210:211], v220 offset:25088
  s_waitcnt lgkmcnt(8)
  v_mfma_f32_32x32x16_bf16 v[160:175], v[16:19], v[192:195], 0
  v_mul_u32_u24 v11, 56, v11
  ds_read_b128 v[32:35], v244 offset:16384
  s_mul_i32 s43, s44, 0x9E3779B1
  s_add_u32 s43, s43, 0x7F4A7C15
  ds_read_b64_tr_b16 v[212:213], v220 offset:26624
  ds_read_b64_tr_b16 v[214:215], v220 offset:27136
  v_mfma_f32_32x32x16_bf16 v[160:175], v[20:23], v[196:199], v[160:175]
  v_lshl_add_u32 v12, v240, 2, v241
  ds_read_b128 v[36:39], v245 offset:20480
  s_and_b32 s45, s44, 0xfff
  s_add_u32 s45, s45, 1
  ds_read_b64_tr_b16 v[192:193], v220 offset:28672
  ds_read_b64_tr_b16 v[194:195], v220 offset:29184
  s_waitcnt lgkmcnt(8)
  v_mfma_f32_32x32x16_bf16 v[160:175], v[24:27], v[200:203], v[160:175]
  v_lshl_add_u32 v221, v12, 3, v11
  ds_read_b128 v[40:43], v246 offset:24576
  s_lshl_b32 s45, s45, 16
  s_add_u32 s45, s45, s44
  ds_read_b64_tr_b16 v[196:197], v220 offset:30720
  ds_read_b64_tr_b16 v[198:199], v220 offset:31232
  s_waitcnt lgkmcnt(8)
  v_mfma_f32_32x32x16_bf16 v[160:175], v[28:31], v[204:207], v[160:175]
  s_barrier
  v_mfma_f32_32x32x16_bf16 v[160:175], v[32:35], v[208:211], v[160:175]
  ds_read_b64_tr_b16 v[200:201], v220 offset:32768
  ds_read_b64_tr_b16 v[202:203], v220 offset:33280
  v_lshl_add_u32 v8, v243, 18, v221
  ds_read_b128 v[44:47], v247 offset:28672
  s_and_b32 s45, s45, 0x1fff0000
  s_or_b32 s45, s45, 0x40000000
  v_and_b32 v11, 1, v242
  ds_read_b128 v[48:51], v244 offset:32768
  s_add_u32 m0, s38, 118784
  s_add_u32 s46, s66, 86016
  buffer_load_dwordx4 v2, s[8:11], s46 offen lds
  ds_read_b64_tr_b16 v[204:205], v220 offset:34816
  ds_read_b64_tr_b16 v[206:207], v220 offset:35328
  s_waitcnt lgkmcnt(9)
  v_mfma_f32_32x32x16_bf16 v[160:175], v[36:39], v[212:215], v[160:175]
  ds_read_b128 v[52:55], v245 offset:36864
  ds_read_b64_tr_b16 v[208:209], v220 offset:36864
  ds_read_b64_tr_b16 v[210:211], v220 offset:37376
  s_waitcnt lgkmcnt(11)
  v_mfma_f32_32x32x16_bf16 v[160:175], v[40:43], v[192:195], v[160:175]
  v_xor_b32 v11, v11, v240
  ds_read_b128 v[56:59], v246 offset:40960
  ds_read_b64_tr_b16 v[212:213], v220 offset:38912
  ds_read_b64_tr_b16 v[214:215], v220 offset:39424
  s_waitcnt lgkmcnt(10)
  s_waitcnt lgkmcnt(9)
  v_mfma_f32_32x32x16_bf16 v[160:175], v[44:47], v[196:199], v[160:175]
  v_and_b32 v12, 1, v241
  ds_read_b128 v[60:63], v247 offset:45056
  s_add_u32 m0, s38, 4096
  s_add_u32 s46, s51, 4096
  buffer_load_dwordx4 v1, s[12:15], s46 offen lds
  ds_read_b64_tr_b16 v[192:193], v220 offset:40960
  ds_read_b64_tr_b16 v[194:195], v220 offset:41472
  s_waitcnt lgkmcnt(11)
  v_mfma_f32_32x32x16_bf16 v[160:175], v[48:51], v[200:203], v[160:175]
  v_xor_b32 v12, v12, v243
  ds_read_b128 v[64:67], v244 offset:49152
  ds_read_b64_tr_b16 v[196:197], v220 offset:43008
  ds_read_b64_tr_b16 v[198:199], v220 offset:43520
  s_waitcnt lgkmcnt(9)
  v_mfma_f32_32x32x16_bf16 v[160:175], v[52:55], v[204:207], v[160:175]
  v_lshl_add_u32 v11, v12, 1, v11
  ds_read_b128 v[68:71], v245 offset:53248
  s_add_u32 m0, s38, 12288
  s_add_u32 s46, s51, 12288
  buffer_load_dwordx4 v1, s[12:15], s46 offen lds
  ds_read_b64_tr_b16 v[200:201], v220 offset:45056
  ds_read_b64_tr_b16 v[202:203], v220 offset:45568
  s_waitcnt lgkmcnt(11)
  v_mfma_f32_32x32x16_bf16 v[160:175], v[56:59], v[208:211], v[160:175]
  ds_read_b128 v[72:75], v246 offset:57344
  ds_read_b64_tr_b16 v[204:205], v220 offset:47104
  ds_read_b64_tr_b16 v[206:207], v220 offset:47616
  s_waitcnt lgkmcnt(8)
  v_mfma_f32_32x32x16_bf16 v[160:175], v[60:63], v[212:215], v[160:175]
  s_barrier
  v_mfma_f32_32x32x16_bf16 v[160:175], v[64:67], v[192:195], v[160:175]
  ds_read_b64_tr_b16 v[208:209], v220 offset:49152
  ds_read_b64_tr_b16 v[210:211], v220 offset:49664
  s_and_b32 s54, s37, 1
  ds_read_b128 v[76:79], v247 offset:61440
  v_lshrrev_b32 v12, 1, v242
  v_add_u32 v244, 65536, v244
  ds_read_b128 v[80:83], v244 offset:0
  s_add_u32 m0, s38, 20480
  s_add_u32 s46, s60, 43008
  buffer_load_dwordx4 v3, s[8:11], s46 offen lds
  ds_read_b64_tr_b16 v[212:213], v220 offset:51200
  ds_read_b64_tr_b16 v[214:215], v220 offset:51712
  s_waitcnt lgkmcnt(9)
  v_mfma_f32_32x32x16_bf16 v[160:175], v[68:71], v[196:199], v[160:175]
  v_xor_b32 v12, s54, v12
  v_add_u32 v245, 65536, v245
  ds_read_b128 v[84:87], v245 offset:4096
  ds_read_b64_tr_b16 v[192:193], v220 offset:53248
  ds_read_b64_tr_b16 v[194:195], v220 offset:53760
  s_waitcnt lgkmcnt(11)
  v_mfma_f32_32x32x16_bf16 v[160:175], v[72:75], v[200:203], v[160:175]
  v_lshl_add_u32 v11, v12, 2, v11
  v_add_u32 v246, 65536, v246
  ds_read_b128 v[88:91], v246 offset:8192
  s_add_u32 m0, s38, 28672
  s_add_u32 s46, s60, 129024
  buffer_load_dwordx4 v3, s[8:11], s46 offen lds
  ds_read_b64_tr_b16 v[196:197], v220 offset:55296
  ds_read_b64_tr_b16 v[198:199], v220 offset:55808
  s_waitcnt lgkmcnt(10)
  s_waitcnt lgkmcnt(9)
  v_mfma_f32_32x32x16_bf16 v[160:175], v[76:79], v[204:207], v[160:175]
  v_lshrrev_b32 v12, 1, v241
  v_add_u32 v247, 65536, v247
  ds_read_b128 v[92:95], v247 offset:12288
  ds_read_b64_tr_b16 v[200:201], v220 offset:57344
  ds_read_b64_tr_b16 v[202:203], v220 offset:57856
  s_waitcnt lgkmcnt(11)
  v_mfma_f32_32x32x16_bf16 v[160:175], v[80:83], v[208:211], v[160:175]
  ds_read_b128 v[96:99], v244 offset:16384
  s_add_u32 m0, s38, 126976
  s_add_u32 s46, s61, 43008
  buffer_load_dwordx4 v3, s[8:11], s46 offen lds
  ds_read_b64_tr_b16 v[204:205], v220 offset:59392
  ds_read_b64_tr_b16 v[206:207], v220 offset:59904
  s_waitcnt lgkmcnt(9)
  v_mfma_f32_32x32x16_bf16 v[160:175], v[84:87], v[212:215], v[160:175]
  v_lshl_add_u32 v11, v11, 1, v12
  ds_read_b128 v[100:103], v245 offset:20480
  ds_read_b64_tr_b16 v[208:209], v220 offset:61440
  ds_read_b64_tr_b16 v[210:211], v220 offset:61952
  s_waitcnt lgkmcnt(11)
  v_mfma_f32_32x32x16_bf16 v[160:175], v[88:91], v[192:195], v[160:175]
  v_lshl_add_u32 v12, v243, 2, v242
  ds_read_b128 v[104:107], v246 offset:24576
  s_add_u32 m0, s38, 135168
  s_add_u32 s46, s61, 129024
  buffer_load_dwordx4 v3, s[8:11], s46 offen lds
  ds_read_b64_tr_b16 v[212:213], v220 offset:63488
  ds_read_b64_tr_b16 v[214:215], v220 offset:64000
  s_waitcnt vmcnt(3)
  s_waitcnt lgkmcnt(8)
  v_mfma_f32_32x32x16_bf16 v[160:175], v[92:95], v[196:199], v[160:175]
  s_barrier
  v_mfma_f32_32x32x16_bf16 v[160:175], v[96:99], v[200:203], v[160:175]
  ds_read_b64_tr_b16 v[192:193], v220 offset:16384
  ds_read_b64_tr_b16 v[194:195], v220 offset:16896
  v_lshlrev_b32 v12, 7, v12
  ds_read_b128 v[108:111], v247 offset:28672
  v_lshl_add_u32 v222, v11, 3, v12
  ds_read_b128 v[112:115], v244 offset:32768
  s_add_u32 m0, s38, 61440
  s_add_u32 s46, s62, 43008
  buffer_load_dwordx4 v3, s[8:11], s46 offen lds
  ds_read_b64_tr_b16 v[196:197], v220 offset:18432
  ds_read_b64_tr_b16 v[198:199], v220 offset:18944
  s_waitcnt lgkmcnt(9)
  v_mfma_f32_32x32x16_bf16 v[160:175], v[100:103], v[204:207], v[160:175]
  ds_read_b128 v[116:119], v245 offset:36864
  ds_read_b64_tr_b16 v[200:201], v220 offset:20480
  ds_read_b64_tr_b16 v[202:203], v220 offset:20992
  s_waitcnt lgkmcnt(11)
  v_mfma_f32_32x32x16_bf16 v[160:175], v[104:107], v[208:211], v[160:175]
  ds_read_b128 v[120:123], v246 offset:40960
  s_add_u32 m0, s38, 69632
  s_add_u32 s46, s62, 129024
  buffer_load_dwordx4 v3, s[8:11], s46 offen lds
  v_lshl_add_u32 v14, s37, 11, v1
  ds_read_b64_tr_b16 v[204:205], v220 offset:22528
  ds_read_b64_tr_b16 v[206:207], v220 offset:23040
  s_waitcnt lgkmcnt(10)
  s_waitcnt lgkmcnt(9)
  v_mfma_f32_32x32x16_bf16 v[160:175], v[108:111], v[212:215], v[160:175]
  ds_read_b128 v[124:127], v247 offset:45056
  v_and_b32 v11, 31, v15
  v_subrev_u32 v12, 26, v11
  ds_read_b64_tr_b16 v[208:209], v6 offset:16384
  ds_read_b64_tr_b16 v[210:211], v6 offset:17408
  s_waitcnt vmcnt(3)
  s_waitcnt lgkmcnt(8)
  v_mfma_f32_32x32x16_bf16 v[160:175], v[112:115], v[192:195], v[160:175]
  s_barrier
  v_mfma_f32_32x32x16_bf16 v[160:175], v[116:119], v[196:199], v[160:175]
  ds_read_b64_tr_b16 v[212:213], v6 offset:20480
  ds_read_b64_tr_b16 v[214:215], v6 offset:21504
  s_add_u32 m0, s38, 77824
  s_add_u32 s46, s63, 43008
  buffer_load_dwordx4 v3, s[8:11], s46 offen lds
  v_cmp_gt_u32 vcc, 4, v12
  v_xor_b32 v12, 96, v14
  s_nop 0
  v_cndmask_b32 v13, v14, v12, vcc
  ds_read_b64_tr_b16 v[192:193], v6 offset:24576
  ds_read_b64_tr_b16 v[194:195], v6 offset:25600
  s_waitcnt lgkmcnt(7)
  v_mfma_f32_32x32x16_bf16 v[160:175], v[120:123], v[200:203], v[160:175]
  s_add_u32 m0, s38, 143360
  s_add_u32 s46, s63, 129024
  buffer_load_dwordx4 v3, s[8:11], s46 offen lds
  v_mov_b32 v12, 0x3f803f80
  ds_read_b64_tr_b16 v[196:197], v6 offset:28672
  ds_read_b64_tr_b16 v[198:199], v6 offset:29696
  s_waitcnt lgkmcnt(8)
  v_mfma_f32_32x32x16_bf16 v[160:175], v[124:127], v[204:207], v[160:175]
  v_cmp_lt_u32 vcc, 27, v11
  v_add_u32 v6, 98304, v6
  ds_read_b64_tr_b16 v[200:201], v6 offset:24576
  ds_read_b64_tr_b16 v[202:203], v6 offset:25600
  s_waitcnt lgkmcnt(6)
  v_mfma_f32_32x32x16_bf16 v[128:143], v[208:211], v[16:19], 0
  s_add_u32 m0, s38, 151552
  s_add_u32 s46, s64, 43008
  buffer_load_dwordx4 v3, s[8:11], s46 offen lds
  ds_read_b64_tr_b16 v[204:205], v6 offset:28672
  ds_read_b64_tr_b16 v[206:207], v6 offset:29696
  s_waitcnt vmcnt(3)
  s_waitcnt lgkmcnt(6)
  v_mfma_f32_32x32x16_bf16 v[128:143], v[212:215], v[20:23], v[128:143]
  s_barrier
  v_mfma_f32_32x32x16_bf16 v[128:143], v[192:195], v[24:27], v[128:143]
  ds_read_b64_tr_b16 v[208:209], v6 offset:32768
  ds_read_b64_tr_b16 v[210:211], v6 offset:33792
  v_cvt_pk_bf16_f32 v160, v160, v161
  v_cvt_pk_bf16_f32 v161, v162, v163
  v_cndmask_b32 v160, v160, v12, vcc
  v_cvt_pk_bf16_f32 v162, v164, v165
  ds_read_b64_tr_b16 v[212:213], v6 offset:36864
  ds_read_b64_tr_b16 v[214:215], v6 offset:37888
  s_waitcnt lgkmcnt(6)
  v_mfma_f32_32x32x16_bf16 v[128:143], v[196:199], v[28:31], v[128:143]
  v_cndmask_b32 v161, v161, v12, vcc
  v_cvt_pk_bf16_f32 v163, v166, v167
  v_cndmask_b32 v162, v162, v12, vcc
  v_add_u32 v6, 4294901760, v6
  ds_read_b64_tr_b16 v[192:193], v6 offset:24576
  ds_read_b64_tr_b16 v[194:195], v6 offset:25600
  v_mfma_f32_32x32x16_bf16 v[128:143], v[200:203], v[32:35], v[128:143]
  v_cvt_pk_bf16_f32 v164, v168, v169
  v_cndmask_b32 v163, v163, v12, vcc
  v_cvt_pk_bf16_f32 v165, v170, v171
  ds_read_b64_tr_b16 v[196:197], v6 offset:28672
  ds_read_b64_tr_b16 v[198:199], v6 offset:29696
  s_waitcnt lgkmcnt(6)
  v_mfma_f32_32x32x16_bf16 v[128:143], v[204:207], v[36:39], v[128:143]
  s_add_u32 m0, s38, 86016
  s_add_u32 s46, s64, 129024
  buffer_load_dwordx4 v3, s[8:11], s46 offen lds
  v_cndmask_b32 v164, v164, v12, vcc
  v_cvt_pk_bf16_f32 v166, v172, v173
  v_cndmask_b32 v165, v165, v12, vcc
  ds_read_b64_tr_b16 v[200:201], v6 offset:32768
  ds_read_b64_tr_b16 v[202:203], v6 offset:33792
  v_mfma_f32_32x32x16_bf16 v[128:143], v[208:211], v[40:43], v[128:143]
  v_cvt_pk_bf16_f32 v167, v174, v175
  v_cndmask_b32 v166, v166, v12, vcc
  v_cndmask_b32 v167, v167, v12, vcc
  ds_read_b64_tr_b16 v[204:205], v6 offset:36864
  ds_read_b64_tr_b16 v[206:207], v6 offset:37888
  s_waitcnt vmcnt(1)
  s_waitcnt lgkmcnt(6)
  v_mfma_f32_32x32x16_bf16 v[128:143], v[212:215], v[44:47], v[128:143]
  s_barrier
  v_mfma_f32_32x32x16_bf16 v[128:143], v[192:195], v[48:51], v[128:143]
  ds_read_b64_tr_b16 v[208:209], v6 offset:40960
  ds_read_b64_tr_b16 v[210:211], v6 offset:41984
  ds_write_b128 v13, v[160:163] offset:49152
  s_add_u32 m0, s38, 94208
  s_add_u32 s46, s65, 43008
  buffer_load_dwordx4 v3, s[8:11], s46 offen lds
  ds_read_b64_tr_b16 v[212:213], v7 offset:16384
  ds_read_b64_tr_b16 v[214:215], v7 offset:17408
  s_waitcnt lgkmcnt(7)
  v_mfma_f32_32x32x16_bf16 v[128:143], v[196:199], v[52:55], v[128:143]
  ds_write_b128 v13, v[164:167] offset:50176
  ds_read_b64_tr_b16 v[192:193], v6 offset:45056
  ds_read_b64_tr_b16 v[194:195], v6 offset:46080
  v_mfma_f32_32x32x16_bf16 v[128:143], v[200:203], v[56:59], v[128:143]
  ds_read_b64_tr_b16 v[196:197], v7 offset:20480
  ds_read_b64_tr_b16 v[198:199], v7 offset:21504
  s_waitcnt lgkmcnt(8)
  v_mfma_f32_32x32x16_bf16 v[128:143], v[204:207], v[60:63], v[128:143]
  v_add_u32 v6, 65536, v6
  ds_read_b64_tr_b16 v[200:201], v6 offset:40960
  ds_read_b64_tr_b16 v[202:203], v6 offset:41984
  v_mfma_f32_32x32x16_bf16 v[128:143], v[208:211], v[64:67], v[128:143]
  s_add_u32 m0, s38, 159744
  s_add_u32 s46, s65, 129024
  buffer_load_dwordx4 v3, s[8:11], s46 offen lds
  ds_read_b64_tr_b16 v[204:205], v7 offset:24576
  ds_read_b64_tr_b16 v[206:207], v7 offset:25600
  s_waitcnt lgkmcnt(6)
  v_mfma_f32_32x32x16_bf16 v[144:159], v[212:215], v[16:19], 0
  ds_read_b64_tr_b16 v[208:209], v6 offset:45056
  ds_read_b64_tr_b16 v[210:211], v6 offset:46080
  v_mfma_f32_32x32x16_bf16 v[128:143], v[192:195], v[68:71], v[128:143]
  ds_read_b64_tr_b16 v[212:213], v7 offset:28672
  ds_read_b64_tr_b16 v[214:215], v7 offset:29696
  s_waitcnt lgkmcnt(6)
  v_mfma_f32_32x32x16_bf16 v[144:159], v[196:199], v[20:23], v[144:159]
  s_add_u32 m0, s38, 102400
  s_add_u32 s46, s66, 43008
  buffer_load_dwordx4 v3, s[8:11], s46 offen lds
  ds_read_b64_tr_b16 v[192:193], v6 offset:49152
  ds_read_b64_tr_b16 v[194:195], v6 offset:50176
  v_mfma_f32_32x32x16_bf16 v[128:143], v[200:203], v[72:75], v[128:143]
  v_add_u32 v7, 98304, v7
  ds_read_b64_tr_b16 v[196:197], v7 offset:24576
  ds_read_b64_tr_b16 v[198:199], v7 offset:25600
  s_waitcnt vmcnt(2)
  s_waitcnt lgkmcnt(6)
  v_mfma_f32_32x32x16_bf16 v[144:159], v[204:207], v[24:27], v[144:159]
  s_barrier
  v_mfma_f32_32x32x16_bf16 v[128:143], v[208:211], v[76:79], v[128:143]
  ds_read_b64_tr_b16 v[200:201], v6 offset:53248
  ds_read_b64_tr_b16 v[202:203], v6 offset:54272
  s_add_u32 m0, s38, 110592
  s_add_u32 s46, s66, 129024
  buffer_load_dwordx4 v3, s[8:11], s46 offen lds
  ds_read_b64_tr_b16 v[240:241], v222 offset:32768
  ds_read_b64_tr_b16 v[242:243], v222 offset:33792
  ds_read_b128 v[160:163], v1 offset:49152
  ds_read_b64_tr_b16 v[244:245], v222 offset:34816
  ds_read_b64_tr_b16 v[246:247], v222 offset:35840
  ds_read_b128 v[164:167], v1 offset:50176
  ds_read_b64_tr_b16 v[248:249], v222 offset:36864
  ds_read_b64_tr_b16 v[250:251], v222 offset:37888
  ds_read_b128 v[168:171], v1 offset:51200
  s_waitcnt lgkmcnt(6)
  v_mfma_f32_32x32x16_bf16 v[176:191], v[240:243], v[160:163], 0
  ds_read_b64_tr_b16 v[252:253], v222 offset:38912
  ds_read_b64_tr_b16 v[254:255], v222 offset:39936
  ds_read_b128 v[172:175], v1 offset:52224
  ds_read_b64_tr_b16 v[204:205], v7 offset:28672
  ds_read_b64_tr_b16 v[206:207], v7 offset:29696
  v_mfma_f32_32x32x16_bf16 v[144:159], v[212:215], v[28:31], v[144:159]
  s_waitcnt lgkmcnt(8)
  v_mfma_f32_32x32x16_bf16 v[176:191], v[244:247], v[164:167], v[176:191]
  ds_read_b64_tr_b16 v[240:241], v222 offset:40960
  ds_read_b64_tr_b16 v[242:243], v222 offset:41984
  ds_read_b128 v[160:163], v1 offset:53248
  s_waitcnt lgkmcnt(8)
  v_mfma_f32_32x32x16_bf16 v[176:191], v[248:251], v[168:171], v[176:191]
  ds_read_b64_tr_b16 v[244:245], v222 offset:43008
  ds_read_b64_tr_b16 v[246:247], v222 offset:44032
  ds_read_b128 v[164:167], v1 offset:54272
  v_add_u32 v6, 4294934528, v6
  ds_read_b64_tr_b16 v[208:209], v6 offset:16384
  ds_read_b64_tr_b16 v[210:211], v6 offset:17408
  v_mfma_f32_32x32x16_bf16 v[128:143], v[192:195], v[80:83], v[128:143]
  s_add_u32 m0, s38, 118784
  s_add_u32 s46, s60, 43232
  buffer_load_dwordx4 v3, s[8:11], s46 offen lds
  s_waitcnt lgkmcnt(10)
  v_mfma_f32_32x32x16_bf16 v[176:191], v[252:255], v[172:175], v[176:191]
  ds_read_b64_tr_b16 v[248:249], v222 offset:45056
  ds_read_b64_tr_b16 v[250:251], v222 offset:46080
  ds_read_b128 v[168:171], v1 offset:55296
  s_waitcnt lgkmcnt(8)
  v_mfma_f32_32x32x16_bf16 v[176:191], v[240:243], v[160:163], v[176:191]
  ds_read_b64_tr_b16 v[252:253], v222 offset:47104
  ds_read_b64_tr_b16 v[254:255], v222 offset:48128
  ds_read_b128 v[172:175], v1 offset:56320
  ds_read_b64_tr_b16 v[212:213], v7 offset:32768
  ds_read_b64_tr_b16 v[214:215], v7 offset:33792
  v_mfma_f32_32x32x16_bf16 v[144:159], v[196:199], v[32:35], v[144:159]
  s_waitcnt lgkmcnt(10)
  v_mfma_f32_32x32x16_bf16 v[176:191], v[244:247], v[164:167], v[176:191]
  s_waitcnt lgkmcnt(5)
  v_mfma_f32_32x32x16_bf16 v[176:191], v[248:251], v[168:171], v[176:191]
  ds_read_b64_tr_b16 v[192:193], v6 offset:20480
  ds_read_b64_tr_b16 v[194:195], v6 offset:21504
  v_mfma_f32_32x32x16_bf16 v[128:143], v[200:203], v[84:87], v[128:143]
  s_waitcnt lgkmcnt(4)
  v_mfma_f32_32x32x16_bf16 v[176:191], v[252:255], v[172:175], v[176:191]
  ds_read_b64_tr_b16 v[196:197], v7 offset:36864
  ds_read_b64_tr_b16 v[198:199], v7 offset:37888
  v_mfma_f32_32x32x16_bf16 v[144:159], v[204:207], v[36:39], v[144:159]
  s_add_u32 m0, s38, 20480
  s_add_u32 s46, s60, 129248
  buffer_load_dwordx4 v3, s[8:11], s46 offen lds
  s_lshl1_add_u32 s49, s42, s37
  s_lshl4_add_u32 s49, s49, s40
  s_lshl_b32 s52, s49, 11
  s_add_u32 s52, s52, 1048576
  s_cmp_ge_u32 s37, 2
  s_cselect_b32 s57, 0x20000000, s52
  v_cvt_pk_bf16_f32 v176, v176, v177
  v_cvt_pk_bf16_f32 v177, v178, v179
  v_cvt_pk_bf16_f32 v178, v180, v181
  v_cvt_pk_bf16_f32 v179, v182, s45
  buffer_store_dwordx4 v[176:179], v1, s[32:35], s57 offen offset:0 sc1
  v_cvt_pk_bf16_f32 v180, v183, v184
  v_cvt_pk_bf16_f32 v181, v185, v186
  v_cvt_pk_bf16_f32 v182, v187, v188
  v_cvt_pk_bf16_f32 v183, v189, s45
  buffer_store_dwordx4 v[180:183], v1, s[32:35], s57 offen offset:1024 sc1
  ds_read_b64_tr_b16 v[200:201], v6 offset:24576
  ds_read_b64_tr_b16 v[202:203], v6 offset:25600
  s_waitcnt vmcnt(5)
  s_waitcnt lgkmcnt(6)
  v_mfma_f32_32x32x16_bf16 v[128:143], v[208:211], v[88:91], v[128:143]
  s_barrier
  v_mfma_f32_32x32x16_bf16 v[144:159], v[212:215], v[40:43], v[144:159]
  v_add_u32 v7, 4294901760, v7
  ds_read_b64_tr_b16 v[204:205], v7 offset:24576
  ds_read_b64_tr_b16 v[206:207], v7 offset:25600
  s_lshl1_add_u32 s81, s40, s39
  ds_read_b64_tr_b16 v[208:209], v6 offset:28672
  ds_read_b64_tr_b16 v[210:211], v6 offset:29696
  s_waitcnt lgkmcnt(6)
  v_mfma_f32_32x32x16_bf16 v[128:143], v[192:195], v[92:95], v[128:143]
  s_add_u32 m0, s38, 28672
  s_add_u32 s46, s61, 43232
  buffer_load_dwordx4 v3, s[8:11], s46 offen lds
  v_lshrrev_b32 v222, 4, v15
  ds_read_b64_tr_b16 v[212:213], v7 offset:28672
  ds_read_b64_tr_b16 v[214:215], v7 offset:29696
  v_mfma_f32_32x32x16_bf16 v[144:159], v[196:199], v[44:47], v[144:159]
  v_add_u32 v6, 32768, v6
  ds_read_b64_tr_b16 v[192:193], v6 offset:57344
  ds_read_b64_tr_b16 v[194:195], v6 offset:58368
  s_waitcnt lgkmcnt(6)
  v_mfma_f32_32x32x16_bf16 v[128:143], v[200:203], v[96:99], v[128:143]
  s_add_u32 m0, s38, 36864
  s_add_u32 s46, s61, 129248
  buffer_load_dwordx4 v3, s[8:11], s46 offen lds
  s_lshl_b32 s82, s81, 15
  ds_read_b64_tr_b16 v[196:197], v7 offset:32768
  ds_read_b64_tr_b16 v[198:199], v7 offset:33792
  v_mfma_f32_32x32x16_bf16 v[144:159], v[204:207], v[48:51], v[144:159]
  ds_read_b64_tr_b16 v[200:201], v6 offset:61440
  ds_read_b64_tr_b16 v[202:203], v6 offset:62464
  s_waitcnt lgkmcnt(6)
  v_mfma_f32_32x32x16_bf16 v[128:143], v[208:211], v[100:103], v[128:143]
  v_lshlrev_b32 v222, 11, v222
  ds_read_b64_tr_b16 v[204:205], v7 offset:36864
  ds_read_b64_tr_b16 v[206:207], v7 offset:37888
  v_mfma_f32_32x32x16_bf16 v[144:159], v[212:215], v[52:55], v[144:159]
  s_add_u32 m0, s38, 45056
  s_add_u32 s46, s62, 43232
  buffer_load_dwordx4 v3, s[8:11], s46 offen lds
  ds_read_b64_tr_b16 v[208:209], v6 offset:0
  ds_read_b64_tr_b16 v[210:211], v6 offset:1024
  s_waitcnt vmcnt(7)
  s_waitcnt lgkmcnt(6)
  v_mfma_f32_32x32x16_bf16 v[128:143], v[192:195], v[104:107], v[128:143]
  s_barrier
  v_mfma_f32_32x32x16_bf16 v[144:159], v[196:199], v[56:59], v[144:159]
  ds_read_b64_tr_b16 v[212:213], v7 offset:40960
  ds_read_b64_tr_b16 v[214:215], v7 offset:41984
  s_lshl_b32 s54, s36, 8
  v_and_b32 v223, 0xf0, v1
  ds_read_b64_tr_b16 v[192:193], v6 offset:4096
  ds_read_b64_tr_b16 v[194:195], v6 offset:5120
  s_waitcnt lgkmcnt(6)
  v_mfma_f32_32x32x16_bf16 v[128:143], v[200:203], v[108:111], v[128:143]
  s_add_u32 m0, s38, 53248
  s_add_u32 s46, s62, 129248
  buffer_load_dwordx4 v3, s[8:11], s46 offen lds
  ds_read_b64_tr_b16 v[196:197], v7 offset:45056
  ds_read_b64_tr_b16 v[198:199], v7 offset:46080
  v_mfma_f32_32x32x16_bf16 v[144:159], v[204:207], v[60:63], v[144:159]
  s_add_u32 s82, s82, s54
  ds_read_b64_tr_b16 v[200:201], v6 offset:8192
  ds_read_b64_tr_b16 v[202:203], v6 offset:9216
  s_waitcnt lgkmcnt(6)
  v_mfma_f32_32x32x16_bf16 v[128:143], v[208:211], v[112:115], v[128:143]
  s_add_u32 m0, s38, 126976
  s_add_u32 s46, s63, 43232
  buffer_load_dwordx4 v3, s[8:11], s46 offen lds
  v_add_u32 v7, 65536, v7
  ds_read_b64_tr_b16 v[204:205], v7 offset:40960
  ds_read_b64_tr_b16 v[206:207], v7 offset:41984
  v_mfma_f32_32x32x16_bf16 v[144:159], v[212:215], v[64:67], v[144:159]
  v_add_u32 v222, v222, v223
  ds_read_b64_tr_b16 v[208:209], v6 offset:12288
  ds_read_b64_tr_b16 v[210:211], v6 offset:13312
  s_waitcnt lgkmcnt(6)
  v_mfma_f32_32x32x16_bf16 v[128:143], v[192:195], v[116:119], v[128:143]
  ds_read_b64_tr_b16 v[212:213], v7 offset:45056
  ds_read_b64_tr_b16 v[214:215], v7 offset:46080
  v_mfma_f32_32x32x16_bf16 v[144:159], v[196:199], v[68:71], v[144:159]
  s_add_u32 m0, s38, 61440
  s_add_u32 s46, s63, 129248
  buffer_load_dwordx4 v3, s[8:11], s46 offen lds
  s_add_u32 s88, s82, 1048576
  ds_read_b64_tr_b16 v[192:193], v7 offset:49152
  ds_read_b64_tr_b16 v[194:195], v7 offset:50176
  s_waitcnt lgkmcnt(6)
  v_mfma_f32_32x32x16_bf16 v[128:143], v[200:203], v[120:123], v[128:143]
  s_barrier
  v_mfma_f32_32x32x16_bf16 v[144:159], v[204:207], v[72:75], v[144:159]
  ds_read_b64_tr_b16 v[196:197], v7 offset:53248
  ds_read_b64_tr_b16 v[198:199], v7 offset:54272
  s_add_u32 s89, s82, 1056768
  v_add_u32 v7, 4294934528, v7
  ds_read_b64_tr_b16 v[200:201], v7 offset:16384
  ds_read_b64_tr_b16 v[202:203], v7 offset:17408
  s_waitcnt lgkmcnt(6)
  v_mfma_f32_32x32x16_bf16 v[128:143], v[208:211], v[124:127], v[128:143]
  s_add_u32 m0, s38, 135168
  s_add_u32 s46, s64, 43232
  buffer_load_dwordx4 v3, s[8:11], s46 offen lds
  s_add_u32 s90, s82, 1064960
  ds_read_b64_tr_b16 v[204:205], v7 offset:20480
  ds_read_b64_tr_b16 v[206:207], v7 offset:21504
  v_mfma_f32_32x32x16_bf16 v[144:159], v[212:215], v[76:79], v[144:159]
  ds_read_b64_tr_b16 v[208:209], v7 offset:24576
  ds_read_b64_tr_b16 v[210:211], v7 offset:25600
  s_waitcnt lgkmcnt(6)
  v_mfma_f32_32x32x16_bf16 v[144:159], v[192:195], v[80:83], v[144:159]
  s_add_u32 m0, s38, 69632
  s_add_u32 s46, s64, 129248
  buffer_load_dwordx4 v3, s[8:11], s46 offen lds
  ds_read_b64_tr_b16 v[224:225], v221 offset:1568
  ds_read_b64_tr_b16 v[226:227], v221 offset:2016
  ds_read_b64_tr_b16 v[228:229], v221 offset:2464
  ds_read_b64_tr_b16 v[230:231], v8 offset:2912
  v_cvt_pk_bf16_f32 v232, v128, v129
  v_cvt_pk_bf16_f32 v233, v130, v131
  v_cvt_pk_bf16_f32 v234, v132, v133
  v_cvt_pk_bf16_f32 v235, v134, v135
  v_cvt_pk_bf16_f32 v236, v136, v137
  v_cvt_pk_bf16_f32 v237, v138, v139
  v_cvt_pk_bf16_f32 v238, v140, v141
  v_cvt_pk_bf16_f32 v239, v142, v143
  s_waitcnt lgkmcnt(3)
  v_mov_b32_dpp v224, v224 row_shr:2 row_mask:0xa bank_mask:0x8
  s_add_u32 s91, s82, 1073152
  ds_read_b64_tr_b16 v[212:213], v7 offset:28672
  ds_read_b64_tr_b16 v[214:215], v7 offset:29696
  v_mfma_f32_32x32x16_bf16 v[144:159], v[196:199], v[84:87], v[144:159]
  v_mov_b32_dpp v225, v225 row_shr:2 row_mask:0xa bank_mask:0x8
  s_waitcnt lgkmcnt(4)
  v_mov_b32_dpp v226, v226 row_shr:2 row_mask:0xa bank_mask:0x8
  v_mov_b32_dpp v227, v227 row_shr:2 row_mask:0xa bank_mask:0x8
  s_waitcnt lgkmcnt(3)
  v_mov_b32_dpp v228, v228 row_shr:2 row_mask:0xa bank_mask:0x8
  v_mov_b32_dpp v229, v229 row_shr:2 row_mask:0xa bank_mask:0x8
  s_waitcnt lgkmcnt(2)
  v_mov_b32_dpp v230, v230 row_shr:2 row_mask:0xa bank_mask:0x8
  v_mov_b32_dpp v231, v231 row_shr:2 row_mask:0xa bank_mask:0x8
  v_mfma_f32_32x32x16_bf16 v[128:143], v[224:227], v[232:235], 0
  s_nop 0
  v_mfma_f32_32x32x16_bf16 v[128:143], v[228:231], v[236:239], v[128:143]
  v_add_u32 v7, 32768, v7
  ds_read_b64_tr_b16 v[192:193], v7 offset:57344
  ds_read_b64_tr_b16 v[194:195], v7 offset:58368
  v_mfma_f32_32x32x16_bf16 v[144:159], v[200:203], v[88:91], v[144:159]
  s_nop 7
  v_max3_f32 v216, v128, v129, v130
  v_min3_f32 v217, v128, v129, v130
  v_max3_f32 v216, v216, v131, v132
  v_min3_f32 v217, v217, v131, v132
  v_max3_f32 v216, v216, v133, v134
  v_min3_f32 v217, v217, v133, v134
  v_mov_b32 v176, 0x3f80
  v_mov_b32 v177, 0
  v_and_b32 v180, 0x30, v1
  v_lshlrev_b64 v[176:177], v180, v[176:177]
  v_and_b32 v180, 12, v15
  v_cmp_eq_u32 vcc, 4, v180
  v_cmp_eq_u32 s[58:59], 0, v180
  v_lshrrev_b32 v181, 1, v15
  v_cndmask_b32 v178, 0, v176, vcc
  v_and_b32 v181, 0x18, v181
  v_cndmask_b32 v179, 0, v177, vcc
  v_cndmask_b32 v176, 0, v176, s[58:59]
  v_cndmask_b32 v177, 0, v177, s[58:59]
  v_add_u32 v223, v223, v181
  v_and_b32 v181, 32, v15
  v_lshl_add_u32 v223, v181, 24, v223
  ds_read_b64_tr_b16 v[196:197], v7 offset:61440
  ds_read_b64_tr_b16 v[198:199], v7 offset:62464
  v_mfma_f32_32x32x16_bf16 v[144:159], v[204:207], v[92:95], v[144:159]
  s_add_u32 m0, s38, 77824
  s_add_u32 s46, s65, 43232
  buffer_load_dwordx4 v3, s[8:11], s46 offen lds
  v_max3_f32 v216, v216, v135, v136
  v_min3_f32 v217, v217, v135, v136
  v_max3_f32 v216, v216, v137, v138
  v_min3_f32 v217, v217, v137, v138
  v_max3_f32 v216, v216, v139, v140
  v_min3_f32 v217, v217, v139, v140
  v_max_f32 v216, v216, v141
  v_min_f32 v217, v217, v141
  v_mov_b32 v218, v216
  v_mov_b32 v219, v217
  ds_read_b64_tr_b16 v[200:201], v7 offset:0
  ds_read_b64_tr_b16 v[202:203], v7 offset:1024
  v_mfma_f32_32x32x16_bf16 v[144:159], v[208:211], v[96:99], v[144:159]
  v_permlane32_swap_b32 v216, v218
  v_permlane32_swap_b32 v217, v219
  v_max_f32 v216, v216, v218
  v_min_f32 v217, v217, v219
  v_mul_f32 v216, 0xbfb8aa3b, v216
  v_mul_f32 v217, 0x3fb8aa3b, v217
  v_fmamk_f32 v224, v128, 0x3fb8aa3b, v216
  v_fmamk_f32 v128, v128, 0xbfb8aa3b, v217
  v_exp_f32 v224, v224
  buffer_load_dwordx4 v[240:243], v222, s[32:35], s88 offen sc1
  buffer_load_dwordx4 v[244:247], v222, s[32:35], s89 offen sc1
  ds_read_b64_tr_b16 v[204:205], v7 offset:4096
  ds_read_b64_tr_b16 v[206:207], v7 offset:5120
  s_waitcnt lgkmcnt(6)
  v_mfma_f32_32x32x16_bf16 v[144:159], v[212:215], v[100:103], v[144:159]
  v_exp_f32 v128, v128
  v_fmamk_f32 v225, v129, 0x3fb8aa3b, v216
  v_fmamk_f32 v129, v129, 0xbfb8aa3b, v217
  v_exp_f32 v225, v225
  v_exp_f32 v129, v129
  v_fmamk_f32 v226, v130, 0x3fb8aa3b, v216
  buffer_load_dwordx4 v[248:251], v222, s[32:35], s90 offen sc1
  buffer_load_dwordx4 v[252:255], v222, s[32:35], s91 offen sc1
  ds_read_b64_tr_b16 v[208:209], v7 offset:8192
  ds_read_b64_tr_b16 v[210:211], v7 offset:9216
  v_mfma_f32_32x32x16_bf16 v[144:159], v[192:195], v[104:107], v[144:159]
  v_fmamk_f32 v130, v130, 0xbfb8aa3b, v217
  v_exp_f32 v226, v226
  v_exp_f32 v130, v130
  v_fmamk_f32 v227, v131, 0x3fb8aa3b, v216
  v_fmamk_f32 v131, v131, 0xbfb8aa3b, v217
  v_exp_f32 v227, v227
  ds_read_b64_tr_b16 v[212:213], v7 offset:12288
  ds_read_b64_tr_b16 v[214:215], v7 offset:13312
  s_waitcnt vmcnt(9)
  s_waitcnt lgkmcnt(6)
  v_mfma_f32_32x32x16_bf16 v[144:159], v[196:199], v[108:111], v[144:159]
  s_barrier
  v_mfma_f32_32x32x16_bf16 v[144:159], v[200:203], v[112:115], v[144:159]
  ds_read_b64_tr_b16 v[192:193], v6 offset:16384
  ds_read_b64_tr_b16 v[194:195], v6 offset:17408
  v_exp_f32 v131, v131
  v_fmamk_f32 v228, v132, 0x3fb8aa3b, v216
  v_fmamk_f32 v132, v132, 0xbfb8aa3b, v217
  v_exp_f32 v228, v228
  v_exp_f32 v132, v132
  v_fmamk_f32 v229, v133, 0x3fb8aa3b, v216
  v_fmamk_f32 v133, v133, 0xbfb8aa3b, v217
  s_add_u32 m0, s38, 86016
  s_add_u32 s46, s65, 129248
  buffer_load_dwordx4 v3, s[8:11], s46 offen lds
  v_exp_f32 v229, v229
  v_exp_f32 v133, v133
  v_fmamk_f32 v230, v134, 0x3fb8aa3b, v216
  v_fmamk_f32 v134, v134, 0xbfb8aa3b, v217
  v_exp_f32 v230, v230
  v_exp_f32 v134, v134
  ds_read_b64_tr_b16 v[196:197], v6 offset:20480
  ds_read_b64_tr_b16 v[198:199], v6 offset:21504
  s_waitcnt lgkmcnt(6)
  v_mfma_f32_32x32x16_bf16 v[144:159], v[204:207], v[116:119], v[144:159]
  v_fmamk_f32 v231, v135, 0x3fb8aa3b, v216
  v_fmamk_f32 v135, v135, 0xbfb8aa3b, v217
  v_exp_f32 v231, v231
  v_exp_f32 v135, v135
  v_fmamk_f32 v232, v136, 0x3fb8aa3b, v216
  v_fmamk_f32 v136, v136, 0xbfb8aa3b, v217
  v_exp_f32 v232, v232
  v_add_u32 v6, 4294868992, v6
  ds_read_b64_tr_b16 v[200:201], v6 offset:16384
  ds_read_b64_tr_b16 v[202:203], v6 offset:17408
  v_mfma_f32_32x32x16_bf16 v[144:159], v[208:211], v[120:123], v[144:159]
  s_add_u32 m0, s38, 94208
  s_add_u32 s46, s66, 43232
  buffer_load_dwordx4 v3, s[8:11], s46 offen lds
  v_exp_f32 v136, v136
  v_fmamk_f32 v233, v137, 0x3fb8aa3b, v216
  v_fmamk_f32 v137, v137, 0xbfb8aa3b, v217
  v_exp_f32 v233, v233
  v_exp_f32 v137, v137
  v_fmamk_f32 v234, v138, 0x3fb8aa3b, v216
  ds_read_b64_tr_b16 v[204:205], v6 offset:20480
  ds_read_b64_tr_b16 v[206:207], v6 offset:21504
  s_waitcnt lgkmcnt(6)
  v_mfma_f32_32x32x16_bf16 v[144:159], v[212:215], v[124:127], v[144:159]
  v_fmamk_f32 v138, v138, 0xbfb8aa3b, v217
  v_exp_f32 v234, v234
  v_exp_f32 v138, v138
  v_fmamk_f32 v235, v139, 0x3fb8aa3b, v216
  v_fmamk_f32 v139, v139, 0xbfb8aa3b, v217
  v_exp_f32 v235, v235
  v_exp_f32 v139, v139
  ds_read_b64_tr_b16 v[208:209], v6 offset:24576
  ds_read_b64_tr_b16 v[210:211], v6 offset:25600
  v_mfma_f32_32x32x16_bf16 v[160:175], v[192:195], v[16:19], 0
  s_add_u32 m0, s38, 143360
  s_add_u32 s46, s66, 129248
  buffer_load_dwordx4 v3, s[8:11], s46 offen lds
  v_fmamk_f32 v236, v140, 0x3fb8aa3b, v216
  v_fmamk_f32 v140, v140, 0xbfb8aa3b, v217
  v_exp_f32 v236, v236
  v_exp_f32 v140, v140
  v_fmamk_f32 v237, v141, 0x3fb8aa3b, v216
  v_fmamk_f32 v141, v141, 0xbfb8aa3b, v217
  v_exp_f32 v237, v237
  ds_read_b64_tr_b16 v[212:213], v6 offset:28672
  ds_read_b64_tr_b16 v[214:215], v6 offset:29696
  s_waitcnt lgkmcnt(6)
  v_mfma_f32_32x32x16_bf16 v[160:175], v[196:199], v[20:23], v[160:175]
  v_exp_f32 v141, v141
  v_cvt_pk_bf16_f32 v128, v128, v129
  v_cvt_pk_bf16_f32 v129, v130, v131
  v_cvt_pk_bf16_f32 v130, v132, v133
  v_cvt_pk_bf16_f32 v131, v134, 0
  v_cvt_pk_bf16_f32 v132, v135, v136
  v_cvt_pk_bf16_f32 v133, v137, v138
  v_cvt_pk_bf16_f32 v134, v139, v140
  ds_read_b64_tr_b16 v[192:193], v6 offset:32768
  ds_read_b64_tr_b16 v[194:195], v6 offset:33792
  v_mfma_f32_32x32x16_bf16 v[160:175], v[200:203], v[24:27], v[160:175]
  v_cvt_pk_bf16_f32 v135, v141, 0
  v_cvt_pk_bf16_f32 v136, v224, v225
  v_cvt_pk_bf16_f32 v137, v226, v227
  v_cvt_pk_bf16_f32 v138, v228, v229
  v_cvt_pk_bf16_f32 v139, v230, 0
  v_cvt_pk_bf16_f32 v140, v231, v232
  v_cvt_pk_bf16_f32 v141, v233, v234
  v_cvt_pk_bf16_f32 v142, v235, v236
  v_cvt_pk_bf16_f32 v143, v237, 0
  ds_read_b64_tr_b16 v[196:197], v6 offset:36864
  ds_read_b64_tr_b16 v[198:199], v6 offset:37888
  s_waitcnt lgkmcnt(6)
  v_mfma_f32_32x32x16_bf16 v[160:175], v[204:207], v[28:31], v[160:175]
  ds_read_b64_tr_b16 v[224:225], v221 offset:4704
  ds_read_b64_tr_b16 v[226:227], v221 offset:5152
  ds_read_b64_tr_b16 v[228:229], v221 offset:5600
  ds_read_b64_tr_b16 v[230:231], v8 offset:6048
  v_cvt_pk_bf16_f32 v232, v144, v145
  v_cvt_pk_bf16_f32 v233, v146, v147
  v_cvt_pk_bf16_f32 v234, v148, v149
  v_cvt_pk_bf16_f32 v235, v150, v151
  v_cvt_pk_bf16_f32 v236, v152, v153
  ds_read_b64_tr_b16 v[200:201], v6 offset:40960
  ds_read_b64_tr_b16 v[202:203], v6 offset:41984
  v_mfma_f32_32x32x16_bf16 v[160:175], v[208:211], v[32:35], v[160:175]
  v_cvt_pk_bf16_f32 v237, v154, v155
  v_cvt_pk_bf16_f32 v238, v156, v157
  v_cvt_pk_bf16_f32 v239, v158, v159
  s_waitcnt lgkmcnt(5)
  v_mov_b32_dpp v224, v224 row_shr:2 row_mask:0xa bank_mask:0x8
  v_mov_b32_dpp v225, v225 row_shr:2 row_mask:0xa bank_mask:0x8
  s_waitcnt vmcnt(6)
  v_xor_b32 v9, s45, v243
  s_waitcnt vmcnt(5)
  v_bitop3_b32 v9, v247, s45, v9 bitop3:0xbe
  s_waitcnt vmcnt(4)
  v_bitop3_b32 v9, v251, s45, v9 bitop3:0xbe
  s_waitcnt vmcnt(3)
  v_bitop3_b32 v9, v255, s45, v9 bitop3:0xbe
  v_cmp_lt_u32 vcc, 0xffff, v9
  s_cbranch_vccnz L_tslow_162
L_tok_161:
  v_mfma_f32_16x16x32_bf16 v[180:183], v[176:179], v[240:243], 0
  v_mfma_f32_16x16x32_bf16 v[180:183], v[176:179], v[244:247], v[180:183]
  ds_read_b64_tr_b16 v[204:205], v6 offset:45056
  ds_read_b64_tr_b16 v[206:207], v6 offset:46080
  v_mfma_f32_32x32x16_bf16 v[160:175], v[212:215], v[36:39], v[160:175]
  s_waitcnt lgkmcnt(6)
  v_mov_b32_dpp v226, v226 row_shr:2 row_mask:0xa bank_mask:0x8
  v_mov_b32_dpp v227, v227 row_shr:2 row_mask:0xa bank_mask:0x8
  s_waitcnt lgkmcnt(5)
  v_mov_b32_dpp v228, v228 row_shr:2 row_mask:0xa bank_mask:0x8
  v_mov_b32_dpp v229, v229 row_shr:2 row_mask:0xa bank_mask:0x8
  s_waitcnt lgkmcnt(4)
  v_mov_b32_dpp v230, v230 row_shr:2 row_mask:0xa bank_mask:0x8
  v_mfma_f32_16x16x32_bf16 v[180:183], v[176:179], v[248:251], v[180:183]
  v_mfma_f32_16x16x32_bf16 v[180:183], v[176:179], v[252:255], v[180:183]
  s_lshl_b32 s82, s81, 11
  s_lshl_b32 s54, s36, 8
  s_add_u32 s82, s82, s54
  s_add_u32 s82, s82, 3145728
  v_and_b32 v176, 11, v15
  v_lshl_add_u32 v176, s37, 4, v176
  v_and_b32 v176, 27, v176
  v_cmp_ne_u32 vcc, 27, v176
  v_mov_b32 v177, 0x3f803f80
  v_mov_b32 v178, s45
  v_cvt_pk_bf16_f32 v4, v180, v181
  v_cndmask_b32 v183, 1.0, v183, vcc
  s_lshl_b32 s56, s39, 15
  v_cndmask_b32 v182, 1.0, v182, vcc
  s_add_u32 s56, s56, s38
  v_cndmask_b32 v4, v177, v4, vcc
  v_mov_b32_dpp v183, v178 quad_perm:[0,1,2,3] row_mask:0x2 bank_mask:0xf
  s_add_u32 s56, s56, 3145728
  v_cvt_pk_bf16_f32 v5, v182, v183
  buffer_store_dwordx2 v[4:5], v223, s[32:35], s82 offen sc1
  v_mov_b32 v13, v1
  ds_read_b64_tr_b16 v[208:209], v6 offset:49152
  ds_read_b64_tr_b16 v[210:211], v6 offset:50176
  v_mfma_f32_32x32x16_bf16 v[160:175], v[192:195], v[40:43], v[160:175]
  v_mov_b32_dpp v231, v231 row_shr:2 row_mask:0xa bank_mask:0x8
  v_mfma_f32_32x32x16_bf16 v[144:159], v[224:227], v[232:235], 0
  s_nop 0
  v_mfma_f32_32x32x16_bf16 v[144:159], v[228:231], v[236:239], v[144:159]
  ds_read_b64_tr_b16 v[212:213], v6 offset:53248
  ds_read_b64_tr_b16 v[214:215], v6 offset:54272
  s_waitcnt vmcnt(1)
  s_waitcnt lgkmcnt(6)
  v_mfma_f32_32x32x16_bf16 v[160:175], v[196:199], v[44:47], v[160:175]
  s_barrier
  v_mfma_f32_32x32x16_bf16 v[160:175], v[200:203], v[48:51], v[160:175]
  v_add_u32 v6, 98304, v6
  ds_read_b64_tr_b16 v[192:193], v6 offset:24576
  ds_read_b64_tr_b16 v[194:195], v6 offset:25600
  s_nop 1
  v_max3_f32 v216, v144, v145, v146
  v_min3_f32 v217, v144, v145, v146
  v_max3_f32 v216, v216, v147, v148
  v_min3_f32 v217, v217, v147, v148
  v_max3_f32 v216, v216, v149, v150
  v_min3_f32 v217, v217, v149, v150
  v_max3_f32 v216, v216, v151, v152
  ds_read_b64_tr_b16 v[196:197], v6 offset:28672
  ds_read_b64_tr_b16 v[198:199], v6 offset:29696
  s_waitcnt lgkmcnt(6)
  v_mfma_f32_32x32x16_bf16 v[160:175], v[204:207], v[52:55], v[160:175]
  v_min3_f32 v217, v217, v151, v152
  v_max3_f32 v216, v216, v153, v154
  v_min3_f32 v217, v217, v153, v154
  v_max3_f32 v216, v216, v155, v156
  v_min3_f32 v217, v217, v155, v156
  v_add_u32 v6, 4294901760, v6
  ds_read_b64_tr_b16 v[200:201], v6 offset:24576
  ds_read_b64_tr_b16 v[202:203], v6 offset:25600
  v_mfma_f32_32x32x16_bf16 v[160:175], v[208:211], v[56:59], v[160:175]
  v_max_f32 v216, v216, v157
  v_min_f32 v217, v217, v157
  v_mov_b32 v218, v216
  v_mov_b32 v219, v217
  s_nop 0
  v_permlane32_swap_b32 v216, v218
  ds_read_b64_tr_b16 v[204:205], v6 offset:28672
  ds_read_b64_tr_b16 v[206:207], v6 offset:29696
  s_waitcnt lgkmcnt(6)
  v_mfma_f32_32x32x16_bf16 v[160:175], v[212:215], v[60:63], v[160:175]
  v_permlane32_swap_b32 v217, v219
  v_max_f32 v216, v216, v218
  v_min_f32 v217, v217, v219
  v_mul_f32 v216, 0xbfb8aa3b, v216
  v_add_u32 v6, 65536, v6
  ds_read_b64_tr_b16 v[208:209], v6 offset:32768
  ds_read_b64_tr_b16 v[210:211], v6 offset:33792
  v_mfma_f32_32x32x16_bf16 v[160:175], v[192:195], v[64:67], v[160:175]
  v_mul_f32 v217, 0x3fb8aa3b, v217
  v_fmamk_f32 v224, v144, 0x3fb8aa3b, v216
  v_fmamk_f32 v144, v144, 0xbfb8aa3b, v217
  v_exp_f32 v224, v224
  v_exp_f32 v144, v144
  ds_read_b64_tr_b16 v[212:213], v6 offset:36864
  ds_read_b64_tr_b16 v[214:215], v6 offset:37888
  s_waitcnt lgkmcnt(6)
  v_mfma_f32_32x32x16_bf16 v[160:175], v[196:199], v[68:71], v[160:175]
  v_fmamk_f32 v225, v145, 0x3fb8aa3b, v216
  v_fmamk_f32 v145, v145, 0xbfb8aa3b, v217
  v_exp_f32 v225, v225
  v_add_u32 v6, 4294934528, v6
  ds_read_b64_tr_b16 v[192:193], v6 offset:0
  ds_read_b64_tr_b16 v[194:195], v6 offset:1024
  v_mfma_f32_32x32x16_bf16 v[160:175], v[200:203], v[72:75], v[160:175]
  v_exp_f32 v145, v145
  v_fmamk_f32 v226, v146, 0x3fb8aa3b, v216
  v_fmamk_f32 v146, v146, 0xbfb8aa3b, v217
  v_exp_f32 v226, v226
  ds_read_b64_tr_b16 v[196:197], v6 offset:4096
  ds_read_b64_tr_b16 v[198:199], v6 offset:5120
  s_waitcnt lgkmcnt(6)
  v_mfma_f32_32x32x16_bf16 v[160:175], v[204:207], v[76:79], v[160:175]
  v_exp_f32 v146, v146
  v_fmamk_f32 v227, v147, 0x3fb8aa3b, v216
  v_fmamk_f32 v147, v147, 0xbfb8aa3b, v217
  ds_read_b64_tr_b16 v[200:201], v6 offset:8192
  ds_read_b64_tr_b16 v[202:203], v6 offset:9216
  v_mfma_f32_32x32x16_bf16 v[160:175], v[208:211], v[80:83], v[160:175]
  v_exp_f32 v227, v227
  v_exp_f32 v147, v147
  v_fmamk_f32 v228, v148, 0x3fb8aa3b, v216
  v_mov_b32 v252, -1
  v_mov_b32 v253, -1
  v_mov_b32 v254, -1
  v_mov_b32 v255, -1
  s_mul_i32 s47, s39, 14336
  s_add_u32 s50, s47, s50
  s_add_u32 s50, s50, 121856
  s_add_u32 s3, s50, 4096
  ds_read_b64_tr_b16 v[204:205], v6 offset:12288
  ds_read_b64_tr_b16 v[206:207], v6 offset:13312
  s_waitcnt lgkmcnt(6)
  v_mfma_f32_32x32x16_bf16 v[160:175], v[212:215], v[84:87], v[160:175]
  v_fmamk_f32 v148, v148, 0xbfb8aa3b, v217
  v_exp_f32 v228, v228
  v_exp_f32 v148, v148
  buffer_store_dwordx4 v[252:255], v1, s[32:35], s50 offen offset:0 sc1
  ds_read_b64_tr_b16 v[208:209], v6 offset:16384
  ds_read_b64_tr_b16 v[210:211], v6 offset:17408
  v_mfma_f32_32x32x16_bf16 v[160:175], v[192:195], v[88:91], v[160:175]
  v_fmamk_f32 v229, v149, 0x3fb8aa3b, v216
  v_fmamk_f32 v149, v149, 0xbfb8aa3b, v217
  v_exp_f32 v229, v229
  v_exp_f32 v149, v149
  ds_read_b64_tr_b16 v[212:213], v6 offset:20480
  ds_read_b64_tr_b16 v[214:215], v6 offset:21504
  s_waitcnt lgkmcnt(6)
  v_mfma_f32_32x32x16_bf16 v[160:175], v[196:199], v[92:95], v[160:175]
  v_fmamk_f32 v230, v150, 0x3fb8aa3b, v216
  v_fmamk_f32 v150, v150, 0xbfb8aa3b, v217
  v_exp_f32 v230, v230
  buffer_store_dwordx4 v[252:255], v1, s[32:35], s50 offen offset:1024 sc1
  ds_read_b64_tr_b16 v[192:193], v6 offset:24576
  ds_read_b64_tr_b16 v[194:195], v6 offset:25600
  v_mfma_f32_32x32x16_bf16 v[160:175], v[200:203], v[96:99], v[160:175]
  v_exp_f32 v150, v150
  v_fmamk_f32 v231, v151, 0x3fb8aa3b, v216
  v_fmamk_f32 v151, v151, 0xbfb8aa3b, v217
  v_exp_f32 v231, v231
  ds_read_b64_tr_b16 v[196:197], v7 offset:16384
  ds_read_b64_tr_b16 v[198:199], v7 offset:17408
  s_waitcnt lgkmcnt(6)
  v_mfma_f32_32x32x16_bf16 v[160:175], v[204:207], v[100:103], v[160:175]
  v_exp_f32 v151, v151
  v_fmamk_f32 v232, v152, 0x3fb8aa3b, v216
  v_fmamk_f32 v152, v152, 0xbfb8aa3b, v217
  buffer_store_dwordx4 v[252:255], v1, s[32:35], s50 offen offset:2048 sc1
  ds_read_b64_tr_b16 v[200:201], v6 offset:28672
  ds_read_b64_tr_b16 v[202:203], v6 offset:29696
  v_mfma_f32_32x32x16_bf16 v[160:175], v[208:211], v[104:107], v[160:175]
  v_exp_f32 v232, v232
  v_exp_f32 v152, v152
  v_fmamk_f32 v233, v153, 0x3fb8aa3b, v216
  ds_read_b64_tr_b16 v[204:205], v7 offset:20480
  ds_read_b64_tr_b16 v[206:207], v7 offset:21504
  s_waitcnt lgkmcnt(6)
  v_mfma_f32_32x32x16_bf16 v[160:175], v[212:215], v[108:111], v[160:175]
  v_fmamk_f32 v153, v153, 0xbfb8aa3b, v217
  v_exp_f32 v233, v233
  v_exp_f32 v153, v153
  buffer_store_dwordx4 v[252:255], v1, s[32:35], s50 offen offset:3072 sc1
  v_add_u32 v6, 32768, v6
  ds_read_b64_tr_b16 v[208:209], v6 offset:40960
  ds_read_b64_tr_b16 v[210:211], v6 offset:41984
  v_mfma_f32_32x32x16_bf16 v[160:175], v[192:195], v[112:115], v[160:175]
  v_fmamk_f32 v234, v154, 0x3fb8aa3b, v216
  v_fmamk_f32 v154, v154, 0xbfb8aa3b, v217
  v_exp_f32 v234, v234
  v_exp_f32 v154, v154
  buffer_store_dwordx4 v[252:255], v1, s[32:35], s3 offen offset:0 sc1
  v_add_u32 v7, 4294868992, v7
  ds_read_b64_tr_b16 v[212:213], v7 offset:16384
  ds_read_b64_tr_b16 v[214:215], v7 offset:17408
  s_waitcnt lgkmcnt(6)
  v_mfma_f32_32x32x16_bf16 v[176:191], v[196:199], v[16:19], 0
  v_fmamk_f32 v235, v155, 0x3fb8aa3b, v216
  v_fmamk_f32 v155, v155, 0xbfb8aa3b, v217
  v_exp_f32 v235, v235
  ds_read_b64_tr_b16 v[192:193], v6 offset:45056
  ds_read_b64_tr_b16 v[194:195], v6 offset:46080
  v_mfma_f32_32x32x16_bf16 v[160:175], v[200:203], v[116:119], v[160:175]
  v_exp_f32 v155, v155
  v_fmamk_f32 v236, v156, 0x3fb8aa3b, v216
  v_fmamk_f32 v156, v156, 0xbfb8aa3b, v217
  v_exp_f32 v236, v236
  buffer_store_dwordx4 v[252:255], v1, s[32:35], s3 offen offset:1024 sc1
  ds_read_b64_tr_b16 v[196:197], v7 offset:20480
  ds_read_b64_tr_b16 v[198:199], v7 offset:21504
  s_waitcnt lgkmcnt(6)
  v_mfma_f32_32x32x16_bf16 v[176:191], v[204:207], v[20:23], v[176:191]
  s_barrier
  v_mfma_f32_32x32x16_bf16 v[160:175], v[208:211], v[120:123], v[160:175]
  ds_read_b64_tr_b16 v[200:201], v7 offset:24576
  ds_read_b64_tr_b16 v[202:203], v7 offset:25600
  v_exp_f32 v156, v156
  v_fmamk_f32 v237, v157, 0x3fb8aa3b, v216
  v_fmamk_f32 v157, v157, 0xbfb8aa3b, v217
  v_exp_f32 v237, v237
  v_exp_f32 v157, v157
  v_cvt_pk_bf16_f32 v144, v144, v145
  buffer_store_dwordx4 v[252:255], v1, s[32:35], s3 offen offset:2048 sc1
  ds_read_b64_tr_b16 v[204:205], v7 offset:28672
  ds_read_b64_tr_b16 v[206:207], v7 offset:29696
  s_waitcnt lgkmcnt(6)
  v_mfma_f32_32x32x16_bf16 v[176:191], v[212:215], v[24:27], v[176:191]
  v_cvt_pk_bf16_f32 v145, v146, v147
  v_cvt_pk_bf16_f32 v146, v148, v149
  v_cvt_pk_bf16_f32 v147, v150, 0
  v_cvt_pk_bf16_f32 v148, v151, v152
  v_cvt_pk_bf16_f32 v149, v153, v154
  ds_read_b64_tr_b16 v[208:209], v7 offset:32768
  ds_read_b64_tr_b16 v[210:211], v7 offset:33792
  v_mfma_f32_32x32x16_bf16 v[160:175], v[192:195], v[124:127], v[160:175]
  v_cvt_pk_bf16_f32 v150, v155, v156
  v_cvt_pk_bf16_f32 v151, v157, 0
  v_cvt_pk_bf16_f32 v152, v224, v225
  v_cvt_pk_bf16_f32 v153, v226, v227
  v_cvt_pk_bf16_f32 v154, v228, v229
  s_add_u32 m0, s38, 151552
  s_add_u32 s46, s56, 4096
  buffer_load_dwordx4 v1, s[32:35], s46 offen sc1 lds
  s_add_u32 m0, s38, 159744
  s_add_u32 s46, s56, 12288
  buffer_load_dwordx4 v1, s[32:35], s46 offen sc1 lds
  ds_read_b64_tr_b16 v[212:213], v7 offset:36864
  ds_read_b64_tr_b16 v[214:215], v7 offset:37888
  s_waitcnt lgkmcnt(6)
  v_mfma_f32_32x32x16_bf16 v[176:191], v[196:199], v[28:31], v[176:191]
  v_cvt_pk_bf16_f32 v155, v230, 0
  v_cvt_pk_bf16_f32 v156, v231, v232
  v_cvt_pk_bf16_f32 v157, v233, v234
  v_cvt_pk_bf16_f32 v158, v235, v236
  v_cvt_pk_bf16_f32 v159, v237, 0
  s_add_u32 m0, s38, 102400
  s_add_u32 s46, s56, 20480
  buffer_load_dwordx4 v1, s[32:35], s46 offen sc1 lds
  s_add_u32 m0, s38, 110592
  s_add_u32 s46, s56, 28672
  buffer_load_dwordx4 v1, s[32:35], s46 offen sc1 lds
  ds_read_b64_tr_b16 v[192:193], v7 offset:40960
  ds_read_b64_tr_b16 v[194:195], v7 offset:41984
  v_mfma_f32_32x32x16_bf16 v[176:191], v[200:203], v[32:35], v[176:191]
  ds_read_b64_tr_b16 v[224:225], v221 offset:7840
  ds_read_b64_tr_b16 v[226:227], v221 offset:8288
  ds_read_b64_tr_b16 v[228:229], v221 offset:8736
  ds_read_b64_tr_b16 v[230:231], v8 offset:9184
  v_cvt_pk_bf16_f32 v232, v160, v161
  v_cvt_pk_bf16_f32 v233, v162, v163
  v_cvt_pk_bf16_f32 v234, v164, v165
  v_cvt_pk_bf16_f32 v235, v166, v167
  v_cvt_pk_bf16_f32 v236, v168, v169
  v_cvt_pk_bf16_f32 v237, v170, v171
  s_add_u32 s54, s38, 151564
  v_add_u32 v9, s54, v1
  s_add_u32 s54, s38, 159756
  v_add_u32 v220, s54, v1
  ds_read_b64_tr_b16 v[196:197], v7 offset:45056
  ds_read_b64_tr_b16 v[198:199], v7 offset:46080
  s_waitcnt lgkmcnt(10)
  v_mfma_f32_32x32x16_bf16 v[176:191], v[204:207], v[36:39], v[176:191]
  v_cvt_pk_bf16_f32 v238, v172, v173
  v_cvt_pk_bf16_f32 v239, v174, v175
  s_waitcnt lgkmcnt(5)
  v_mov_b32_dpp v224, v224 row_shr:2 row_mask:0xa bank_mask:0x8
  v_mov_b32_dpp v225, v225 row_shr:2 row_mask:0xa bank_mask:0x8
  s_waitcnt lgkmcnt(4)
  v_mov_b32_dpp v226, v226 row_shr:2 row_mask:0xa bank_mask:0x8
  v_mov_b32_dpp v227, v227 row_shr:2 row_mask:0xa bank_mask:0x8
  s_add_u32 s54, s38, 102412
  v_add_u32 v222, s54, v1
  s_add_u32 s54, s38, 110604
  v_add_u32 v223, s54, v1
  ds_read_b64_tr_b16 v[200:201], v7 offset:49152
  ds_read_b64_tr_b16 v[202:203], v7 offset:50176
  v_mfma_f32_32x32x16_bf16 v[176:191], v[208:211], v[40:43], v[176:191]
  s_waitcnt lgkmcnt(5)
  v_mov_b32_dpp v228, v228 row_shr:2 row_mask:0xa bank_mask:0x8
  v_mov_b32_dpp v229, v229 row_shr:2 row_mask:0xa bank_mask:0x8
  s_waitcnt lgkmcnt(4)
  v_mov_b32_dpp v230, v230 row_shr:2 row_mask:0xa bank_mask:0x8
  v_mov_b32_dpp v231, v231 row_shr:2 row_mask:0xa bank_mask:0x8
  v_mfma_f32_32x32x16_bf16 v[160:175], v[224:227], v[232:235], 0
  s_nop 0
  v_mfma_f32_32x32x16_bf16 v[160:175], v[228:231], v[236:239], v[160:175]
  ds_read_b64_tr_b16 v[204:205], v7 offset:53248
  ds_read_b64_tr_b16 v[206:207], v7 offset:54272
  v_mfma_f32_32x32x16_bf16 v[176:191], v[212:215], v[44:47], v[176:191]
  s_nop 8
  v_max3_f32 v216, v160, v161, v162
  v_add_u32 v7, 98304, v7
  ds_read_b64_tr_b16 v[208:209], v7 offset:24576
  ds_read_b64_tr_b16 v[210:211], v7 offset:25600
  v_mfma_f32_32x32x16_bf16 v[176:191], v[192:195], v[48:51], v[176:191]
  v_min3_f32 v217, v160, v161, v162
  v_max3_f32 v216, v216, v163, v164
  v_min3_f32 v217, v217, v163, v164
  v_max3_f32 v216, v216, v165, v166
  v_min3_f32 v217, v217, v165, v166
  v_max3_f32 v216, v216, v167, v168
  ds_read_b64_tr_b16 v[240:241], v221 offset:10976
  ds_read_b64_tr_b16 v[242:243], v221 offset:11424
  ds_read_b64_tr_b16 v[244:245], v221 offset:11872
  ds_read_b64_tr_b16 v[246:247], v8 offset:12320
  ds_read_b64_tr_b16 v[212:213], v7 offset:28672
  ds_read_b64_tr_b16 v[214:215], v7 offset:29696
  s_waitcnt lgkmcnt(10)
  v_mfma_f32_32x32x16_bf16 v[176:191], v[196:199], v[52:55], v[176:191]
  v_min3_f32 v217, v217, v167, v168
  v_max3_f32 v216, v216, v169, v170
  v_min3_f32 v217, v217, v169, v170
  v_max3_f32 v216, v216, v171, v172
  v_min3_f32 v217, v217, v171, v172
  v_max_f32 v216, v216, v173
  v_add_u32 v7, 4294901760, v7
  ds_read_b64_tr_b16 v[192:193], v7 offset:24576
  ds_read_b64_tr_b16 v[194:195], v7 offset:25600
  v_mfma_f32_32x32x16_bf16 v[176:191], v[200:203], v[56:59], v[176:191]
  v_min_f32 v217, v217, v173
  v_mov_b32 v218, v216
  v_mov_b32 v219, v217
  s_nop 0
  v_permlane32_swap_b32 v216, v218
  v_permlane32_swap_b32 v217, v219
  s_waitcnt lgkmcnt(7)
  v_mov_b32_dpp v240, v240 row_shr:2 row_mask:0xa bank_mask:0x8
  v_mov_b32_dpp v241, v241 row_shr:2 row_mask:0xa bank_mask:0x8
  ds_read_b64_tr_b16 v[196:197], v7 offset:28672
  ds_read_b64_tr_b16 v[198:199], v7 offset:29696
  v_mfma_f32_32x32x16_bf16 v[176:191], v[204:207], v[60:63], v[176:191]
  v_max_f32 v216, v216, v218
  v_min_f32 v217, v217, v219
  v_mul_f32 v216, 0xbfb8aa3b, v216
  v_mul_f32 v217, 0x3fb8aa3b, v217
  v_fmamk_f32 v224, v160, 0x3fb8aa3b, v216
  v_fmamk_f32 v160, v160, 0xbfb8aa3b, v217
  v_exp_f32 v224, v224
  s_waitcnt lgkmcnt(8)
  v_mov_b32_dpp v242, v242 row_shr:2 row_mask:0xa bank_mask:0x8
  v_mov_b32_dpp v243, v243 row_shr:2 row_mask:0xa bank_mask:0x8
  v_add_u32 v7, 65536, v7
  ds_read_b64_tr_b16 v[200:201], v7 offset:32768
  ds_read_b64_tr_b16 v[202:203], v7 offset:33792
  v_mfma_f32_32x32x16_bf16 v[176:191], v[208:211], v[64:67], v[176:191]
  v_exp_f32 v160, v160
  v_fmamk_f32 v225, v161, 0x3fb8aa3b, v216
  v_fmamk_f32 v161, v161, 0xbfb8aa3b, v217
  v_exp_f32 v225, v225
  s_lshl1_add_u32 s49, s40, s39
  s_lshl3_add_u32 s49, s49, s36
  s_lshl_b32 s49, s49, 12
  s_add_u32 s49, s49, 2097152
  s_add_u32 s49, s49, 896
  s_waitcnt vmcnt(4)
  v_mov_b32 v10, s43
  s_mov_b64 exec, 0xff
  buffer_store_dwordx4 v[10:13], v1, s[32:35], s49 offen sc1
  s_mov_b64 exec, -1
  s_waitcnt lgkmcnt(9)
  v_mov_b32_dpp v244, v244 row_shr:2 row_mask:0xa bank_mask:0x8
  v_mov_b32_dpp v245, v245 row_shr:2 row_mask:0xa bank_mask:0x8
  ds_read_b64_tr_b16 v[204:205], v7 offset:36864
  ds_read_b64_tr_b16 v[206:207], v7 offset:37888
  s_waitcnt lgkmcnt(6)
  v_mfma_f32_32x32x16_bf16 v[176:191], v[212:215], v[68:71], v[176:191]
  v_exp_f32 v161, v161
  v_fmamk_f32 v226, v162, 0x3fb8aa3b, v216
  v_fmamk_f32 v162, v162, 0xbfb8aa3b, v217
  v_exp_f32 v226, v226
  v_mov_b32_dpp v246, v246 row_shr:2 row_mask:0xa bank_mask:0x8
  v_mov_b32_dpp v247, v247 row_shr:2 row_mask:0xa bank_mask:0x8
  v_add_u32 v7, 4294934528, v7
  ds_read_b64_tr_b16 v[208:209], v7 offset:0
  ds_read_b64_tr_b16 v[210:211], v7 offset:1024
  s_waitcnt lgkmcnt(6)
  v_mfma_f32_32x32x16_bf16 v[176:191], v[192:195], v[72:75], v[176:191]
  s_barrier
  v_mfma_f32_32x32x16_bf16 v[176:191], v[196:199], v[76:79], v[176:191]
  ds_read_b64_tr_b16 v[212:213], v7 offset:4096
  ds_read_b64_tr_b16 v[214:215], v7 offset:5120
  v_exp_f32 v162, v162
  v_fmamk_f32 v227, v163, 0x3fb8aa3b, v216
  v_fmamk_f32 v163, v163, 0xbfb8aa3b, v217
  v_exp_f32 v227, v227
  v_mov_b32 v248, 0x3fb8aa3b
  v_mov_b32 v249, 0xbfb8aa3b
  v_exp_f32 v163, v163
  v_fmamk_f32 v228, v164, 0x3fb8aa3b, v216
  v_fmamk_f32 v164, v164, 0xbfb8aa3b, v217
  v_exp_f32 v228, v228
  ds_read_b64_tr_b16 v[192:193], v7 offset:8192
  ds_read_b64_tr_b16 v[194:195], v7 offset:9216
  s_waitcnt lgkmcnt(6)
  v_mfma_f32_32x32x16_bf16 v[176:191], v[200:203], v[80:83], v[176:191]
  v_exp_f32 v164, v164
  v_fmamk_f32 v229, v165, 0x3fb8aa3b, v216
  v_fmamk_f32 v165, v165, 0xbfb8aa3b, v217
  v_exp_f32 v229, v229
  ds_read_b64_tr_b16 v[196:197], v7 offset:12288
  ds_read_b64_tr_b16 v[198:199], v7 offset:13312
  v_mfma_f32_32x32x16_bf16 v[176:191], v[204:207], v[84:87], v[176:191]
  v_exp_f32 v165, v165
  v_fmamk_f32 v230, v166, 0x3fb8aa3b, v216
  v_fmamk_f32 v166, v166, 0xbfb8aa3b, v217
  v_exp_f32 v230, v230
  ds_read_b64_tr_b16 v[200:201], v7 offset:16384
  ds_read_b64_tr_b16 v[202:203], v7 offset:17408
  s_waitcnt lgkmcnt(6)
  v_mfma_f32_32x32x16_bf16 v[176:191], v[208:211], v[88:91], v[176:191]
  v_exp_f32 v166, v166
  v_fmamk_f32 v231, v167, 0x3fb8aa3b, v216
  v_fmamk_f32 v167, v167, 0xbfb8aa3b, v217
  v_exp_f32 v231, v231
  ds_read_b64_tr_b16 v[204:205], v7 offset:20480
  ds_read_b64_tr_b16 v[206:207], v7 offset:21504
  v_mfma_f32_32x32x16_bf16 v[176:191], v[212:215], v[92:95], v[176:191]
  v_exp_f32 v167, v167
  v_fmamk_f32 v232, v168, 0x3fb8aa3b, v216
  v_fmamk_f32 v168, v168, 0xbfb8aa3b, v217
  v_exp_f32 v232, v232
  ds_read_b64_tr_b16 v[208:209], v7 offset:24576
  ds_read_b64_tr_b16 v[210:211], v7 offset:25600
  s_waitcnt lgkmcnt(6)
  v_mfma_f32_32x32x16_bf16 v[176:191], v[192:195], v[96:99], v[176:191]
  v_exp_f32 v168, v168
  v_fmamk_f32 v233, v169, 0x3fb8aa3b, v216
  v_fmamk_f32 v169, v169, 0xbfb8aa3b, v217
  v_exp_f32 v233, v233
  ds_read_b64_tr_b16 v[212:213], v7 offset:28672
  ds_read_b64_tr_b16 v[214:215], v7 offset:29696
  v_mfma_f32_32x32x16_bf16 v[176:191], v[196:199], v[100:103], v[176:191]
  v_exp_f32 v169, v169
  v_fmamk_f32 v234, v170, 0x3fb8aa3b, v216
  v_fmamk_f32 v170, v170, 0xbfb8aa3b, v217
  v_exp_f32 v234, v234
  v_add_u32 v7, 32768, v7
  ds_read_b64_tr_b16 v[192:193], v7 offset:40960
  ds_read_b64_tr_b16 v[194:195], v7 offset:41984
  s_waitcnt lgkmcnt(6)
  v_mfma_f32_32x32x16_bf16 v[176:191], v[200:203], v[104:107], v[176:191]
  v_exp_f32 v170, v170
  v_fmamk_f32 v235, v171, 0x3fb8aa3b, v216
  v_fmamk_f32 v171, v171, 0xbfb8aa3b, v217
  v_exp_f32 v235, v235
  ds_read_b64_tr_b16 v[196:197], v7 offset:45056
  ds_read_b64_tr_b16 v[198:199], v7 offset:46080
  v_mfma_f32_32x32x16_bf16 v[176:191], v[204:207], v[108:111], v[176:191]
  v_exp_f32 v171, v171
  v_fmamk_f32 v236, v172, 0x3fb8aa3b, v216
  v_fmamk_f32 v172, v172, 0xbfb8aa3b, v217
  v_exp_f32 v236, v236
  s_waitcnt lgkmcnt(4)
  v_mfma_f32_32x32x16_bf16 v[176:191], v[208:211], v[112:115], v[176:191]
  v_exp_f32 v172, v172
  v_fmamk_f32 v237, v173, 0x3fb8aa3b, v216
  v_fmamk_f32 v173, v173, 0xbfb8aa3b, v217
  v_exp_f32 v237, v237
  v_mfma_f32_32x32x16_bf16 v[176:191], v[212:215], v[116:119], v[176:191]
  v_exp_f32 v173, v173
  v_cvt_pk_bf16_f32 v160, v160, v161
  v_cvt_pk_bf16_f32 v161, v162, v163
  v_cvt_pk_bf16_f32 v162, v164, v165
  v_cvt_pk_bf16_f32 v163, v166, 0
  s_waitcnt lgkmcnt(0)
  v_mfma_f32_32x32x16_bf16 v[176:191], v[192:195], v[120:123], v[176:191]
  v_cvt_pk_bf16_f32 v164, v167, v168
  v_cvt_pk_bf16_f32 v165, v169, v170
  v_cvt_pk_bf16_f32 v166, v171, v172
  v_cvt_pk_bf16_f32 v167, v173, 0
  v_cvt_pk_bf16_f32 v168, v224, v225
  v_cvt_pk_bf16_f32 v169, v226, v227
  v_mfma_f32_32x32x16_bf16 v[176:191], v[196:199], v[124:127], v[176:191]
  v_cvt_pk_bf16_f32 v170, v228, v229
  v_cvt_pk_bf16_f32 v171, v230, 0
  v_cvt_pk_bf16_f32 v172, v231, v232
  v_cvt_pk_bf16_f32 v173, v233, v234
  v_cvt_pk_bf16_f32 v174, v235, v236
  v_cvt_pk_bf16_f32 v175, v237, 0
  s_nop 5
  v_cvt_pk_bf16_f32 v232, v176, v177
  v_cvt_pk_bf16_f32 v233, v178, v179
  v_cvt_pk_bf16_f32 v234, v180, v181
  v_cvt_pk_bf16_f32 v235, v182, v183
  v_cvt_pk_bf16_f32 v236, v184, v185
  v_cvt_pk_bf16_f32 v237, v186, v187
  v_cvt_pk_bf16_f32 v238, v188, v189
  v_cvt_pk_bf16_f32 v239, v190, v191
  v_mfma_f32_32x32x16_bf16 v[176:191], v[240:243], v[232:235], 0
  s_nop 0
  v_mfma_f32_32x32x16_bf16 v[176:191], v[244:247], v[236:239], v[176:191]
  s_nop 11
  v_max3_f32 v216, v176, v177, v178
  v_min3_f32 v217, v176, v177, v178
  v_max3_f32 v216, v216, v179, v180
  v_min3_f32 v217, v217, v179, v180
  v_max3_f32 v216, v216, v181, v182
  v_min3_f32 v217, v217, v181, v182
  v_max3_f32 v216, v216, v183, v184
  v_min3_f32 v217, v217, v183, v184
  v_max3_f32 v216, v216, v185, v186
  v_min3_f32 v217, v217, v185, v186
  v_max3_f32 v216, v216, v187, v188
  s_waitcnt vmcnt(1)
  ds_read_b32 v112, v9
  ds_read_b32 v113, v220
  ds_read_b32 v114, v222
  ds_read_b32 v115, v223
  s_waitcnt lgkmcnt(3)
  v_xor_b32 v116, s45, v112
  s_waitcnt lgkmcnt(2)
  v_bitop3_b32 v116, v113, s45, v116 bitop3:0xbe
  s_waitcnt lgkmcnt(1)
  v_bitop3_b32 v116, v114, s45, v116 bitop3:0xbe
  s_waitcnt lgkmcnt(0)
  v_bitop3_b32 v116, v115, s45, v116 bitop3:0xbe
  v_cmp_lt_u32 vcc, 0xffff, v116
  s_cbranch_vccnz L_tslow_165
L_tok_164:
  s_barrier
  v_add_u32 v13, 98304, v13
  ds_read_b128 v[16:19], v13 offset:53248
  ds_read_b128 v[20:23], v13 offset:54272
  ds_read_b128 v[24:27], v13 offset:55296
  ds_read_b128 v[28:31], v13 offset:56320
  ds_read_b128 v[32:35], v13 offset:61440
  ds_read_b128 v[36:39], v13 offset:62464
  ds_read_b128 v[40:43], v13 offset:63488
  ds_read_b128 v[44:47], v13 offset:64512
  s_waitcnt lgkmcnt(7)
  v_mfma_f32_32x32x16_bf16 v[48:63], v[16:19], v[136:139], 0
  v_min3_f32 v217, v217, v187, v188
  v_max_f32 v216, v216, v189
  v_min_f32 v217, v217, v189
  s_waitcnt lgkmcnt(6)
  v_mfma_f32_32x32x16_bf16 v[48:63], v[20:23], v[140:143], v[48:63]
  v_mov_b32 v218, v216
  v_mov_b32 v219, v217
  s_nop 0
  v_permlane32_swap_b32 v216, v218
  s_waitcnt lgkmcnt(5)
  v_mfma_f32_32x32x16_bf16 v[64:79], v[24:27], v[128:131], 0
  v_permlane32_swap_b32 v217, v219
  v_max_f32 v216, v216, v218
  v_min_f32 v217, v217, v219
  s_waitcnt lgkmcnt(4)
  v_mfma_f32_32x32x16_bf16 v[64:79], v[28:31], v[132:135], v[64:79]
  v_mul_f32 v216, 0xbfb8aa3b, v216
  v_mul_f32 v217, 0x3fb8aa3b, v217
  v_pk_fma_f32 v[224:225], v[176:177], v[248:249], v[216:217] op_sel_hi:[1,0,0]
  s_setprio 1
  s_waitcnt lgkmcnt(3)
  v_mfma_f32_32x32x16_bf16 v[80:95], v[32:35], v[152:155], 0
  v_pk_fma_f32 v[176:177], v[176:177], v[248:249], v[216:217] op_sel:[0,1,1]
  v_exp_f32 v224, v224
  v_exp_f32 v225, v225
  v_exp_f32 v176, v176
  s_waitcnt lgkmcnt(2)
  v_mfma_f32_32x32x16_bf16 v[80:95], v[36:39], v[156:159], v[80:95]
  v_exp_f32 v177, v177
  v_pk_fma_f32 v[226:227], v[178:179], v[248:249], v[216:217] op_sel_hi:[1,0,0]
  v_pk_fma_f32 v[178:179], v[178:179], v[248:249], v[216:217] op_sel:[0,1,1]
  v_exp_f32 v226, v226
  s_waitcnt lgkmcnt(1)
  v_mfma_f32_32x32x16_bf16 v[96:111], v[40:43], v[144:147], 0
  v_exp_f32 v227, v227
  v_exp_f32 v178, v178
  v_exp_f32 v179, v179
  s_waitcnt lgkmcnt(0)
  v_mfma_f32_32x32x16_bf16 v[96:111], v[44:47], v[148:151], v[96:111]
  v_pk_fma_f32 v[228:229], v[180:181], v[248:249], v[216:217] op_sel_hi:[1,0,0]
  v_pk_fma_f32 v[180:181], v[180:181], v[248:249], v[216:217] op_sel:[0,1,1]
  v_exp_f32 v228, v228
  v_exp_f32 v229, v229
  v_exp_f32 v180, v180
  v_exp_f32 v181, v181
  v_pk_fma_f32 v[230:231], v[182:183], v[248:249], v[216:217] op_sel_hi:[1,0,0]
  ds_read_b128 v[16:19], v13 offset:4096
  ds_read_b128 v[20:23], v13 offset:5120
  ds_read_b128 v[24:27], v13 offset:6144
  ds_read_b128 v[28:31], v13 offset:7168
  v_rcp_f32 v4, v63
  v_rcp_f32 v5, v79
  v_fmaak_f32 v2, v62, v4, 0x358637bd
  v_fmac_f32 v2, v78, v5
  v_rcp_f32 v2, v2
  s_nop 0
  v_mul_f32 v4, v4, v2
  v_mul_f32 v5, v5, v2
  v_pk_mul_f32 v[48:49], v[48:49], v[4:5] op_sel_hi:[1,0]
  v_pk_mul_f32 v[50:51], v[50:51], v[4:5] op_sel_hi:[1,0]
  v_pk_mul_f32 v[52:53], v[52:53], v[4:5] op_sel_hi:[1,0]
  v_pk_mul_f32 v[54:55], v[54:55], v[4:5] op_sel_hi:[1,0]
  v_pk_fma_f32 v[48:49], v[64:65], v[4:5], v[48:49] op_sel:[0,1,0]
  v_pk_fma_f32 v[50:51], v[66:67], v[4:5], v[50:51] op_sel:[0,1,0]
  v_pk_fma_f32 v[52:53], v[68:69], v[4:5], v[52:53] op_sel:[0,1,0]
  v_pk_fma_f32 v[54:55], v[70:71], v[4:5], v[54:55] op_sel:[0,1,0]
  v_cvt_pk_bf16_f32 v112, v48, v49
  v_cvt_pk_bf16_f32 v113, v50, v51
  v_cvt_pk_bf16_f32 v114, v52, v53
  v_cvt_pk_bf16_f32 v115, v54, v55
  buffer_store_dwordx4 v[112:115], v1, s[32:35], s50 offen offset:0 sc1
  v_pk_mul_f32 v[56:57], v[56:57], v[4:5] op_sel_hi:[1,0]
  v_pk_mul_f32 v[58:59], v[58:59], v[4:5] op_sel_hi:[1,0]
  v_pk_mul_f32 v[60:61], v[60:61], v[4:5] op_sel_hi:[1,0]
  v_pk_fma_f32 v[56:57], v[72:73], v[4:5], v[56:57] op_sel:[0,1,0]
  v_pk_fma_f32 v[58:59], v[74:75], v[4:5], v[58:59] op_sel:[0,1,0]
  v_pk_fma_f32 v[60:61], v[76:77], v[4:5], v[60:61] op_sel:[0,1,0]
  v_cvt_pk_bf16_f32 v116, v56, v57
  v_cvt_pk_bf16_f32 v117, v58, v59
  v_cvt_pk_bf16_f32 v118, v60, v61
  s_setprio 0
  s_waitcnt lgkmcnt(3)
  v_mfma_f32_32x32x16_bf16 v[48:63], v[16:19], v[168:171], 0
  v_pk_fma_f32 v[182:183], v[182:183], v[248:249], v[216:217] op_sel:[0,1,1]
  v_exp_f32 v230, v230
  v_exp_f32 v231, v231
  v_exp_f32 v182, v182
  s_waitcnt lgkmcnt(2)
  v_mfma_f32_32x32x16_bf16 v[48:63], v[20:23], v[172:175], v[48:63]
  v_exp_f32 v183, v183
  v_pk_fma_f32 v[232:233], v[184:185], v[248:249], v[216:217] op_sel_hi:[1,0,0]
  v_pk_fma_f32 v[184:185], v[184:185], v[248:249], v[216:217] op_sel:[0,1,1]
  v_exp_f32 v232, v232
  s_waitcnt lgkmcnt(1)
  v_mfma_f32_32x32x16_bf16 v[64:79], v[24:27], v[160:163], 0
  v_exp_f32 v233, v233
  v_exp_f32 v184, v184
  v_exp_f32 v185, v185
  s_waitcnt lgkmcnt(0)
  v_mfma_f32_32x32x16_bf16 v[64:79], v[28:31], v[164:167], v[64:79]
  v_pk_fma_f32 v[234:235], v[186:187], v[248:249], v[216:217] op_sel_hi:[1,0,0]
  v_pk_fma_f32 v[186:187], v[186:187], v[248:249], v[216:217] op_sel:[0,1,1]
  v_exp_f32 v234, v234
  v_exp_f32 v235, v235
  v_exp_f32 v186, v186
  v_exp_f32 v187, v187
  v_pk_fma_f32 v[236:237], v[188:189], v[248:249], v[216:217] op_sel_hi:[1,0,0]
  ds_read_b128 v[32:35], v13 offset:12288
  ds_read_b128 v[36:39], v13 offset:13312
  ds_read_b128 v[40:43], v13 offset:14336
  ds_read_b128 v[44:47], v13 offset:15360
  v_rcp_f32 v4, v95
  v_rcp_f32 v5, v111
  v_fmaak_f32 v2, v94, v4, 0x358637bd
  v_fmac_f32 v2, v110, v5
  v_rcp_f32 v2, v2
  s_nop 0
  v_mul_f32 v4, v4, v2
  v_mul_f32 v5, v5, v2
  v_pk_mul_f32 v[80:81], v[80:81], v[4:5] op_sel_hi:[1,0]
  v_pk_mul_f32 v[82:83], v[82:83], v[4:5] op_sel_hi:[1,0]
  v_pk_mul_f32 v[84:85], v[84:85], v[4:5] op_sel_hi:[1,0]
  v_pk_mul_f32 v[86:87], v[86:87], v[4:5] op_sel_hi:[1,0]
  v_pk_fma_f32 v[80:81], v[96:97], v[4:5], v[80:81] op_sel:[0,1,0]
  v_pk_fma_f32 v[82:83], v[98:99], v[4:5], v[82:83] op_sel:[0,1,0]
  v_pk_fma_f32 v[84:85], v[100:101], v[4:5], v[84:85] op_sel:[0,1,0]
  v_pk_fma_f32 v[86:87], v[102:103], v[4:5], v[86:87] op_sel:[0,1,0]
  v_cvt_pk_bf16_f32 v119, v80, v81
  buffer_store_dwordx4 v[116:119], v1, s[32:35], s50 offen offset:1024 sc1
  v_cvt_pk_bf16_f32 v120, v82, v83
  v_cvt_pk_bf16_f32 v121, v84, v85
  v_cvt_pk_bf16_f32 v122, v86, v87
  v_pk_mul_f32 v[88:89], v[88:89], v[4:5] op_sel_hi:[1,0]
  v_pk_mul_f32 v[90:91], v[90:91], v[4:5] op_sel_hi:[1,0]
  v_pk_mul_f32 v[92:93], v[92:93], v[4:5] op_sel_hi:[1,0]
  v_pk_fma_f32 v[88:89], v[104:105], v[4:5], v[88:89] op_sel:[0,1,0]
  v_pk_fma_f32 v[90:91], v[106:107], v[4:5], v[90:91] op_sel:[0,1,0]
  v_pk_fma_f32 v[92:93], v[108:109], v[4:5], v[92:93] op_sel:[0,1,0]
  v_cvt_pk_bf16_f32 v123, v88, v89
  buffer_store_dwordx4 v[120:123], v1, s[32:35], s50 offen offset:2048 sc1
  v_cvt_pk_bf16_f32 v124, v90, v91
  v_cvt_pk_bf16_f32 v125, v92, v93
  s_setprio 1
  v_pk_fma_f32 v[188:189], v[188:189], v[248:249], v[216:217] op_sel:[0,1,1]
  v_exp_f32 v236, v236
  v_exp_f32 v237, v237
  v_exp_f32 v188, v188
  v_exp_f32 v189, v189
  v_cvt_pk_bf16_f32 v176, v176, v177
  v_cvt_pk_bf16_f32 v177, v178, v179
  v_cvt_pk_bf16_f32 v178, v180, v181
  v_cvt_pk_bf16_f32 v179, v182, 0
  v_cvt_pk_bf16_f32 v180, v183, v184
  v_cvt_pk_bf16_f32 v181, v185, v186
  v_cvt_pk_bf16_f32 v182, v187, v188
  v_cvt_pk_bf16_f32 v183, v189, 0
  v_cvt_pk_bf16_f32 v184, v224, v225
  v_cvt_pk_bf16_f32 v185, v226, v227
  v_cvt_pk_bf16_f32 v186, v228, v229
  v_cvt_pk_bf16_f32 v187, v230, 0
  v_cvt_pk_bf16_f32 v188, v231, v232
  v_cvt_pk_bf16_f32 v189, v233, v234
  v_cvt_pk_bf16_f32 v190, v235, v236
  v_cvt_pk_bf16_f32 v191, v237, 0
  s_waitcnt lgkmcnt(3)
  v_mfma_f32_32x32x16_bf16 v[80:95], v[32:35], v[184:187], 0
  v_rcp_f32 v4, v63
  v_rcp_f32 v5, v79
  v_fmaak_f32 v2, v62, v4, 0x358637bd
  v_fmac_f32 v2, v78, v5
  v_rcp_f32 v2, v2
  s_waitcnt lgkmcnt(2)
  v_mfma_f32_32x32x16_bf16 v[80:95], v[36:39], v[188:191], v[80:95]
  v_mul_f32 v4, v4, v2
  v_mul_f32 v5, v5, v2
  v_pk_mul_f32 v[48:49], v[48:49], v[4:5] op_sel_hi:[1,0]
  v_pk_mul_f32 v[50:51], v[50:51], v[4:5] op_sel_hi:[1,0]
  s_waitcnt lgkmcnt(1)
  v_mfma_f32_32x32x16_bf16 v[96:111], v[40:43], v[176:179], 0
  v_pk_mul_f32 v[52:53], v[52:53], v[4:5] op_sel_hi:[1,0]
  v_pk_mul_f32 v[54:55], v[54:55], v[4:5] op_sel_hi:[1,0]
  v_pk_fma_f32 v[48:49], v[64:65], v[4:5], v[48:49] op_sel:[0,1,0]
  v_pk_fma_f32 v[50:51], v[66:67], v[4:5], v[50:51] op_sel:[0,1,0]
  v_pk_fma_f32 v[52:53], v[68:69], v[4:5], v[52:53] op_sel:[0,1,0]
  s_waitcnt lgkmcnt(0)
  v_mfma_f32_32x32x16_bf16 v[96:111], v[44:47], v[180:183], v[96:111]
  v_pk_fma_f32 v[54:55], v[70:71], v[4:5], v[54:55] op_sel:[0,1,0]
  v_cvt_pk_bf16_f32 v126, v48, v49
  v_cvt_pk_bf16_f32 v127, v50, v51
  buffer_store_dwordx4 v[124:127], v1, s[32:35], s50 offen offset:3072 sc1
  v_cvt_pk_bf16_f32 v128, v52, v53
  v_cvt_pk_bf16_f32 v129, v54, v55
  v_pk_mul_f32 v[56:57], v[56:57], v[4:5] op_sel_hi:[1,0]
  v_pk_mul_f32 v[58:59], v[58:59], v[4:5] op_sel_hi:[1,0]
  v_pk_mul_f32 v[60:61], v[60:61], v[4:5] op_sel_hi:[1,0]
  v_pk_fma_f32 v[56:57], v[72:73], v[4:5], v[56:57] op_sel:[0,1,0]
  v_pk_fma_f32 v[58:59], v[74:75], v[4:5], v[58:59] op_sel:[0,1,0]
  v_pk_fma_f32 v[60:61], v[76:77], v[4:5], v[60:61] op_sel:[0,1,0]
  v_cvt_pk_bf16_f32 v130, v56, v57
  v_cvt_pk_bf16_f32 v131, v58, v59
  s_add_u32 s50, s50, 4096
  buffer_store_dwordx4 v[128:131], v1, s[32:35], s50 offen offset:0 sc1
  v_cvt_pk_bf16_f32 v132, v60, v61
  s_setprio 0
  v_rcp_f32 v4, v95
  v_rcp_f32 v5, v111
  v_fmaak_f32 v2, v94, v4, 0x358637bd
  v_fmac_f32 v2, v110, v5
  v_rcp_f32 v2, v2
  s_nop 0
  v_mul_f32 v4, v4, v2
  v_mul_f32 v5, v5, v2
  v_pk_mul_f32 v[80:81], v[80:81], v[4:5] op_sel_hi:[1,0]
  v_pk_mul_f32 v[82:83], v[82:83], v[4:5] op_sel_hi:[1,0]
  v_pk_mul_f32 v[84:85], v[84:85], v[4:5] op_sel_hi:[1,0]
  v_pk_mul_f32 v[86:87], v[86:87], v[4:5] op_sel_hi:[1,0]
  v_pk_fma_f32 v[80:81], v[96:97], v[4:5], v[80:81] op_sel:[0,1,0]
  v_pk_fma_f32 v[82:83], v[98:99], v[4:5], v[82:83] op_sel:[0,1,0]
  v_pk_fma_f32 v[84:85], v[100:101], v[4:5], v[84:85] op_sel:[0,1,0]
  v_pk_fma_f32 v[86:87], v[102:103], v[4:5], v[86:87] op_sel:[0,1,0]
  v_cvt_pk_bf16_f32 v133, v80, v81
  v_cvt_pk_bf16_f32 v134, v82, v83
  v_cvt_pk_bf16_f32 v135, v84, v85
  buffer_store_dwordx4 v[132:135], v1, s[32:35], s50 offen offset:1024 sc1
  v_cvt_pk_bf16_f32 v136, v86, v87
  v_pk_mul_f32 v[88:89], v[88:89], v[4:5] op_sel_hi:[1,0]
  v_pk_mul_f32 v[90:91], v[90:91], v[4:5] op_sel_hi:[1,0]
  v_pk_mul_f32 v[92:93], v[92:93], v[4:5] op_sel_hi:[1,0]
  v_pk_fma_f32 v[88:89], v[104:105], v[4:5], v[88:89] op_sel:[0,1,0]
  v_pk_fma_f32 v[90:91], v[106:107], v[4:5], v[90:91] op_sel:[0,1,0]
  v_pk_fma_f32 v[92:93], v[108:109], v[4:5], v[92:93] op_sel:[0,1,0]
  v_cvt_pk_bf16_f32 v137, v88, v89
  v_cvt_pk_bf16_f32 v138, v90, v91
  v_cvt_pk_bf16_f32 v139, v92, v93
  buffer_store_dwordx4 v[136:139], v1, s[32:35], s50 offen offset:2048 sc1
  s_endpgm
L_slow_2:
  s_mov_b32 s53, 0
L_lp_3:
  buffer_load_dword v10, v9, s[32:35], s80 offen sc1
  s_add_u32 s53, s53, 1
  s_waitcnt vmcnt(0)
  v_cmp_ne_u32 vcc, s43, v10
  s_nop 1
  s_cbranch_vccz L_ok_1
  s_cmp_lt_u32 s53, 50000
  s_cbranch_scc1 L_lp_3
  s_branch L_ok_1
L_slow_6:
  s_mov_b32 s53, 0
L_lp_7:
  buffer_load_dword v223, v222, s[32:35], s56 offen sc1
  s_add_u32 s53, s53, 1
  s_waitcnt vmcnt(0)
  v_cmp_ne_u32 vcc, s43, v223
  s_nop 1
  s_cbranch_vccz L_ok_5
  s_cmp_lt_u32 s53, 50000
  s_cbranch_scc1 L_lp_7
  s_branch L_ok_5
L_slow_9:
  s_mov_b32 s53, 0
L_lp_10:
  buffer_load_dword v10, v9, s[32:35], s80 offen sc1
  s_add_u32 s53, s53, 1
  s_waitcnt vmcnt(0)
  v_cmp_ne_u32 vcc, s43, v10
  s_nop 1
  s_cbranch_vccz L_ok_8
  s_cmp_lt_u32 s53, 50000
  s_cbranch_scc1 L_lp_10
  s_branch L_ok_8
L_slow_12:
  s_mov_b32 s53, 0
L_lp_13:
  buffer_load_dword v10, v9, s[32:35], s80 offen sc1
  s_add_u32 s53, s53, 1
  s_waitcnt vmcnt(0)
  v_cmp_ne_u32 vcc, s43, v10
  s_nop 1
  s_cbranch_vccz L_ok_11
  s_cmp_lt_u32 s53, 50000
  s_cbranch_scc1 L_lp_13
  s_branch L_ok_11
L_slow_15:
  s_mov_b32 s53, 0
L_lp_16:
  buffer_load_dword v223, v222, s[32:35], s57 offen sc1
  s_add_u32 s53, s53, 1
  s_waitcnt vmcnt(0)
  v_cmp_ne_u32 vcc, s43, v223
  s_nop 1
  s_cbranch_vccz L_ok_14
  s_cmp_lt_u32 s53, 50000
  s_cbranch_scc1 L_lp_16
  s_branch L_ok_14
L_vslow_18:
  s_mov_b32 s53, 0
L_vlp_19:
  buffer_load_dwordx4 v[16:19], v1, s[32:35], s51 offen offset:0 sc1
  s_add_u32 s53, s53, 1
  s_waitcnt vmcnt(0)
  v_max3_u32 v14, v16, v17, v18
  v_max_u32 v14, v14, v19
  v_cmp_eq_u32 vcc, -1, v14
  s_nop 1
  s_cbranch_vccz L_vok_17
  s_cmp_lt_u32 s53, 50000
  s_cbranch_scc1 L_vlp_19
  s_branch L_vok_17
L_vslow_21:
  s_mov_b32 s53, 0
L_vlp_22:
  buffer_load_dwordx4 v[20:23], v1, s[32:35], s51 offen offset:1024 sc1
  s_add_u32 s53, s53, 1
  s_waitcnt vmcnt(0)
  v_max3_u32 v14, v20, v21, v22
  v_max_u32 v14, v14, v23
  v_cmp_eq_u32 vcc, -1, v14
  s_nop 1
  s_cbranch_vccz L_vok_20
  s_cmp_lt_u32 s53, 50000
  s_cbranch_scc1 L_vlp_22
  s_branch L_vok_20
L_vslow_24:
  s_mov_b32 s53, 0
L_vlp_25:
  buffer_load_dwordx4 v[24:27], v1, s[32:35], s51 offen offset:2048 sc1
  s_add_u32 s53, s53, 1
  s_waitcnt vmcnt(0)
  v_max3_u32 v14, v24, v25, v26
  v_max_u32 v14, v14, v27
  v_cmp_eq_u32 vcc, -1, v14
  s_nop 1
  s_cbranch_vccz L_vok_23
  s_cmp_lt_u32 s53, 50000
  s_cbranch_scc1 L_vlp_25
  s_branch L_vok_23
L_vslow_27:
  s_mov_b32 s53, 0
L_vlp_28:
  buffer_load_dwordx4 v[28:31], v1, s[32:35], s51 offen offset:3072 sc1
  s_add_u32 s53, s53, 1
  s_waitcnt vmcnt(0)
  v_max3_u32 v14, v28, v29, v30
  v_max_u32 v14, v14, v31
  v_cmp_eq_u32 vcc, -1, v14
  s_nop 1
  s_cbranch_vccz L_vok_26
  s_cmp_lt_u32 s53, 50000
  s_cbranch_scc1 L_vlp_28
  s_branch L_vok_26
L_vslow_30:
  s_mov_b32 s53, 0
L_vlp_31:
  buffer_load_dwordx4 v[32:35], v1, s[32:35], s3 offen offset:0 sc1
  s_add_u32 s53, s53, 1
  s_waitcnt vmcnt(0)
  v_max3_u32 v14, v32, v33, v34
  v_max_u32 v14, v14, v35
  v_cmp_eq_u32 vcc, -1, v14
  s_nop 1
  s_cbranch_vccz L_vok_29
  s_cmp_lt_u32 s53, 50000
  s_cbranch_scc1 L_vlp_31
  s_branch L_vok_29
L_vslow_33:
  s_mov_b32 s53, 0
L_vlp_34:
  buffer_load_dwordx4 v[36:39], v1, s[32:35], s3 offen offset:1024 sc1
  s_add_u32 s53, s53, 1
  s_waitcnt vmcnt(0)
  v_max3_u32 v14, v36, v37, v38
  v_max_u32 v14, v14, v39
  v_cmp_eq_u32 vcc, -1, v14
  s_nop 1
  s_cbranch_vccz L_vok_32
  s_cmp_lt_u32 s53, 50000
  s_cbranch_scc1 L_vlp_34
  s_branch L_vok_32
L_vslow_36:
  s_mov_b32 s53, 0
L_vlp_37:
  buffer_load_dwordx4 v[40:43], v1, s[32:35], s3 offen offset:2048 sc1
  s_add_u32 s53, s53, 1
  s_waitcnt vmcnt(0)
  v_max3_u32 v14, v40, v41, v42
  v_max_u32 v14, v14, v43
  v_cmp_eq_u32 vcc, -1, v14
  s_nop 1
  s_cbranch_vccz L_vok_35
  s_cmp_lt_u32 s53, 50000
  s_cbranch_scc1 L_vlp_37
  s_branch L_vok_35
L_xslow_39:
  s_mov_b32 s53, 0
L_xlp_40:
  buffer_load_dwordx4 v246, s[32:35], s56 offen sc1 lds
  s_add_u32 s53, s53, 1
  s_waitcnt vmcnt(0)
  ds_read_b128 v[88:91], v247
  s_waitcnt lgkmcnt(0)
  v_max3_u32 v11, v88, v89, v90
  v_max_u32 v11, v11, v91
  v_cmp_eq_u32 vcc, -1, v11
  s_nop 1
  s_cbranch_vccz L_xok_38
  s_cmp_lt_u32 s53, 50000
  s_cbranch_scc1 L_xlp_40
  s_branch L_xok_38
L_slow_43:
  s_mov_b32 s53, 0
L_lp_44:
  buffer_load_dword v223, v222, s[32:35], s56 offen sc1
  s_add_u32 s53, s53, 1
  s_waitcnt vmcnt(0)
  v_cmp_ne_u32 vcc, s43, v223
  s_nop 1
  s_cbranch_vccz L_ok_42
  s_cmp_lt_u32 s53, 50000
  s_cbranch_scc1 L_lp_44
  s_branch L_ok_42
L_slow_46:
  s_mov_b32 s53, 0
L_lp_47:
  buffer_load_dword v10, v9, s[32:35], s80 offen sc1
  s_add_u32 s53, s53, 1
  s_waitcnt vmcnt(0)
  v_cmp_ne_u32 vcc, s43, v10
  s_nop 1
  s_cbranch_vccz L_ok_45
  s_cmp_lt_u32 s53, 50000
  s_cbranch_scc1 L_lp_47
  s_branch L_ok_45
L_slow_49:
  s_mov_b32 s53, 0
L_lp_50:
  buffer_load_dword v10, v9, s[32:35], s80 offen sc1
  s_add_u32 s53, s53, 1
  s_waitcnt vmcnt(0)
  v_cmp_ne_u32 vcc, s43, v10
  s_nop 1
  s_cbranch_vccz L_ok_48
  s_cmp_lt_u32 s53, 50000
  s_cbranch_scc1 L_lp_50
  s_branch L_ok_48
L_slow_52:
  s_mov_b32 s53, 0
L_lp_53:
  buffer_load_dword v223, v222, s[32:35], s57 offen sc1
  s_add_u32 s53, s53, 1
  s_waitcnt vmcnt(0)
  v_cmp_ne_u32 vcc, s43, v223
  s_nop 1
  s_cbranch_vccz L_ok_51
  s_cmp_lt_u32 s53, 50000
  s_cbranch_scc1 L_lp_53
  s_branch L_ok_51
L_vslow_55:
  s_mov_b32 s53, 0
L_vlp_56:
  buffer_load_dwordx4 v[16:19], v1, s[32:35], s51 offen offset:0 sc1
  s_add_u32 s53, s53, 1
  s_waitcnt vmcnt(0)
  v_max3_u32 v14, v16, v17, v18
  v_max_u32 v14, v14, v19
  v_cmp_eq_u32 vcc, -1, v14
  s_nop 1
  s_cbranch_vccz L_vok_54
  s_cmp_lt_u32 s53, 50000
  s_cbranch_scc1 L_vlp_56
  s_branch L_vok_54
L_vslow_58:
  s_mov_b32 s53, 0
L_vlp_59:
  buffer_load_dwordx4 v[20:23], v1, s[32:35], s51 offen offset:1024 sc1
  s_add_u32 s53, s53, 1
  s_waitcnt vmcnt(0)
  v_max3_u32 v14, v20, v21, v22
  v_max_u32 v14, v14, v23
  v_cmp_eq_u32 vcc, -1, v14
  s_nop 1
  s_cbranch_vccz L_vok_57
  s_cmp_lt_u32 s53, 50000
  s_cbranch_scc1 L_vlp_59
  s_branch L_vok_57
L_vslow_61:
  s_mov_b32 s53, 0
L_vlp_62:
  buffer_load_dwordx4 v[24:27], v1, s[32:35], s51 offen offset:2048 sc1
  s_add_u32 s53, s53, 1
  s_waitcnt vmcnt(0)
  v_max3_u32 v14, v24, v25, v26
  v_max_u32 v14, v14, v27
  v_cmp_eq_u32 vcc, -1, v14
  s_nop 1
  s_cbranch_vccz L_vok_60
  s_cmp_lt_u32 s53, 50000
  s_cbranch_scc1 L_vlp_62
  s_branch L_vok_60
L_vslow_64:
  s_mov_b32 s53, 0
L_vlp_65:
  buffer_load_dwordx4 v[28:31], v1, s[32:35], s51 offen offset:3072 sc1
  s_add_u32 s53, s53, 1
  s_waitcnt vmcnt(0)
  v_max3_u32 v14, v28, v29, v30
  v_max_u32 v14, v14, v31
  v_cmp_eq_u32 vcc, -1, v14
  s_nop 1
  s_cbranch_vccz L_vok_63
  s_cmp_lt_u32 s53, 50000
  s_cbranch_scc1 L_vlp_65
  s_branch L_vok_63
L_vslow_67:
  s_mov_b32 s53, 0
L_vlp_68:
  buffer_load_dwordx4 v[32:35], v1, s[32:35], s3 offen offset:0 sc1
  s_add_u32 s53, s53, 1
  s_waitcnt vmcnt(0)
  v_max3_u32 v14, v32, v33, v34
  v_max_u32 v14, v14, v35
  v_cmp_eq_u32 vcc, -1, v14
  s_nop 1
  s_cbranch_vccz L_vok_66
  s_cmp_lt_u32 s53, 50000
  s_cbranch_scc1 L_vlp_68
  s_branch L_vok_66
L_vslow_70:
  s_mov_b32 s53, 0
L_vlp_71:
  buffer_load_dwordx4 v[36:39], v1, s[32:35], s3 offen offset:1024 sc1
  s_add_u32 s53, s53, 1
  s_waitcnt vmcnt(0)
  v_max3_u32 v14, v36, v37, v38
  v_max_u32 v14, v14, v39
  v_cmp_eq_u32 vcc, -1, v14
  s_nop 1
  s_cbranch_vccz L_vok_69
  s_cmp_lt_u32 s53, 50000
  s_cbranch_scc1 L_vlp_71
  s_branch L_vok_69
L_vslow_73:
  s_mov_b32 s53, 0
L_vlp_74:
  buffer_load_dwordx4 v[40:43], v1, s[32:35], s3 offen offset:2048 sc1
  s_add_u32 s53, s53, 1
  s_waitcnt vmcnt(0)
  v_max3_u32 v14, v40, v41, v42
  v_max_u32 v14, v14, v43
  v_cmp_eq_u32 vcc, -1, v14
  s_nop 1
  s_cbranch_vccz L_vok_72
  s_cmp_lt_u32 s53, 50000
  s_cbranch_scc1 L_vlp_74
  s_branch L_vok_72
L_xslow_76:
  s_mov_b32 s53, 0
L_xlp_77:
  buffer_load_dwordx4 v246, s[32:35], s56 offen sc1 lds
  s_add_u32 s53, s53, 1
  s_waitcnt vmcnt(0)
  ds_read_b128 v[88:91], v247
  s_waitcnt lgkmcnt(0)
  v_max3_u32 v11, v88, v89, v90
  v_max_u32 v11, v11, v91
  v_cmp_eq_u32 vcc, -1, v11
  s_nop 1
  s_cbranch_vccz L_xok_75
  s_cmp_lt_u32 s53, 50000
  s_cbranch_scc1 L_xlp_77
  s_branch L_xok_75
L_slow_80:
  s_mov_b32 s53, 0
L_lp_81:
  buffer_load_dword v10, v9, s[32:35], s80 offen sc1
  s_add_u32 s53, s53, 1
  s_waitcnt vmcnt(0)
  v_cmp_ne_u32 vcc, s43, v10
  s_nop 1
  s_cbranch_vccz L_ok_79
  s_cmp_lt_u32 s53, 50000
  s_cbranch_scc1 L_lp_81
  s_branch L_ok_79
L_slow_84:
  s_mov_b32 s53, 0
L_lp_85:
  buffer_load_dword v223, v222, s[32:35], s56 offen sc1
  s_add_u32 s53, s53, 1
  s_waitcnt vmcnt(0)
  v_cmp_ne_u32 vcc, s43, v223
  s_nop 1
  s_cbranch_vccz L_ok_83
  s_cmp_lt_u32 s53, 50000
  s_cbranch_scc1 L_lp_85
  s_branch L_ok_83
L_slow_87:
  s_mov_b32 s53, 0
L_lp_88:
  buffer_load_dword v10, v9, s[32:35], s80 offen sc1
  s_add_u32 s53, s53, 1
  s_waitcnt vmcnt(0)
  v_cmp_ne_u32 vcc, s43, v10
  s_nop 1
  s_cbranch_vccz L_ok_86
  s_cmp_lt_u32 s53, 50000
  s_cbranch_scc1 L_lp_88
  s_branch L_ok_86
L_slow_90:
  s_mov_b32 s53, 0
L_lp_91:
  buffer_load_dword v10, v9, s[32:35], s80 offen sc1
  s_add_u32 s53, s53, 1
  s_waitcnt vmcnt(0)
  v_cmp_ne_u32 vcc, s43, v10
  s_nop 1
  s_cbranch_vccz L_ok_89
  s_cmp_lt_u32 s53, 50000
  s_cbranch_scc1 L_lp_91
  s_branch L_ok_89
L_slow_93:
  s_mov_b32 s53, 0
L_lp_94:
  buffer_load_dword v223, v222, s[32:35], s57 offen sc1
  s_add_u32 s53, s53, 1
  s_waitcnt vmcnt(0)
  v_cmp_ne_u32 vcc, s43, v223
  s_nop 1
  s_cbranch_vccz L_ok_92
  s_cmp_lt_u32 s53, 50000
  s_cbranch_scc1 L_lp_94
  s_branch L_ok_92
L_vslow_96:
  s_mov_b32 s53, 0
L_vlp_97:
  buffer_load_dwordx4 v[16:19], v1, s[32:35], s51 offen offset:0 sc1
  s_add_u32 s53, s53, 1
  s_waitcnt vmcnt(0)
  v_max3_u32 v14, v16, v17, v18
  v_max_u32 v14, v14, v19
  v_cmp_eq_u32 vcc, -1, v14
  s_nop 1
  s_cbranch_vccz L_vok_95
  s_cmp_lt_u32 s53, 50000
  s_cbranch_scc1 L_vlp_97
  s_branch L_vok_95
L_vslow_99:
  s_mov_b32 s53, 0
L_vlp_100:
  buffer_load_dwordx4 v[20:23], v1, s[32:35], s51 offen offset:1024 sc1
  s_add_u32 s53, s53, 1
  s_waitcnt vmcnt(0)
  v_max3_u32 v14, v20, v21, v22
  v_max_u32 v14, v14, v23
  v_cmp_eq_u32 vcc, -1, v14
  s_nop 1
  s_cbranch_vccz L_vok_98
  s_cmp_lt_u32 s53, 50000
  s_cbranch_scc1 L_vlp_100
  s_branch L_vok_98
L_vslow_102:
  s_mov_b32 s53, 0
L_vlp_103:
  buffer_load_dwordx4 v[24:27], v1, s[32:35], s51 offen offset:2048 sc1
  s_add_u32 s53, s53, 1
  s_waitcnt vmcnt(0)
  v_max3_u32 v14, v24, v25, v26
  v_max_u32 v14, v14, v27
  v_cmp_eq_u32 vcc, -1, v14
  s_nop 1
  s_cbranch_vccz L_vok_101
  s_cmp_lt_u32 s53, 50000
  s_cbranch_scc1 L_vlp_103
  s_branch L_vok_101
L_vslow_105:
  s_mov_b32 s53, 0
L_vlp_106:
  buffer_load_dwordx4 v[28:31], v1, s[32:35], s51 offen offset:3072 sc1
  s_add_u32 s53, s53, 1
  s_waitcnt vmcnt(0)
  v_max3_u32 v14, v28, v29, v30
  v_max_u32 v14, v14, v31
  v_cmp_eq_u32 vcc, -1, v14
  s_nop 1
  s_cbranch_vccz L_vok_104
  s_cmp_lt_u32 s53, 50000
  s_cbranch_scc1 L_vlp_106
  s_branch L_vok_104
L_vslow_108:
  s_mov_b32 s53, 0
L_vlp_109:
  buffer_load_dwordx4 v[32:35], v1, s[32:35], s3 offen offset:0 sc1
  s_add_u32 s53, s53, 1
  s_waitcnt vmcnt(0)
  v_max3_u32 v14, v32, v33, v34
  v_max_u32 v14, v14, v35
  v_cmp_eq_u32 vcc, -1, v14
  s_nop 1
  s_cbranch_vccz L_vok_107
  s_cmp_lt_u32 s53, 50000
  s_cbranch_scc1 L_vlp_109
  s_branch L_vok_107
L_vslow_111:
  s_mov_b32 s53, 0
L_vlp_112:
  buffer_load_dwordx4 v[36:39], v1, s[32:35], s3 offen offset:1024 sc1
  s_add_u32 s53, s53, 1
  s_waitcnt vmcnt(0)
  v_max3_u32 v14, v36, v37, v38
  v_max_u32 v14, v14, v39
  v_cmp_eq_u32 vcc, -1, v14
  s_nop 1
  s_cbranch_vccz L_vok_110
  s_cmp_lt_u32 s53, 50000
  s_cbranch_scc1 L_vlp_112
  s_branch L_vok_110
L_vslow_114:
  s_mov_b32 s53, 0
L_vlp_115:
  buffer_load_dwordx4 v[40:43], v1, s[32:35], s3 offen offset:2048 sc1
  s_add_u32 s53, s53, 1
  s_waitcnt vmcnt(0)
  v_max3_u32 v14, v40, v41, v42
  v_max_u32 v14, v14, v43
  v_cmp_eq_u32 vcc, -1, v14
  s_nop 1
  s_cbranch_vccz L_vok_113
  s_cmp_lt_u32 s53, 50000
  s_cbranch_scc1 L_vlp_115
  s_branch L_vok_113
L_xslow_117:
  s_mov_b32 s53, 0
L_xlp_118:
  buffer_load_dwordx4 v246, s[32:35], s56 offen sc1 lds
  s_add_u32 s53, s53, 1
  s_waitcnt vmcnt(0)
  ds_read_b128 v[88:91], v247
  s_waitcnt lgkmcnt(0)
  v_max3_u32 v11, v88, v89, v90
  v_max_u32 v11, v11, v91
  v_cmp_eq_u32 vcc, -1, v11
  s_nop 1
  s_cbranch_vccz L_xok_116
  s_cmp_lt_u32 s53, 50000
  s_cbranch_scc1 L_xlp_118
  s_branch L_xok_116
L_slow_120:
  s_mov_b32 s53, 0
L_lp_121:
  buffer_load_dword v223, v222, s[32:35], s56 offen sc1
  s_add_u32 s53, s53, 1
  s_waitcnt vmcnt(0)
  v_cmp_ne_u32 vcc, s43, v223
  s_nop 1
  s_cbranch_vccz L_ok_119
  s_cmp_lt_u32 s53, 50000
  s_cbranch_scc1 L_lp_121
  s_branch L_ok_119
L_slow_123:
  s_mov_b32 s53, 0
L_lp_124:
  buffer_load_dword v10, v9, s[32:35], s80 offen sc1
  s_add_u32 s53, s53, 1
  s_waitcnt vmcnt(0)
  v_cmp_ne_u32 vcc, s43, v10
  s_nop 1
  s_cbranch_vccz L_ok_122
  s_cmp_lt_u32 s53, 50000
  s_cbranch_scc1 L_lp_124
  s_branch L_ok_122
L_slow_126:
  s_mov_b32 s53, 0
L_lp_127:
  buffer_load_dword v10, v9, s[32:35], s80 offen sc1
  s_add_u32 s53, s53, 1
  s_waitcnt vmcnt(0)
  v_cmp_ne_u32 vcc, s43, v10
  s_nop 1
  s_cbranch_vccz L_ok_125
  s_cmp_lt_u32 s53, 50000
  s_cbranch_scc1 L_lp_127
  s_branch L_ok_125
L_slow_129:
  s_mov_b32 s53, 0
L_lp_130:
  buffer_load_dword v223, v222, s[32:35], s57 offen sc1
  s_add_u32 s53, s53, 1
  s_waitcnt vmcnt(0)
  v_cmp_ne_u32 vcc, s43, v223
  s_nop 1
  s_cbranch_vccz L_ok_128
  s_cmp_lt_u32 s53, 50000
  s_cbranch_scc1 L_lp_130
  s_branch L_ok_128
L_vslow_132:
  s_mov_b32 s53, 0
L_vlp_133:
  buffer_load_dwordx4 v[16:19], v1, s[32:35], s51 offen offset:0 sc1
  s_add_u32 s53, s53, 1
  s_waitcnt vmcnt(0)
  v_max3_u32 v14, v16, v17, v18
  v_max_u32 v14, v14, v19
  v_cmp_eq_u32 vcc, -1, v14
  s_nop 1
  s_cbranch_vccz L_vok_131
  s_cmp_lt_u32 s53, 50000
  s_cbranch_scc1 L_vlp_133
  s_branch L_vok_131
L_vslow_135:
  s_mov_b32 s53, 0
L_vlp_136:
  buffer_load_dwordx4 v[20:23], v1, s[32:35], s51 offen offset:1024 sc1
  s_add_u32 s53, s53, 1
  s_waitcnt vmcnt(0)
  v_max3_u32 v14, v20, v21, v22
  v_max_u32 v14, v14, v23
  v_cmp_eq_u32 vcc, -1, v14
  s_nop 1
  s_cbranch_vccz L_vok_134
  s_cmp_lt_u32 s53, 50000
  s_cbranch_scc1 L_vlp_136
  s_branch L_vok_134
L_vslow_138:
  s_mov_b32 s53, 0
L_vlp_139:
  buffer_load_dwordx4 v[24:27], v1, s[32:35], s51 offen offset:2048 sc1
  s_add_u32 s53, s53, 1
  s_waitcnt vmcnt(0)
  v_max3_u32 v14, v24, v25, v26
  v_max_u32 v14, v14, v27
  v_cmp_eq_u32 vcc, -1, v14
  s_nop 1
  s_cbranch_vccz L_vok_137
  s_cmp_lt_u32 s53, 50000
  s_cbranch_scc1 L_vlp_139
  s_branch L_vok_137
L_vslow_141:
  s_mov_b32 s53, 0
L_vlp_142:
  buffer_load_dwordx4 v[28:31], v1, s[32:35], s51 offen offset:3072 sc1
  s_add_u32 s53, s53, 1
  s_waitcnt vmcnt(0)
  v_max3_u32 v14, v28, v29, v30
  v_max_u32 v14, v14, v31
  v_cmp_eq_u32 vcc, -1, v14
  s_nop 1
  s_cbranch_vccz L_vok_140
  s_cmp_lt_u32 s53, 50000
  s_cbranch_scc1 L_vlp_142
  s_branch L_vok_140
L_vslow_144:
  s_mov_b32 s53, 0
L_vlp_145:
  buffer_load_dwordx4 v[32:35], v1, s[32:35], s3 offen offset:0 sc1
  s_add_u32 s53, s53, 1
  s_waitcnt vmcnt(0)
  v_max3_u32 v14, v32, v33, v34
  v_max_u32 v14, v14, v35
  v_cmp_eq_u32 vcc, -1, v14
  s_nop 1
  s_cbranch_vccz L_vok_143
  s_cmp_lt_u32 s53, 50000
  s_cbranch_scc1 L_vlp_145
  s_branch L_vok_143
L_vslow_147:
  s_mov_b32 s53, 0
L_vlp_148:
  buffer_load_dwordx4 v[36:39], v1, s[32:35], s3 offen offset:1024 sc1
  s_add_u32 s53, s53, 1
  s_waitcnt vmcnt(0)
  v_max3_u32 v14, v36, v37, v38
  v_max_u32 v14, v14, v39
  v_cmp_eq_u32 vcc, -1, v14
  s_nop 1
  s_cbranch_vccz L_vok_146
  s_cmp_lt_u32 s53, 50000
  s_cbranch_scc1 L_vlp_148
  s_branch L_vok_146
L_vslow_150:
  s_mov_b32 s53, 0
L_vlp_151:
  buffer_load_dwordx4 v[40:43], v1, s[32:35], s3 offen offset:2048 sc1
  s_add_u32 s53, s53, 1
  s_waitcnt vmcnt(0)
  v_max3_u32 v14, v40, v41, v42
  v_max_u32 v14, v14, v43
  v_cmp_eq_u32 vcc, -1, v14
  s_nop 1
  s_cbranch_vccz L_vok_149
  s_cmp_lt_u32 s53, 50000
  s_cbranch_scc1 L_vlp_151
  s_branch L_vok_149
L_xslow_153:
  s_mov_b32 s53, 0
L_xlp_154:
  buffer_load_dwordx4 v246, s[32:35], s56 offen sc1 lds
  s_add_u32 s53, s53, 1
  s_waitcnt vmcnt(0)
  ds_read_b128 v[88:91], v247
  s_waitcnt lgkmcnt(0)
  v_max3_u32 v11, v88, v89, v90
  v_max_u32 v11, v11, v91
  v_cmp_eq_u32 vcc, -1, v11
  s_nop 1
  s_cbranch_vccz L_xok_152
  s_cmp_lt_u32 s53, 50000
  s_cbranch_scc1 L_xlp_154
  s_branch L_xok_152
L_tslow_156:
  s_mov_b32 s53, 0
L_tlp_157:
  buffer_load_dwordx4 v[240:243], v222, s[32:35], s88 offen sc1
  buffer_load_dwordx4 v[244:247], v222, s[32:35], s89 offen sc1
  buffer_load_dwordx4 v[248:251], v222, s[32:35], s90 offen sc1
  buffer_load_dwordx4 v[252:255], v222, s[32:35], s91 offen sc1
  s_waitcnt vmcnt(0)
  s_add_u32 s53, s53, 1
  v_xor_b32 v9, s45, v243
  v_bitop3_b32 v9, v247, s45, v9 bitop3:0xbe
  v_bitop3_b32 v9, v251, s45, v9 bitop3:0xbe
  v_bitop3_b32 v9, v255, s45, v9 bitop3:0xbe
  v_cmp_lt_u32 vcc, 0xffff, v9
  s_nop 1
  s_cbranch_vccz L_tok_155
  s_cmp_lt_u32 s53, 50000
  s_cbranch_scc1 L_tlp_157
  s_branch L_tok_155
L_tslow_159:
  s_mov_b32 s53, 0
L_tlp_160:
  s_add_u32 m0, s38, 147456
  s_add_u32 s46, s56, 0
  buffer_load_dwordx4 v1, s[32:35], s46 offen sc1 lds
  s_add_u32 m0, s38, 155648
  s_add_u32 s46, s56, 8192
  buffer_load_dwordx4 v1, s[32:35], s46 offen sc1 lds
  s_add_u32 m0, s38, 98304
  s_add_u32 s46, s56, 16384
  buffer_load_dwordx4 v1, s[32:35], s46 offen sc1 lds
  s_add_u32 m0, s38, 106496
  s_add_u32 s46, s56, 24576
  buffer_load_dwordx4 v1, s[32:35], s46 offen sc1 lds
  s_waitcnt vmcnt(0)
  ds_read_b32 v112, v9
  ds_read_b32 v113, v220
  ds_read_b32 v114, v222
  ds_read_b32 v115, v223
  s_waitcnt lgkmcnt(0)
  s_add_u32 s53, s53, 1
  v_xor_b32 v116, s45, v112
  v_bitop3_b32 v116, v113, s45, v116 bitop3:0xbe
  v_bitop3_b32 v116, v114, s45, v116 bitop3:0xbe
  v_bitop3_b32 v116, v115, s45, v116 bitop3:0xbe
  v_cmp_lt_u32 vcc, 0xffff, v116
  s_nop 1
  s_cbranch_vccz L_tok_158
  s_cmp_lt_u32 s53, 50000
  s_cbranch_scc1 L_tlp_160
  s_branch L_tok_158
L_tslow_162:
  s_mov_b32 s53, 0
L_tlp_163:
  buffer_load_dwordx4 v[240:243], v222, s[32:35], s88 offen sc1
  buffer_load_dwordx4 v[244:247], v222, s[32:35], s89 offen sc1
  buffer_load_dwordx4 v[248:251], v222, s[32:35], s90 offen sc1
  buffer_load_dwordx4 v[252:255], v222, s[32:35], s91 offen sc1
  s_waitcnt vmcnt(0)
  s_add_u32 s53, s53, 1
  v_xor_b32 v9, s45, v243
  v_bitop3_b32 v9, v247, s45, v9 bitop3:0xbe
  v_bitop3_b32 v9, v251, s45, v9 bitop3:0xbe
  v_bitop3_b32 v9, v255, s45, v9 bitop3:0xbe
  v_cmp_lt_u32 vcc, 0xffff, v9
  s_nop 1
  s_cbranch_vccz L_tok_161
  s_cmp_lt_u32 s53, 50000
  s_cbranch_scc1 L_tlp_163
  s_branch L_tok_161
L_tslow_165:
  s_mov_b32 s53, 0
L_tlp_166:
  s_add_u32 m0, s38, 151552
  s_add_u32 s46, s56, 4096
  buffer_load_dwordx4 v1, s[32:35], s46 offen sc1 lds
  s_add_u32 m0, s38, 159744
  s_add_u32 s46, s56, 12288
  buffer_load_dwordx4 v1, s[32:35], s46 offen sc1 lds
  s_add_u32 m0, s38, 102400
  s_add_u32 s46, s56, 20480
  buffer_load_dwordx4 v1, s[32:35], s46 offen sc1 lds
  s_add_u32 m0, s38, 110592
  s_add_u32 s46, s56, 28672
  buffer_load_dwordx4 v1, s[32:35], s46 offen sc1 lds
  s_waitcnt vmcnt(0)
  ds_read_b32 v112, v9
  ds_read_b32 v113, v220
  ds_read_b32 v114, v222
  ds_read_b32 v115, v223
  s_waitcnt lgkmcnt(0)
  s_add_u32 s53, s53, 1
  v_xor_b32 v116, s45, v112
  v_bitop3_b32 v116, v113, s45, v116 bitop3:0xbe
  v_bitop3_b32 v116, v114, s45, v116 bitop3:0xbe
  v_bitop3_b32 v116, v115, s45, v116 bitop3:0xbe
  v_cmp_lt_u32 vcc, 0xffff, v116
  s_nop 1
  s_cbranch_vccz L_tok_164
  s_cmp_lt_u32 s53, 50000
  s_cbranch_scc1 L_tlp_166
  s_branch L_tok_164
L_end:
  s_endpgm
L_code_end:
.section .rodata,"a"
.p2align 6
.amdhsa_kernel parallel_sum__linear_kernel_hedgehog__glu_gated_geglu__prompt_kernel
  .amdhsa_next_free_vgpr 256
  .amdhsa_next_free_sgpr 102
  .amdhsa_accum_offset 256
  .amdhsa_group_segment_fixed_size 0
  .amdhsa_kernarg_size 88
  .amdhsa_user_sgpr_count 2
  .amdhsa_user_sgpr_kernarg_segment_ptr 1
  .amdhsa_system_sgpr_workgroup_id_x 1
.end_amdhsa_kernel
```
